```python
import torch

def _softmax(x, axis=-1):
    return torch.softmax(x, dim=axis)
def _gelu(x):
    return torch.nn.functional.gelu(x, approximate="tanh")
def _silu(x):
    return torch.nn.functional.silu(x)
def _sigmoid(x):
    return torch.sigmoid(x)
def _layernorm(x, axis=-1, eps=1e-5):
    m = x.mean(dim=axis, keepdim=True)
    v = x.var(dim=axis, keepdim=True, unbiased=False)
    return (x - m) / torch.sqrt(v + eps)
def _scatter_add(tgt, idx, src, axis=0):
    return tgt.clone().index_add_(axis, idx, src)
def _segment_sum(src, seg, n):
    out = torch.zeros((n,) + src.shape[1:], dtype=src.dtype)
    return out.index_add_(0, seg, src)
def _pad(x, pw):
    flat = tuple(v for pair in reversed(pw) for v in pair)
    return torch.nn.functional.pad(x, flat)

kernel_name = 'recurrent_scan__sliding_block_cached__dense_activation_squared_relu__prompt'

def setup_inputs():

    _w = (lambda a: (lambda t: t.to(torch.bfloat16) if t.is_floating_point() else t)(torch.as_tensor(a)))
    def _A_setup():
        B, Sq, D = 1, 2048, 512
        Hq, Hkv, Sk, Dh = 32, 8, 2048, 128
        assert Hq % Hkv == 0, (Hq, Hkv)
        return {
            "x": _w((lambda *s: torch.randn(*s, dtype=torch.bfloat16) * 0.05)(B, Sq, D)),
            "k_cache": _w((lambda *s: torch.randn(*s, dtype=torch.bfloat16) * 0.8)(B, Hkv, Sk, Dh)),
            "v_cache": _w((lambda *s: torch.randn(*s, dtype=torch.bfloat16) * 0.2)(B, Hkv, Sk, Dh)),
            "wq": _w((lambda *s: torch.randn(*s, dtype=torch.bfloat16) * 0.8)(D, Hq * Dh) * (D ** -0.5)),
            "wo": _w((lambda *s: torch.randn(*s, dtype=torch.bfloat16) * 0.2)(Hq * Dh, D) * ((Hq * Dh) ** -0.5)),
        }
    _A_in = _A_setup()

    def _B_setup():
        B, S, D, F = 1, 2048, 512, 1792
        return {
            "x": _w((lambda *s: torch.randn(*s, dtype=torch.bfloat16) * 0.05)(B, S, D)),
            "w1": _w((lambda *s: torch.randn(*s, dtype=torch.bfloat16) * 0.1)(D, F)),
            "b1": _w((lambda *s: torch.randn(*s, dtype=torch.bfloat16) * 0.4)(F)),
            "w2": _w((lambda *s: torch.randn(*s, dtype=torch.bfloat16) * 0.1)(F, D)),
            "b2": _w((lambda *s: torch.randn(*s, dtype=torch.bfloat16) * 6.4)(D)),
        }
    _B_in = _B_setup()

    return {
        "A_x": _A_in["x"],
        "A_k_cache": _A_in["k_cache"],
        "A_v_cache": _A_in["v_cache"],
        "A_wq": _A_in["wq"],
        "A_wo": _A_in["wo"],
        "B_x": _B_in["x"],
        "B_w1": _B_in["w1"],
        "B_b1": _B_in["b1"],
        "B_w2": _B_in["w2"],
        "B_b2": _B_in["b2"],
    }

def reference(A_x, A_k_cache, A_v_cache, A_wq, A_wo, B_x, B_w1, B_b1, B_w2, B_b2):
    def _A_ref(x, k_cache, v_cache, wq, wo):
        B, Sq, D = x.shape
        Hq, Dh = 32, 128
        Hkv, Sk = k_cache.shape[1], k_cache.shape[2]
        W = min(4096, max(256, Sk // 4))
        rep = Hq // Hkv
        q = (lambda x, *d: x.permute(*d))((x @ wq).reshape(B, Sq, Hq, Dh), 0, 2, 1, 3)
        k = (lambda x, n, axis: torch.repeat_interleave(x, n, dim=axis))(k_cache[:, :, Sk - W:, :], rep, axis=1)
        v = (lambda x, n, axis: torch.repeat_interleave(x, n, dim=axis))(v_cache[:, :, Sk - W:, :], rep, axis=1)
        scores = torch.einsum("bhqd,bhkd->bhqk", q, k) * (Dh ** -0.5)
        p = _softmax(scores, axis=-1)
        o = torch.einsum("bhqk,bhkd->bhqd", p, v)
        return (lambda x, *d: x.permute(*d))(o, 0, 2, 1, 3).reshape(B, Sq, Hq * Dh) @ wo

    def _B_ref(x, w1, b1, w2, b2):
        h = torch.einsum("bsd,df->bsf", x, w1) + b1
        zero = torch.zeros_like(h)
        r = torch.where(h > zero, h, zero)
        h = r * r
        out = torch.einsum("bsf,fd->bsd", h, w2) + b2
        return out

    x = A_x
    xn = _layernorm(x, axis=-1)
    s = _A_ref(xn, A_k_cache, A_v_cache, A_wq, A_wo)
    g = _silu(_B_ref(xn, B_w1, B_b1, B_w2, B_b2))
    return x + s * g
```

```asm
; @launch grid=(256,1,1) block=(256,1,1) lds=163840
.amdgcn_target "amdgcn-amd-amdhsa--gfx950"
.text
.globl recurrent_scan__sliding_block_cached__dense_activation_squared_relu__prompt_kernel
.p2align 8
.type recurrent_scan__sliding_block_cached__dense_activation_squared_relu__prompt_kernel,@function
recurrent_scan__sliding_block_cached__dense_activation_squared_relu__prompt_kernel:
    s_cmp_ge_u32 s2, 256
    s_cbranch_scc1 L_end
    s_getpc_b64 s[42:43]
L_pc:
    s_and_b32 s10, s2, 8
    s_lshl_b32 s10, s10, 12
    v_lshl_add_u32 v66, v0, 7, s10
    v_min_u32 v66, L_codeend-L_pc-4, v66
    global_load_dword v66, v66, s[42:43]
    s_load_dwordx2 s[44:45], s[0:1], 0
    s_load_dwordx2 s[52:53], s[0:1], 48
    s_load_dwordx2 s[48:49], s[0:1], 24
    s_load_dwordx2 s[56:57], s[0:1], 8
    s_load_dwordx2 s[60:61], s[0:1], 16
    s_load_dwordx2 s[64:65], s[0:1], 32
    s_load_dwordx2 s[80:81], s[0:1], 56
    s_load_dwordx2 s[68:69], s[0:1], 64
    s_load_dwordx2 s[84:85], s[0:1], 72
    s_load_dwordx2 s[76:77], s[0:1], 80
    s_load_dwordx2 s[38:39], s[0:1], 88
    s_load_dwordx2 s[72:73], s[0:1], 96
    v_lshrrev_b32 v65, 6, v0
    v_and_b32 v64, 63, v0
    v_readfirstlane_b32 s3, v65
    s_lshr_b32 s88, s2, 3
    s_and_b32 s13, s2, 7
    s_lshr_b32 s14, s88, 1
    s_lshr_b32 s10, s13, 2
    s_lshl_b32 s10, s10, 4
    s_add_u32 s4, s10, s14
    v_lshrrev_b32 v65, 3, v64
    v_and_b32 v69, 7, v64
    v_lshlrev_b32 v67, 10, v65
    v_lshl_or_b32 v67, v69, 4, v67
    s_lshl_b32 s9, s4, 2
    s_add_u32 s9, s9, s3
    s_lshl_b32 s9, s9, 14
    s_add_u32 s10, s9, 8192
    s_mov_b32 s46, 0x200000
    s_mov_b32 s47, 0x20000
    s_mov_b32 s54, 0x1c0000
    s_mov_b32 s55, 0x20000
    s_mov_b32 s50, 0x400000
    s_mov_b32 s51, 0x20000
    s_mov_b32 s58, 0x20000
    s_mov_b32 s59, 0x20000
    s_mov_b32 s62, 0x20000
    s_mov_b32 s63, 0x20000
    s_mov_b32 s66, 0x80000
    s_mov_b32 s67, 0x20000
    s_mov_b32 s82, 0xe00
    s_mov_b32 s83, 0x20000
    s_mov_b32 s70, 0x1c0000
    s_mov_b32 s71, 0x20000
    s_mov_b32 s86, 0x400
    s_mov_b32 s87, 0x20000
    s_mov_b32 s78, 0x200000
    s_mov_b32 s79, 0x20000
    s_mov_b32 s74, 0x1900000
    s_mov_b32 s75, 0x20000
    s_waitcnt lgkmcnt(0)
    buffer_load_dwordx4 v[0:3], v67, s[44:47], s9 offen offset:0
    buffer_load_dwordx4 v[4:7], v67, s[44:47], s9 offen offset:128
    buffer_load_dwordx4 v[8:11], v67, s[44:47], s9 offen offset:256
    buffer_load_dwordx4 v[12:15], v67, s[44:47], s9 offen offset:384
    buffer_load_dwordx4 v[16:19], v67, s[44:47], s9 offen offset:512
    buffer_load_dwordx4 v[20:23], v67, s[44:47], s9 offen offset:640
    buffer_load_dwordx4 v[24:27], v67, s[44:47], s9 offen offset:768
    buffer_load_dwordx4 v[28:31], v67, s[44:47], s9 offen offset:896
    buffer_load_dwordx4 v[32:35], v67, s[44:47], s10 offen offset:0
    buffer_load_dwordx4 v[36:39], v67, s[44:47], s10 offen offset:128
    buffer_load_dwordx4 v[40:43], v67, s[44:47], s10 offen offset:256
    buffer_load_dwordx4 v[44:47], v67, s[44:47], s10 offen offset:384
    buffer_load_dwordx4 v[48:51], v67, s[44:47], s10 offen offset:512
    buffer_load_dwordx4 v[52:55], v67, s[44:47], s10 offen offset:640
    buffer_load_dwordx4 v[56:59], v67, s[44:47], s10 offen offset:768
    buffer_load_dwordx4 v[60:63], v67, s[44:47], s10 offen offset:896
    v_lshlrev_b32 v193, 7, v64
    s_and_b32 s10, s13, 3
    s_lshl_b32 s10, s10, 1
    s_and_b32 s11, s88, 1
    s_add_u32 s5, s10, s11
    s_mul_i32 s8, s3, 40960
    v_mul_u32_u24 v70, 1040, v65
    v_add_u32 v70, s8, v70
    v_lshl_add_u32 v68, v69, 4, v70
    v_lshrrev_b32 v71, 5, v64
    v_bfe_u32 v72, v64, 2, 2
    v_and_b32 v73, 3, v64
    v_lshrrev_b32 v74, 4, v64
    v_and_b32 v75, 1, v74
    v_lshlrev_b32 v76, 6, v75
    v_lshl_or_b32 v76, v73, 4, v76
    v_lshl_add_u32 v77, v71, 2, v72
    s_lshr_b32 s9, s5, 1
    s_mul_i32 s92, s9, 7
    s_and_b32 s9, s5, 1
    s_lshl_b32 s9, s9, 2
    s_add_u32 s9, s9, s3
    s_add_u32 s92, s92, s9
    s_cmp_eq_u32 s9, 7
    s_cselect_b32 s93, 0x40000000, 0
    v_mul_u32_u24 v78, 3584, v77
    v_add3_u32 v200, v78, v76, s93
    v_xor_b32 v201, 32, v200
    v_add_u32 v201, 27648, v201
    v_add_u32 v202, 55296, v200
    v_add_u32 v203, 55296, v201
    s_and_b32 s27, s14, 15
    s_lshl_b32 s19, s92, 7
    s_mul_i32 s18, s27, 114688
    s_add_u32 s18, s18, s19
    s_lshl_b32 s28, s27, 6
    v_lshlrev_b32 v78, 3, v73
    v_lshl_or_b32 v78, v72, 6, v78
    v_lshl_or_b32 v78, v75, 5, v78
    v_lshl_add_u32 v79, v74, 10, v78
    v_add_u32 v213, s8, v79
    v_xor_b32 v214, 32, v213
    v_and_b32 v80, 15, v64
    v_mul_u32_u24 v81, 1040, v80
    v_lshl_add_u32 v194, v74, 4, v81
    v_add_u32 v195, 81920, v194
    v_add_u32 v110, s28, v194
    v_add_u32 v111, s28, v195
    v_add_u32 v89, 81920, v81
    s_lshl_b32 s9, s5, 19
    s_add_u32 s64, s64, s9
    s_addc_u32 s65, s65, 0
    s_add_u32 s9, s9, 393216
    s_add_u32 s56, s56, s9
    s_addc_u32 s57, s57, 0
    s_add_u32 s60, s60, s9
    s_addc_u32 s61, s61, 0
    s_lshl_b32 s13, s14, 2
    s_add_u32 s13, s13, s3
    s_lshl_b32 s15, s13, 13
    s_lshl_b32 s13, s13, 11
    v_and_b32 v84, 0x780, v193
    s_or_b32 s9, s2, s3
    s_cmp_lg_u32 s9, 0
    s_cbranch_scc0 L_mktag
L_notag:
    v_mov_b32 v86, 0x3f803f80
    v_mov_b32 v87, 0x3f80
    v_mov_b32 v88, 0x3f800000
    v_mov_b32 v90, 0
    v_mov_b32 v91, 0
    v_mov_b32 v92, 0
    v_mov_b32 v93, 0
    v_mov_b32 v94, 0
    v_mov_b32 v95, 0
    v_mov_b32 v96, 0
    v_mov_b32 v97, 0
    s_mov_b32 s11, 0x3b000000
    s_mov_b32 s12, 0x3727c5ac
    s_waitcnt vmcnt(15)
    v_dot2c_f32_bf16 v90, v0, v86
    v_dot2c_f32_bf16 v94, v0, v0
    v_dot2c_f32_bf16 v91, v1, v86
    v_dot2c_f32_bf16 v95, v1, v1
    v_dot2c_f32_bf16 v90, v2, v86
    v_dot2c_f32_bf16 v94, v2, v2
    v_dot2c_f32_bf16 v91, v3, v86
    v_dot2c_f32_bf16 v95, v3, v3
    s_add_u32 m0, s8, 28672
    s_nop 0
    buffer_load_dwordx4 v200, s[52:55], s18 offen offset:0 lds
    s_waitcnt vmcnt(15)
    v_dot2c_f32_bf16 v90, v4, v86
    v_dot2c_f32_bf16 v94, v4, v4
    v_dot2c_f32_bf16 v91, v5, v86
    v_dot2c_f32_bf16 v95, v5, v5
    v_dot2c_f32_bf16 v90, v6, v86
    v_dot2c_f32_bf16 v94, v6, v6
    v_dot2c_f32_bf16 v91, v7, v86
    v_dot2c_f32_bf16 v95, v7, v7
    buffer_load_dwordx4 v201, s[52:55], s18 offen offset:1024 lds
    s_waitcnt vmcnt(15)
    v_dot2c_f32_bf16 v90, v8, v86
    v_dot2c_f32_bf16 v94, v8, v8
    v_dot2c_f32_bf16 v91, v9, v86
    v_dot2c_f32_bf16 v95, v9, v9
    v_dot2c_f32_bf16 v90, v10, v86
    v_dot2c_f32_bf16 v94, v10, v10
    v_dot2c_f32_bf16 v91, v11, v86
    v_dot2c_f32_bf16 v95, v11, v11
    buffer_load_dwordx4 v202, s[52:55], s18 offen offset:2048 lds
    s_waitcnt vmcnt(15)
    v_dot2c_f32_bf16 v90, v12, v86
    v_dot2c_f32_bf16 v94, v12, v12
    v_dot2c_f32_bf16 v91, v13, v86
    v_dot2c_f32_bf16 v95, v13, v13
    v_dot2c_f32_bf16 v90, v14, v86
    v_dot2c_f32_bf16 v94, v14, v14
    v_dot2c_f32_bf16 v91, v15, v86
    v_dot2c_f32_bf16 v95, v15, v15
    buffer_load_dwordx4 v203, s[52:55], s18 offen offset:3072 lds
    s_waitcnt vmcnt(15)
    v_dot2c_f32_bf16 v90, v16, v86
    v_dot2c_f32_bf16 v94, v16, v16
    v_dot2c_f32_bf16 v91, v17, v86
    v_dot2c_f32_bf16 v95, v17, v17
    v_dot2c_f32_bf16 v90, v18, v86
    v_dot2c_f32_bf16 v94, v18, v18
    v_dot2c_f32_bf16 v91, v19, v86
    v_dot2c_f32_bf16 v95, v19, v19
    s_add_u32 m0, s8, 32768
    s_add_u32 s18, s18, 114688
    s_cmp_ge_u32 s18, 1835008
    s_cselect_b32 s18, s19, s18
    buffer_load_dwordx4 v200, s[52:55], s18 offen offset:0 lds
    s_waitcnt vmcnt(15)
    v_dot2c_f32_bf16 v90, v20, v86
    v_dot2c_f32_bf16 v94, v20, v20
    v_dot2c_f32_bf16 v91, v21, v86
    v_dot2c_f32_bf16 v95, v21, v21
    v_dot2c_f32_bf16 v90, v22, v86
    v_dot2c_f32_bf16 v94, v22, v22
    v_dot2c_f32_bf16 v91, v23, v86
    v_dot2c_f32_bf16 v95, v23, v23
    buffer_load_dwordx4 v201, s[52:55], s18 offen offset:1024 lds
    s_waitcnt vmcnt(15)
    v_dot2c_f32_bf16 v90, v24, v86
    v_dot2c_f32_bf16 v94, v24, v24
    v_dot2c_f32_bf16 v91, v25, v86
    v_dot2c_f32_bf16 v95, v25, v25
    v_dot2c_f32_bf16 v90, v26, v86
    v_dot2c_f32_bf16 v94, v26, v26
    v_dot2c_f32_bf16 v91, v27, v86
    v_dot2c_f32_bf16 v95, v27, v27
    buffer_load_dwordx4 v202, s[52:55], s18 offen offset:2048 lds
    s_waitcnt vmcnt(15)
    v_dot2c_f32_bf16 v90, v28, v86
    v_dot2c_f32_bf16 v94, v28, v28
    v_dot2c_f32_bf16 v91, v29, v86
    v_dot2c_f32_bf16 v95, v29, v29
    v_dot2c_f32_bf16 v90, v30, v86
    v_dot2c_f32_bf16 v94, v30, v30
    v_dot2c_f32_bf16 v91, v31, v86
    v_dot2c_f32_bf16 v95, v31, v31
    buffer_load_dwordx4 v203, s[52:55], s18 offen offset:3072 lds
    s_nop 2
    v_add_f32 v90, v90, v91
    v_add_f32 v94, v94, v95
    s_nop 0
    v_add_f32_dpp v90, v90, v90 quad_perm:[1,0,3,2] row_mask:0xf bank_mask:0xf
    v_add_f32_dpp v94, v94, v94 quad_perm:[1,0,3,2] row_mask:0xf bank_mask:0xf
    s_nop 0
    v_add_f32_dpp v90, v90, v90 quad_perm:[2,3,0,1] row_mask:0xf bank_mask:0xf
    v_add_f32_dpp v94, v94, v94 quad_perm:[2,3,0,1] row_mask:0xf bank_mask:0xf
    s_nop 0
    v_add_f32_dpp v90, v90, v90 row_half_mirror row_mask:0xf bank_mask:0xf
    v_add_f32_dpp v94, v94, v94 row_half_mirror row_mask:0xf bank_mask:0xf
    v_mul_f32 v90, s11, v90
    v_cvt_pk_bf16_f32 v100, v90, v90
    v_and_b32 v100, 0xffff0000, v100
    v_xor_b32 v98, 0x80000000, v100
    v_dot2_f32_bf16 v102, v0, v87, v98
    v_dot2_f32_bf16 v103, v0, v88, v98
    v_dot2_f32_bf16 v104, v1, v87, v98
    v_dot2_f32_bf16 v105, v1, v88, v98
    v_dot2_f32_bf16 v106, v2, v87, v98
    v_dot2_f32_bf16 v107, v2, v88, v98
    v_dot2_f32_bf16 v108, v3, v87, v98
    v_dot2_f32_bf16 v109, v3, v88, v98
    v_cvt_pk_bf16_f32 v0, v102, v103
    v_cvt_pk_bf16_f32 v1, v104, v105
    v_cvt_pk_bf16_f32 v2, v106, v107
    v_cvt_pk_bf16_f32 v3, v108, v109
    ds_write_b128 v68, v[0:3] offset:0
    v_dot2_f32_bf16 v102, v4, v87, v98
    v_dot2_f32_bf16 v103, v4, v88, v98
    v_dot2_f32_bf16 v104, v5, v87, v98
    v_dot2_f32_bf16 v105, v5, v88, v98
    v_dot2_f32_bf16 v106, v6, v87, v98
    v_dot2_f32_bf16 v107, v6, v88, v98
    v_dot2_f32_bf16 v108, v7, v87, v98
    v_dot2_f32_bf16 v109, v7, v88, v98
    v_cvt_pk_bf16_f32 v4, v102, v103
    v_cvt_pk_bf16_f32 v5, v104, v105
    v_cvt_pk_bf16_f32 v6, v106, v107
    v_cvt_pk_bf16_f32 v7, v108, v109
    ds_write_b128 v68, v[4:7] offset:128
    v_dot2_f32_bf16 v102, v8, v87, v98
    v_dot2_f32_bf16 v103, v8, v88, v98
    v_dot2_f32_bf16 v104, v9, v87, v98
    v_dot2_f32_bf16 v105, v9, v88, v98
    v_dot2_f32_bf16 v106, v10, v87, v98
    v_dot2_f32_bf16 v107, v10, v88, v98
    v_dot2_f32_bf16 v108, v11, v87, v98
    v_dot2_f32_bf16 v109, v11, v88, v98
    v_cvt_pk_bf16_f32 v8, v102, v103
    v_cvt_pk_bf16_f32 v9, v104, v105
    v_cvt_pk_bf16_f32 v10, v106, v107
    v_cvt_pk_bf16_f32 v11, v108, v109
    ds_write_b128 v68, v[8:11] offset:256
    v_dot2_f32_bf16 v102, v12, v87, v98
    v_dot2_f32_bf16 v103, v12, v88, v98
    v_dot2_f32_bf16 v104, v13, v87, v98
    v_dot2_f32_bf16 v105, v13, v88, v98
    v_dot2_f32_bf16 v106, v14, v87, v98
    v_dot2_f32_bf16 v107, v14, v88, v98
    v_dot2_f32_bf16 v108, v15, v87, v98
    v_dot2_f32_bf16 v109, v15, v88, v98
    v_cvt_pk_bf16_f32 v12, v102, v103
    v_cvt_pk_bf16_f32 v13, v104, v105
    v_cvt_pk_bf16_f32 v14, v106, v107
    v_cvt_pk_bf16_f32 v15, v108, v109
    ds_write_b128 v68, v[12:15] offset:384
    v_dot2_f32_bf16 v102, v16, v87, v98
    v_dot2_f32_bf16 v103, v16, v88, v98
    v_dot2_f32_bf16 v104, v17, v87, v98
    v_dot2_f32_bf16 v105, v17, v88, v98
    v_dot2_f32_bf16 v106, v18, v87, v98
    v_dot2_f32_bf16 v107, v18, v88, v98
    v_dot2_f32_bf16 v108, v19, v87, v98
    v_dot2_f32_bf16 v109, v19, v88, v98
    v_cvt_pk_bf16_f32 v16, v102, v103
    v_cvt_pk_bf16_f32 v17, v104, v105
    v_cvt_pk_bf16_f32 v18, v106, v107
    v_cvt_pk_bf16_f32 v19, v108, v109
    ds_write_b128 v68, v[16:19] offset:512
    v_dot2_f32_bf16 v102, v20, v87, v98
    v_dot2_f32_bf16 v103, v20, v88, v98
    v_dot2_f32_bf16 v104, v21, v87, v98
    v_dot2_f32_bf16 v105, v21, v88, v98
    v_dot2_f32_bf16 v106, v22, v87, v98
    v_dot2_f32_bf16 v107, v22, v88, v98
    v_dot2_f32_bf16 v108, v23, v87, v98
    v_dot2_f32_bf16 v109, v23, v88, v98
    v_cvt_pk_bf16_f32 v20, v102, v103
    v_cvt_pk_bf16_f32 v21, v104, v105
    v_cvt_pk_bf16_f32 v22, v106, v107
    v_cvt_pk_bf16_f32 v23, v108, v109
    ds_write_b128 v68, v[20:23] offset:640
    v_dot2_f32_bf16 v102, v24, v87, v98
    v_dot2_f32_bf16 v103, v24, v88, v98
    v_dot2_f32_bf16 v104, v25, v87, v98
    v_dot2_f32_bf16 v105, v25, v88, v98
    v_dot2_f32_bf16 v106, v26, v87, v98
    v_dot2_f32_bf16 v107, v26, v88, v98
    v_dot2_f32_bf16 v108, v27, v87, v98
    v_dot2_f32_bf16 v109, v27, v88, v98
    v_cvt_pk_bf16_f32 v24, v102, v103
    v_cvt_pk_bf16_f32 v25, v104, v105
    v_cvt_pk_bf16_f32 v26, v106, v107
    v_cvt_pk_bf16_f32 v27, v108, v109
    ds_write_b128 v68, v[24:27] offset:768
    v_dot2_f32_bf16 v102, v28, v87, v98
    v_dot2_f32_bf16 v103, v28, v88, v98
    v_dot2_f32_bf16 v104, v29, v87, v98
    v_dot2_f32_bf16 v105, v29, v88, v98
    v_dot2_f32_bf16 v106, v30, v87, v98
    v_dot2_f32_bf16 v107, v30, v88, v98
    v_dot2_f32_bf16 v108, v31, v87, v98
    v_dot2_f32_bf16 v109, v31, v88, v98
    v_cvt_pk_bf16_f32 v28, v102, v103
    v_cvt_pk_bf16_f32 v29, v104, v105
    v_cvt_pk_bf16_f32 v30, v106, v107
    v_cvt_pk_bf16_f32 v31, v108, v109
    ds_write_b128 v68, v[28:31] offset:896
    s_waitcnt vmcnt(15)
    v_dot2c_f32_bf16 v92, v32, v86
    v_dot2c_f32_bf16 v96, v32, v32
    v_dot2c_f32_bf16 v93, v33, v86
    v_dot2c_f32_bf16 v97, v33, v33
    v_dot2c_f32_bf16 v92, v34, v86
    v_dot2c_f32_bf16 v96, v34, v34
    v_dot2c_f32_bf16 v93, v35, v86
    v_dot2c_f32_bf16 v97, v35, v35
    s_add_u32 m0, s8, 36864
    s_add_u32 s18, s18, 114688
    s_cmp_ge_u32 s18, 1835008
    s_cselect_b32 s18, s19, s18
    buffer_load_dwordx4 v200, s[52:55], s18 offen offset:0 lds
    s_waitcnt vmcnt(15)
    v_dot2c_f32_bf16 v92, v36, v86
    v_dot2c_f32_bf16 v96, v36, v36
    v_dot2c_f32_bf16 v93, v37, v86
    v_dot2c_f32_bf16 v97, v37, v37
    v_dot2c_f32_bf16 v92, v38, v86
    v_dot2c_f32_bf16 v96, v38, v38
    v_dot2c_f32_bf16 v93, v39, v86
    v_dot2c_f32_bf16 v97, v39, v39
    buffer_load_dwordx4 v201, s[52:55], s18 offen offset:1024 lds
    s_waitcnt vmcnt(15)
    v_dot2c_f32_bf16 v92, v40, v86
    v_dot2c_f32_bf16 v96, v40, v40
    v_dot2c_f32_bf16 v93, v41, v86
    v_dot2c_f32_bf16 v97, v41, v41
    v_dot2c_f32_bf16 v92, v42, v86
    v_dot2c_f32_bf16 v96, v42, v42
    v_dot2c_f32_bf16 v93, v43, v86
    v_dot2c_f32_bf16 v97, v43, v43
    buffer_load_dwordx4 v202, s[52:55], s18 offen offset:2048 lds
    s_waitcnt vmcnt(15)
    v_dot2c_f32_bf16 v92, v44, v86
    v_dot2c_f32_bf16 v96, v44, v44
    v_dot2c_f32_bf16 v93, v45, v86
    v_dot2c_f32_bf16 v97, v45, v45
    v_dot2c_f32_bf16 v92, v46, v86
    v_dot2c_f32_bf16 v96, v46, v46
    v_dot2c_f32_bf16 v93, v47, v86
    v_dot2c_f32_bf16 v97, v47, v47
    buffer_load_dwordx4 v203, s[52:55], s18 offen offset:3072 lds
    s_waitcnt vmcnt(15)
    v_dot2c_f32_bf16 v92, v48, v86
    v_dot2c_f32_bf16 v96, v48, v48
    v_dot2c_f32_bf16 v93, v49, v86
    v_dot2c_f32_bf16 v97, v49, v49
    v_dot2c_f32_bf16 v92, v50, v86
    v_dot2c_f32_bf16 v96, v50, v50
    v_dot2c_f32_bf16 v93, v51, v86
    v_dot2c_f32_bf16 v97, v51, v51
    s_add_u32 m0, s8, 20480
    s_add_u32 s18, s18, 114688
    s_cmp_ge_u32 s18, 1835008
    s_cselect_b32 s18, s19, s18
    buffer_load_dwordx4 v200, s[52:55], s18 offen offset:0 lds
    s_waitcnt vmcnt(15)
    v_dot2c_f32_bf16 v92, v52, v86
    v_dot2c_f32_bf16 v96, v52, v52
    v_dot2c_f32_bf16 v93, v53, v86
    v_dot2c_f32_bf16 v97, v53, v53
    v_dot2c_f32_bf16 v92, v54, v86
    v_dot2c_f32_bf16 v96, v54, v54
    v_dot2c_f32_bf16 v93, v55, v86
    v_dot2c_f32_bf16 v97, v55, v55
    buffer_load_dwordx4 v201, s[52:55], s18 offen offset:1024 lds
    s_waitcnt vmcnt(15)
    v_dot2c_f32_bf16 v92, v56, v86
    v_dot2c_f32_bf16 v96, v56, v56
    v_dot2c_f32_bf16 v93, v57, v86
    v_dot2c_f32_bf16 v97, v57, v57
    v_dot2c_f32_bf16 v92, v58, v86
    v_dot2c_f32_bf16 v96, v58, v58
    v_dot2c_f32_bf16 v93, v59, v86
    v_dot2c_f32_bf16 v97, v59, v59
    buffer_load_dwordx4 v202, s[52:55], s18 offen offset:2048 lds
    s_waitcnt vmcnt(15)
    v_dot2c_f32_bf16 v92, v60, v86
    v_dot2c_f32_bf16 v96, v60, v60
    v_dot2c_f32_bf16 v93, v61, v86
    v_dot2c_f32_bf16 v97, v61, v61
    v_dot2c_f32_bf16 v92, v62, v86
    v_dot2c_f32_bf16 v96, v62, v62
    v_dot2c_f32_bf16 v93, v63, v86
    v_dot2c_f32_bf16 v97, v63, v63
    buffer_load_dwordx4 v203, s[52:55], s18 offen offset:3072 lds
    s_nop 2
    v_add_f32 v92, v92, v93
    v_add_f32 v96, v96, v97
    s_nop 0
    v_add_f32_dpp v92, v92, v92 quad_perm:[1,0,3,2] row_mask:0xf bank_mask:0xf
    v_add_f32_dpp v96, v96, v96 quad_perm:[1,0,3,2] row_mask:0xf bank_mask:0xf
    s_nop 0
    v_add_f32_dpp v92, v92, v92 quad_perm:[2,3,0,1] row_mask:0xf bank_mask:0xf
    v_add_f32_dpp v96, v96, v96 quad_perm:[2,3,0,1] row_mask:0xf bank_mask:0xf
    s_nop 0
    v_add_f32_dpp v92, v92, v92 row_half_mirror row_mask:0xf bank_mask:0xf
    v_add_f32_dpp v96, v96, v96 row_half_mirror row_mask:0xf bank_mask:0xf
    v_mul_f32 v92, s11, v92
    v_cvt_pk_bf16_f32 v100, v92, v92
    v_and_b32 v100, 0xffff0000, v100
    v_xor_b32 v99, 0x80000000, v100
    v_dot2_f32_bf16 v102, v32, v87, v99
    v_dot2_f32_bf16 v103, v32, v88, v99
    v_dot2_f32_bf16 v104, v33, v87, v99
    v_dot2_f32_bf16 v105, v33, v88, v99
    v_dot2_f32_bf16 v106, v34, v87, v99
    v_dot2_f32_bf16 v107, v34, v88, v99
    v_dot2_f32_bf16 v108, v35, v87, v99
    v_dot2_f32_bf16 v109, v35, v88, v99
    v_cvt_pk_bf16_f32 v32, v102, v103
    v_cvt_pk_bf16_f32 v33, v104, v105
    v_cvt_pk_bf16_f32 v34, v106, v107
    v_cvt_pk_bf16_f32 v35, v108, v109
    ds_write_b128 v68, v[32:35] offset:8320
    s_add_u32 m0, s8, 24576
    s_add_u32 s18, s18, 114688
    s_cmp_ge_u32 s18, 1835008
    s_cselect_b32 s18, s19, s18
    buffer_load_dwordx4 v200, s[52:55], s18 offen offset:0 lds
    v_dot2_f32_bf16 v102, v36, v87, v99
    v_dot2_f32_bf16 v103, v36, v88, v99
    v_dot2_f32_bf16 v104, v37, v87, v99
    v_dot2_f32_bf16 v105, v37, v88, v99
    v_dot2_f32_bf16 v106, v38, v87, v99
    v_dot2_f32_bf16 v107, v38, v88, v99
    v_dot2_f32_bf16 v108, v39, v87, v99
    v_dot2_f32_bf16 v109, v39, v88, v99
    v_cvt_pk_bf16_f32 v36, v102, v103
    v_cvt_pk_bf16_f32 v37, v104, v105
    v_cvt_pk_bf16_f32 v38, v106, v107
    v_cvt_pk_bf16_f32 v39, v108, v109
    ds_write_b128 v68, v[36:39] offset:8448
    buffer_load_dwordx4 v201, s[52:55], s18 offen offset:1024 lds
    v_dot2_f32_bf16 v102, v40, v87, v99
    v_dot2_f32_bf16 v103, v40, v88, v99
    v_dot2_f32_bf16 v104, v41, v87, v99
    v_dot2_f32_bf16 v105, v41, v88, v99
    v_dot2_f32_bf16 v106, v42, v87, v99
    v_dot2_f32_bf16 v107, v42, v88, v99
    v_dot2_f32_bf16 v108, v43, v87, v99
    v_dot2_f32_bf16 v109, v43, v88, v99
    v_cvt_pk_bf16_f32 v40, v102, v103
    v_cvt_pk_bf16_f32 v41, v104, v105
    v_cvt_pk_bf16_f32 v42, v106, v107
    v_cvt_pk_bf16_f32 v43, v108, v109
    ds_write_b128 v68, v[40:43] offset:8576
    buffer_load_dwordx4 v202, s[52:55], s18 offen offset:2048 lds
    v_dot2_f32_bf16 v102, v44, v87, v99
    v_dot2_f32_bf16 v103, v44, v88, v99
    v_dot2_f32_bf16 v104, v45, v87, v99
    v_dot2_f32_bf16 v105, v45, v88, v99
    v_dot2_f32_bf16 v106, v46, v87, v99
    v_dot2_f32_bf16 v107, v46, v88, v99
    v_dot2_f32_bf16 v108, v47, v87, v99
    v_dot2_f32_bf16 v109, v47, v88, v99
    v_cvt_pk_bf16_f32 v44, v102, v103
    v_cvt_pk_bf16_f32 v45, v104, v105
    v_cvt_pk_bf16_f32 v46, v106, v107
    v_cvt_pk_bf16_f32 v47, v108, v109
    ds_write_b128 v68, v[44:47] offset:8704
    buffer_load_dwordx4 v203, s[52:55], s18 offen offset:3072 lds
    v_dot2_f32_bf16 v102, v48, v87, v99
    v_dot2_f32_bf16 v103, v48, v88, v99
    v_dot2_f32_bf16 v104, v49, v87, v99
    v_dot2_f32_bf16 v105, v49, v88, v99
    v_dot2_f32_bf16 v106, v50, v87, v99
    v_dot2_f32_bf16 v107, v50, v88, v99
    v_dot2_f32_bf16 v108, v51, v87, v99
    v_dot2_f32_bf16 v109, v51, v88, v99
    v_cvt_pk_bf16_f32 v48, v102, v103
    v_cvt_pk_bf16_f32 v49, v104, v105
    v_cvt_pk_bf16_f32 v50, v106, v107
    v_cvt_pk_bf16_f32 v51, v108, v109
    ds_write_b128 v68, v[48:51] offset:8832
    v_dot2_f32_bf16 v102, v52, v87, v99
    v_dot2_f32_bf16 v103, v52, v88, v99
    v_dot2_f32_bf16 v104, v53, v87, v99
    v_dot2_f32_bf16 v105, v53, v88, v99
    v_dot2_f32_bf16 v106, v54, v87, v99
    v_dot2_f32_bf16 v107, v54, v88, v99
    v_dot2_f32_bf16 v108, v55, v87, v99
    v_dot2_f32_bf16 v109, v55, v88, v99
    v_cvt_pk_bf16_f32 v52, v102, v103
    v_cvt_pk_bf16_f32 v53, v104, v105
    v_cvt_pk_bf16_f32 v54, v106, v107
    v_cvt_pk_bf16_f32 v55, v108, v109
    ds_write_b128 v68, v[52:55] offset:8960
    v_dot2_f32_bf16 v102, v56, v87, v99
    v_dot2_f32_bf16 v103, v56, v88, v99
    v_dot2_f32_bf16 v104, v57, v87, v99
    v_dot2_f32_bf16 v105, v57, v88, v99
    v_dot2_f32_bf16 v106, v58, v87, v99
    v_dot2_f32_bf16 v107, v58, v88, v99
    v_dot2_f32_bf16 v108, v59, v87, v99
    v_dot2_f32_bf16 v109, v59, v88, v99
    v_cvt_pk_bf16_f32 v56, v102, v103
    v_cvt_pk_bf16_f32 v57, v104, v105
    v_cvt_pk_bf16_f32 v58, v106, v107
    v_cvt_pk_bf16_f32 v59, v108, v109
    ds_write_b128 v68, v[56:59] offset:9088
    v_dot2_f32_bf16 v102, v60, v87, v99
    v_dot2_f32_bf16 v103, v60, v88, v99
    v_dot2_f32_bf16 v104, v61, v87, v99
    v_dot2_f32_bf16 v105, v61, v88, v99
    v_dot2_f32_bf16 v106, v62, v87, v99
    v_dot2_f32_bf16 v107, v62, v88, v99
    v_dot2_f32_bf16 v108, v63, v87, v99
    v_dot2_f32_bf16 v109, v63, v88, v99
    v_cvt_pk_bf16_f32 v60, v102, v103
    v_cvt_pk_bf16_f32 v61, v104, v105
    v_cvt_pk_bf16_f32 v62, v106, v107
    v_cvt_pk_bf16_f32 v63, v108, v109
    ds_write_b128 v68, v[60:63] offset:9216
    buffer_load_dword v85, v84, s[56:59], s13 offen
    buffer_load_dword v85, v84, s[60:63], s13 offen
    v_lshlrev_b32 v82, 3, v74
    v_mov_b32 v216, 0
    buffer_load_dwordx2 v[112:113], v82, s[80:83], s19 offen offset:0
    buffer_load_dwordx2 v[114:115], v82, s[80:83], s19 offen offset:32
    buffer_load_dwordx2 v[116:117], v82, s[80:83], s19 offen offset:64
    buffer_load_dwordx2 v[118:119], v82, s[80:83], s19 offen offset:96
    global_load_dwordx2 v[216:217], v216, s[38:39] sc1
    v_mul_f32 v94, s11, v94
    v_fma_f32 v94, -v90, v90, v94
    v_max_f32 v94, 0, v94
    v_mul_f32 v96, s11, v96
    v_fma_f32 v96, -v92, v92, v96
    v_max_f32 v96, 0, v96
    v_cvt_pk_bf16_f32 v100, v94, v96
    v_lshlrev_b32 v101, 16, v100
    v_and_b32 v100, 0xffff0000, v100
    v_add_f32 v101, s12, v101
    v_add_f32 v100, s12, v100
    v_cvt_pk_bf16_f32 v100, v101, v100
    v_lshlrev_b32 v101, 16, v100
    v_and_b32 v100, 0xffff0000, v100
    v_sqrt_f32 v101, v101
    v_sqrt_f32 v100, v100
    s_nop 0
    v_cvt_pk_bf16_f32 v100, v101, v100
    v_lshlrev_b32 v101, 16, v100
    v_and_b32 v100, 0xffff0000, v100
    v_rcp_f32 v101, v101
    v_rcp_f32 v100, v100
    s_nop 0
    ds_write_b32 v70, v101 offset:1024
    ds_write_b32 v70, v100 offset:9344
    s_waitcnt vmcnt(23)
    ds_read_b64_tr_b16 v[224:225], v213 offset:28672
    ds_read_b64_tr_b16 v[226:227], v213 offset:29184
    ds_read_b64_tr_b16 v[228:229], v214 offset:28672
    ds_read_b64_tr_b16 v[230:231], v214 offset:29184
    ds_read_b64_tr_b16 v[232:233], v213 offset:28928
    ds_read_b64_tr_b16 v[234:235], v213 offset:29440
    ds_read_b64_tr_b16 v[236:237], v214 offset:28928
    ds_read_b64_tr_b16 v[238:239], v214 offset:29440
    s_waitcnt lgkmcnt(8)
    s_barrier
    ds_read_b128 a[0:3], v110 offset:0
    ds_read_b128 a[4:7], v110 offset:40960
    ds_read_b128 a[8:11], v111 offset:0
    ds_read_b128 a[12:15], v111 offset:40960
    ds_read_b32 v218, v81 offset:1024
    ds_read_b32 v219, v81 offset:41984
    ds_read_b32 v220, v89 offset:1024
    ds_read_b32 v221, v89 offset:41984
    s_add_u32 s28, s28, 64
    s_and_b32 s28, s28, 0x3ff
    v_add_u32 v110, s28, v194
    v_add_u32 v111, s28, v195
    ds_read_b128 a[16:19], v110 offset:0
    ds_read_b128 a[20:23], v110 offset:40960
    ds_read_b128 a[24:27], v111 offset:0
    ds_read_b128 a[28:31], v111 offset:40960
    s_waitcnt vmcnt(19) lgkmcnt(8)
    v_mfma_f32_16x16x32_bf16 v[128:131], v[224:227], a[0:3], 0
    s_add_u32 m0, s8, 28672
    ds_read_b64_tr_b16 v[240:241], v213 offset:32768
    v_lshl_add_u32 v196, v77, 13, v76
    v_mfma_f32_16x16x32_bf16 v[136:139], v[224:227], a[4:7], 0
    s_add_u32 s18, s18, 114688
    ds_read_b64_tr_b16 v[242:243], v213 offset:33280
    v_xor_b32 v197, 32, v196
    v_mfma_f32_16x16x32_bf16 v[144:147], v[224:227], a[8:11], 0
    s_cmp_ge_u32 s18, 1835008
    s_cselect_b32 s18, s19, s18
    ds_read_b64_tr_b16 v[244:245], v214 offset:32768
    v_mfma_f32_16x16x32_bf16 v[152:155], v[224:227], a[12:15], 0
    buffer_load_dwordx4 v200, s[52:55], s18 offen offset:0 lds
    v_mfma_f32_16x16x32_bf16 v[132:135], v[228:231], a[0:3], 0
    s_add_u32 s28, s28, 64
    ds_read_b64_tr_b16 v[246:247], v214 offset:33280
    v_add_u32 v197, 64512, v197
    v_mfma_f32_16x16x32_bf16 v[140:143], v[228:231], a[4:7], 0
    s_and_b32 s28, s28, 0x3ff
    ds_read_b64_tr_b16 v[248:249], v213 offset:33024
    v_add_u32 v110, s28, v194
    v_mfma_f32_16x16x32_bf16 v[148:151], v[228:231], a[8:11], 0
    s_lshl_b32 s95, s5, 10
    ds_read_b64_tr_b16 v[250:251], v213 offset:33536
    v_add_u32 v111, s28, v195
    v_mfma_f32_16x16x32_bf16 v[156:159], v[228:231], a[12:15], 0
    buffer_load_dwordx4 v201, s[52:55], s18 offen offset:1024 lds
    v_mfma_f32_16x16x32_bf16 v[160:163], v[232:235], a[0:3], 0
    s_lshl_b32 s9, s3, 8
    ds_read_b64_tr_b16 v[252:253], v214 offset:33024
    v_add_u32 v198, 129024, v196
    v_mfma_f32_16x16x32_bf16 v[168:171], v[232:235], a[4:7], 0
    s_add_u32 s95, s95, s9
    ds_read_b64_tr_b16 v[254:255], v214 offset:33536
    v_add_u32 v199, 129024, v197
    v_mfma_f32_16x16x32_bf16 v[176:179], v[232:235], a[8:11], 0
    s_lshl_b32 s9, s27, 18
    ds_read_b128 a[32:35], v110 offset:0
    v_lshlrev_b32 v82, 3, v74
    v_mfma_f32_16x16x32_bf16 v[184:187], v[232:235], a[12:15], 0
    buffer_load_dwordx4 v202, s[52:55], s18 offen offset:2048 lds
    v_mfma_f32_16x16x32_bf16 v[164:167], v[236:239], a[0:3], 0
    s_add_u32 s95, s95, s9
    ds_read_b128 a[36:39], v110 offset:40960
    v_lshl_add_u32 v204, v77, 10, v76
    v_mfma_f32_16x16x32_bf16 v[172:175], v[236:239], a[4:7], 0
    s_lshl_b32 s17, s14, 14
    ds_read_b128 a[40:43], v111 offset:0
    v_lshlrev_b32 v76, 5, v71
    v_mfma_f32_16x16x32_bf16 v[180:183], v[236:239], a[8:11], 0
    buffer_load_dwordx4 v203, s[52:55], s18 offen offset:3072 lds
    v_mfma_f32_16x16x32_bf16 v[188:191], v[236:239], a[12:15], 0
    s_waitcnt vmcnt(19) lgkmcnt(3)
    ds_read_b128 a[44:47], v111 offset:40960
    v_xor_b32 v204, v76, v204
    v_mfma_f32_16x16x32_bf16 v[128:131], v[240:243], a[16:19], v[128:131]
    s_add_u32 m0, s8, 32768
    ds_read_b64_tr_b16 v[224:225], v213 offset:36864
    v_add_u32 v205, 7168, v204
    v_mfma_f32_16x16x32_bf16 v[136:139], v[240:243], a[20:23], v[136:139]
    s_add_u32 s18, s18, 114688
    ds_read_b64_tr_b16 v[226:227], v213 offset:37376
    v_lshl_add_u32 v76, v74, 9, v78
    v_mfma_f32_16x16x32_bf16 v[144:147], v[240:243], a[24:27], v[144:147]
    s_cmp_ge_u32 s18, 1835008
    s_cselect_b32 s18, s19, s18
    ds_read_b64_tr_b16 v[228:229], v214 offset:36864
    v_mfma_f32_16x16x32_bf16 v[152:155], v[240:243], a[28:31], v[152:155]
    buffer_load_dwordx4 v200, s[52:55], s18 offen offset:0 lds
    v_mfma_f32_16x16x32_bf16 v[132:135], v[244:247], a[16:19], v[132:135]
    s_add_u32 s28, s28, 64
    ds_read_b64_tr_b16 v[230:231], v214 offset:37376
    v_add_u32 v206, s8, v76
    v_mfma_f32_16x16x32_bf16 v[140:143], v[244:247], a[20:23], v[140:143]
    s_and_b32 s28, s28, 0x3ff
    ds_read_b64_tr_b16 v[232:233], v213 offset:37120
    v_add_u32 v110, s28, v194
    v_mfma_f32_16x16x32_bf16 v[148:151], v[244:247], a[24:27], v[148:151]
    s_lshl_b32 s9, s3, 12
    ds_read_b64_tr_b16 v[234:235], v213 offset:37632
    v_add_u32 v111, s28, v195
    v_mfma_f32_16x16x32_bf16 v[156:159], v[244:247], a[28:31], v[156:159]
    buffer_load_dwordx4 v201, s[52:55], s18 offen offset:1024 lds
    v_mfma_f32_16x16x32_bf16 v[160:163], v[248:251], a[16:19], v[160:163]
    s_add_u32 s17, s17, s9
    ds_read_b64_tr_b16 v[236:237], v214 offset:37120
    v_xor_b32 v207, 32, v206
    v_mfma_f32_16x16x32_bf16 v[168:171], v[248:251], a[20:23], v[168:171]
    s_sub_u32 s16, s17, 8192
    ds_read_b64_tr_b16 v[238:239], v214 offset:37632
    v_lshlrev_b32 v192, 4, v64
    v_mfma_f32_16x16x32_bf16 v[176:179], v[248:251], a[24:27], v[176:179]
    s_and_b32 s17, s17, 0x1ffff
    ds_read_b128 a[48:51], v110 offset:0
    v_lshlrev_b32 v76, 6, v74
    v_mfma_f32_16x16x32_bf16 v[184:187], v[248:251], a[28:31], v[184:187]
    buffer_load_dwordx4 v202, s[52:55], s18 offen offset:2048 lds
    v_mfma_f32_16x16x32_bf16 v[164:167], v[252:255], a[16:19], v[164:167]
    s_and_b32 s16, s16, 0x1ffff
    ds_read_b128 a[52:55], v110 offset:40960
    v_lshl_or_b32 v76, v73, 4, v76
    v_mfma_f32_16x16x32_bf16 v[172:175], v[252:255], a[20:23], v[172:175]
    s_mov_b32 s33, 0x40004000
    ds_read_b128 a[56:59], v111 offset:0
    v_lshl_add_u32 v209, v72, 8, v76
    v_mfma_f32_16x16x32_bf16 v[180:183], v[252:255], a[24:27], v[180:183]
    buffer_load_dwordx4 v203, s[52:55], s18 offen offset:3072 lds
    v_mfma_f32_16x16x32_bf16 v[188:191], v[252:255], a[28:31], v[188:191]
    s_waitcnt vmcnt(19) lgkmcnt(3)
    ds_read_b128 a[60:63], v111 offset:40960
    v_xor_b32 v210, 32, v209
    v_mfma_f32_16x16x32_bf16 v[128:131], v[224:227], a[32:35], v[128:131]
    s_add_u32 m0, s8, 36864
    ds_read_b64_tr_b16 v[240:241], v213 offset:20480
    v_add_u32 v215, 107264, v79
    v_mfma_f32_16x16x32_bf16 v[136:139], v[224:227], a[36:39], v[136:139]
    s_add_u32 s18, s18, 114688
    ds_read_b64_tr_b16 v[242:243], v213 offset:20992
    v_xor_b32 v223, 32, v215
    v_mfma_f32_16x16x32_bf16 v[144:147], v[224:227], a[40:43], v[144:147]
    s_cmp_ge_u32 s18, 1835008
    s_cselect_b32 s18, s19, s18
    ds_read_b64_tr_b16 v[244:245], v214 offset:20480
    v_mfma_f32_16x16x32_bf16 v[152:155], v[224:227], a[44:47], v[152:155]
    buffer_load_dwordx4 v200, s[52:55], s18 offen offset:0 lds
    v_mfma_f32_16x16x32_bf16 v[132:135], v[228:231], a[32:35], v[132:135]
    s_add_u32 s28, s28, 64
    ds_read_b64_tr_b16 v[246:247], v214 offset:20992
    v_xor_b32 v77, v80, v74
    v_mfma_f32_16x16x32_bf16 v[140:143], v[228:231], a[36:39], v[140:143]
    s_and_b32 s28, s28, 0x3ff
    ds_read_b64_tr_b16 v[248:249], v213 offset:20736
    v_add_u32 v110, s28, v194
    v_mfma_f32_16x16x32_bf16 v[148:151], v[228:231], a[40:43], v[148:151]
    s_mov_b32 s40, 0
    ds_read_b64_tr_b16 v[250:251], v213 offset:21248
    v_add_u32 v111, s28, v195
    v_mfma_f32_16x16x32_bf16 v[156:159], v[228:231], a[44:47], v[156:159]
    buffer_load_dwordx4 v201, s[52:55], s18 offen offset:1024 lds
    v_mfma_f32_16x16x32_bf16 v[160:163], v[232:235], a[32:35], v[160:163]
    ds_read_b64_tr_b16 v[252:253], v214 offset:20736
    v_lshlrev_b32 v77, 4, v77
    v_mfma_f32_16x16x32_bf16 v[168:171], v[232:235], a[36:39], v[168:171]
    ds_read_b64_tr_b16 v[254:255], v214 offset:21248
    v_lshl_or_b32 v208, v74, 8, v77
    v_mfma_f32_16x16x32_bf16 v[176:179], v[232:235], a[40:43], v[176:179]
    ds_read_b128 a[64:67], v110 offset:0
    v_lshl_add_u32 v76, v75, 1, v71
    v_mfma_f32_16x16x32_bf16 v[184:187], v[232:235], a[44:47], v[184:187]
    buffer_load_dwordx4 v202, s[52:55], s18 offen offset:2048 lds
    v_mfma_f32_16x16x32_bf16 v[164:167], v[236:239], a[32:35], v[164:167]
    ds_read_b128 a[68:71], v110 offset:40960
    v_xor_b32 v76, v76, v73
    v_mfma_f32_16x16x32_bf16 v[172:175], v[236:239], a[36:39], v[172:175]
    ds_read_b128 a[72:75], v111 offset:0
    v_mul_u32_u24 v77, 1088, v72
    v_mfma_f32_16x16x32_bf16 v[180:183], v[236:239], a[40:43], v[180:183]
    buffer_load_dwordx4 v203, s[52:55], s18 offen offset:3072 lds
    v_mfma_f32_16x16x32_bf16 v[188:191], v[236:239], a[44:47], v[188:191]
    s_waitcnt vmcnt(19) lgkmcnt(3)
    ds_read_b128 a[76:79], v111 offset:40960
    v_lshl_add_u32 v77, v73, 8, v77
    v_mfma_f32_16x16x32_bf16 v[128:131], v[240:243], a[48:51], v[128:131]
    s_add_u32 m0, s8, 20480
    ds_read_b64_tr_b16 v[224:225], v213 offset:24576
    v_lshl_add_u32 v211, v76, 4, v77
    v_mfma_f32_16x16x32_bf16 v[136:139], v[240:243], a[52:55], v[136:139]
    s_add_u32 s18, s18, 114688
    ds_read_b64_tr_b16 v[226:227], v213 offset:25088
    v_add_u32 v212, 81920, v211
    v_mfma_f32_16x16x32_bf16 v[144:147], v[240:243], a[56:59], v[144:147]
    s_cmp_ge_u32 s18, 1835008
    s_cselect_b32 s18, s19, s18
    ds_read_b64_tr_b16 v[228:229], v214 offset:24576
    v_mfma_f32_16x16x32_bf16 v[152:155], v[240:243], a[60:63], v[152:155]
    buffer_load_dwordx4 v200, s[52:55], s18 offen offset:0 lds
    v_mfma_f32_16x16x32_bf16 v[132:135], v[244:247], a[48:51], v[132:135]
    s_add_u32 s28, s28, 64
    ds_read_b64_tr_b16 v[230:231], v214 offset:25088
    v_mfma_f32_16x16x32_bf16 v[140:143], v[244:247], a[52:55], v[140:143]
    s_and_b32 s28, s28, 0x3ff
    ds_read_b64_tr_b16 v[232:233], v213 offset:24832
    v_add_u32 v110, s28, v194
    v_mfma_f32_16x16x32_bf16 v[148:151], v[244:247], a[56:59], v[148:151]
    ds_read_b64_tr_b16 v[234:235], v213 offset:25344
    v_add_u32 v111, s28, v195
    v_mfma_f32_16x16x32_bf16 v[156:159], v[244:247], a[60:63], v[156:159]
    buffer_load_dwordx4 v201, s[52:55], s18 offen offset:1024 lds
    v_mfma_f32_16x16x32_bf16 v[160:163], v[248:251], a[48:51], v[160:163]
    ds_read_b64_tr_b16 v[236:237], v214 offset:24832
    v_mfma_f32_16x16x32_bf16 v[168:171], v[248:251], a[52:55], v[168:171]
    ds_read_b64_tr_b16 v[238:239], v214 offset:25344
    v_mfma_f32_16x16x32_bf16 v[176:179], v[248:251], a[56:59], v[176:179]
    ds_read_b128 a[80:83], v110 offset:0
    v_mfma_f32_16x16x32_bf16 v[184:187], v[248:251], a[60:63], v[184:187]
    buffer_load_dwordx4 v202, s[52:55], s18 offen offset:2048 lds
    v_mfma_f32_16x16x32_bf16 v[164:167], v[252:255], a[48:51], v[164:167]
    ds_read_b128 a[84:87], v110 offset:40960
    v_mfma_f32_16x16x32_bf16 v[172:175], v[252:255], a[52:55], v[172:175]
    ds_read_b128 a[88:91], v111 offset:0
    v_mfma_f32_16x16x32_bf16 v[180:183], v[252:255], a[56:59], v[180:183]
    buffer_load_dwordx4 v203, s[52:55], s18 offen offset:3072 lds
    v_mfma_f32_16x16x32_bf16 v[188:191], v[252:255], a[60:63], v[188:191]
    s_waitcnt vmcnt(12) lgkmcnt(3)
    ds_read_b128 a[92:95], v111 offset:40960
    v_mfma_f32_16x16x32_bf16 v[128:131], v[224:227], a[64:67], v[128:131]
    s_add_u32 m0, s8, 24576
    ds_read_b64_tr_b16 v[240:241], v213 offset:28672
    v_mfma_f32_16x16x32_bf16 v[136:139], v[224:227], a[68:71], v[136:139]
    s_add_u32 s18, s18, 114688
    ds_read_b64_tr_b16 v[242:243], v213 offset:29184
    v_mfma_f32_16x16x32_bf16 v[144:147], v[224:227], a[72:75], v[144:147]
    s_cmp_ge_u32 s18, 1835008
    s_cselect_b32 s18, s19, s18
    ds_read_b64_tr_b16 v[244:245], v214 offset:28672
    v_mfma_f32_16x16x32_bf16 v[152:155], v[224:227], a[76:79], v[152:155]
    buffer_load_dwordx4 v200, s[52:55], s18 offen offset:0 lds
    v_mfma_f32_16x16x32_bf16 v[132:135], v[228:231], a[64:67], v[132:135]
    s_add_u32 s28, s28, 64
    ds_read_b64_tr_b16 v[246:247], v214 offset:29184
    v_mfma_f32_16x16x32_bf16 v[140:143], v[228:231], a[68:71], v[140:143]
    s_and_b32 s28, s28, 0x3ff
    ds_read_b64_tr_b16 v[248:249], v213 offset:28928
    v_add_u32 v110, s28, v194
    v_mfma_f32_16x16x32_bf16 v[148:151], v[228:231], a[72:75], v[148:151]
    ds_read_b64_tr_b16 v[250:251], v213 offset:29440
    v_add_u32 v111, s28, v195
    v_mfma_f32_16x16x32_bf16 v[156:159], v[228:231], a[76:79], v[156:159]
    buffer_load_dwordx4 v201, s[52:55], s18 offen offset:1024 lds
    v_mfma_f32_16x16x32_bf16 v[160:163], v[232:235], a[64:67], v[160:163]
    ds_read_b64_tr_b16 v[252:253], v214 offset:28928
    v_mfma_f32_16x16x32_bf16 v[168:171], v[232:235], a[68:71], v[168:171]
    ds_read_b64_tr_b16 v[254:255], v214 offset:29440
    v_mfma_f32_16x16x32_bf16 v[176:179], v[232:235], a[72:75], v[176:179]
    ds_read_b128 a[96:99], v110 offset:0
    v_mfma_f32_16x16x32_bf16 v[184:187], v[232:235], a[76:79], v[184:187]
    buffer_load_dwordx4 v202, s[52:55], s18 offen offset:2048 lds
    v_mfma_f32_16x16x32_bf16 v[164:167], v[236:239], a[64:67], v[164:167]
    ds_read_b128 a[100:103], v110 offset:40960
    v_mfma_f32_16x16x32_bf16 v[172:175], v[236:239], a[68:71], v[172:175]
    ds_read_b128 a[104:107], v111 offset:0
    v_mfma_f32_16x16x32_bf16 v[180:183], v[236:239], a[72:75], v[180:183]
    buffer_load_dwordx4 v203, s[52:55], s18 offen offset:3072 lds
    v_mfma_f32_16x16x32_bf16 v[188:191], v[236:239], a[76:79], v[188:191]
    s_waitcnt vmcnt(12) lgkmcnt(3)
    ds_read_b128 a[108:111], v111 offset:40960
    v_mfma_f32_16x16x32_bf16 v[128:131], v[240:243], a[80:83], v[128:131]
    s_add_u32 m0, s8, 28672
    ds_read_b64_tr_b16 v[224:225], v213 offset:32768
    v_mfma_f32_16x16x32_bf16 v[136:139], v[240:243], a[84:87], v[136:139]
    s_add_u32 s18, s18, 114688
    ds_read_b64_tr_b16 v[226:227], v213 offset:33280
    v_mfma_f32_16x16x32_bf16 v[144:147], v[240:243], a[88:91], v[144:147]
    s_cmp_ge_u32 s18, 1835008
    s_cselect_b32 s18, s19, s18
    ds_read_b64_tr_b16 v[228:229], v214 offset:32768
    v_mfma_f32_16x16x32_bf16 v[152:155], v[240:243], a[92:95], v[152:155]
    buffer_load_dwordx4 v200, s[52:55], s18 offen offset:0 lds
    v_mfma_f32_16x16x32_bf16 v[132:135], v[244:247], a[80:83], v[132:135]
    s_add_u32 s28, s28, 64
    ds_read_b64_tr_b16 v[230:231], v214 offset:33280
    v_mfma_f32_16x16x32_bf16 v[140:143], v[244:247], a[84:87], v[140:143]
    s_and_b32 s28, s28, 0x3ff
    ds_read_b64_tr_b16 v[232:233], v213 offset:33024
    v_add_u32 v110, s28, v194
    v_mfma_f32_16x16x32_bf16 v[148:151], v[244:247], a[88:91], v[148:151]
    ds_read_b64_tr_b16 v[234:235], v213 offset:33536
    v_add_u32 v111, s28, v195
    v_mfma_f32_16x16x32_bf16 v[156:159], v[244:247], a[92:95], v[156:159]
    buffer_load_dwordx4 v201, s[52:55], s18 offen offset:1024 lds
    v_mfma_f32_16x16x32_bf16 v[160:163], v[248:251], a[80:83], v[160:163]
    ds_read_b64_tr_b16 v[236:237], v214 offset:33024
    v_mfma_f32_16x16x32_bf16 v[168:171], v[248:251], a[84:87], v[168:171]
    ds_read_b64_tr_b16 v[238:239], v214 offset:33536
    v_mfma_f32_16x16x32_bf16 v[176:179], v[248:251], a[88:91], v[176:179]
    ds_read_b128 a[112:115], v110 offset:0
    v_mfma_f32_16x16x32_bf16 v[184:187], v[248:251], a[92:95], v[184:187]
    buffer_load_dwordx4 v202, s[52:55], s18 offen offset:2048 lds
    v_mfma_f32_16x16x32_bf16 v[164:167], v[252:255], a[80:83], v[164:167]
    ds_read_b128 a[116:119], v110 offset:40960
    v_mfma_f32_16x16x32_bf16 v[172:175], v[252:255], a[84:87], v[172:175]
    ds_read_b128 a[120:123], v111 offset:0
    v_mfma_f32_16x16x32_bf16 v[180:183], v[252:255], a[88:91], v[180:183]
    buffer_load_dwordx4 v203, s[52:55], s18 offen offset:3072 lds
    v_mfma_f32_16x16x32_bf16 v[188:191], v[252:255], a[92:95], v[188:191]
    s_waitcnt vmcnt(12) lgkmcnt(3)
    ds_read_b128 a[124:127], v111 offset:40960
    v_mfma_f32_16x16x32_bf16 v[128:131], v[224:227], a[96:99], v[128:131]
    s_add_u32 m0, s8, 32768
    ds_read_b64_tr_b16 v[240:241], v213 offset:36864
    v_mfma_f32_16x16x32_bf16 v[136:139], v[224:227], a[100:103], v[136:139]
    s_add_u32 s18, s18, 114688
    ds_read_b64_tr_b16 v[242:243], v213 offset:37376
    v_mfma_f32_16x16x32_bf16 v[144:147], v[224:227], a[104:107], v[144:147]
    s_cmp_ge_u32 s18, 1835008
    s_cselect_b32 s18, s19, s18
    ds_read_b64_tr_b16 v[244:245], v214 offset:36864
    v_mfma_f32_16x16x32_bf16 v[152:155], v[224:227], a[108:111], v[152:155]
    buffer_load_dwordx4 v200, s[52:55], s18 offen offset:0 lds
    v_mfma_f32_16x16x32_bf16 v[132:135], v[228:231], a[96:99], v[132:135]
    s_add_u32 s28, s28, 64
    ds_read_b64_tr_b16 v[246:247], v214 offset:37376
    v_mfma_f32_16x16x32_bf16 v[140:143], v[228:231], a[100:103], v[140:143]
    s_and_b32 s28, s28, 0x3ff
    ds_read_b64_tr_b16 v[248:249], v213 offset:37120
    v_add_u32 v110, s28, v194
    v_mfma_f32_16x16x32_bf16 v[148:151], v[228:231], a[104:107], v[148:151]
    ds_read_b64_tr_b16 v[250:251], v213 offset:37632
    v_add_u32 v111, s28, v195
    v_mfma_f32_16x16x32_bf16 v[156:159], v[228:231], a[108:111], v[156:159]
    buffer_load_dwordx4 v201, s[52:55], s18 offen offset:1024 lds
    v_mfma_f32_16x16x32_bf16 v[160:163], v[232:235], a[96:99], v[160:163]
    ds_read_b64_tr_b16 v[252:253], v214 offset:37120
    v_mfma_f32_16x16x32_bf16 v[168:171], v[232:235], a[100:103], v[168:171]
    ds_read_b64_tr_b16 v[254:255], v214 offset:37632
    v_mfma_f32_16x16x32_bf16 v[176:179], v[232:235], a[104:107], v[176:179]
    ds_read_b128 a[128:131], v110 offset:0
    v_mfma_f32_16x16x32_bf16 v[184:187], v[232:235], a[108:111], v[184:187]
    buffer_load_dwordx4 v202, s[52:55], s18 offen offset:2048 lds
    v_mfma_f32_16x16x32_bf16 v[164:167], v[236:239], a[96:99], v[164:167]
    ds_read_b128 a[132:135], v110 offset:40960
    v_mfma_f32_16x16x32_bf16 v[172:175], v[236:239], a[100:103], v[172:175]
    ds_read_b128 a[136:139], v111 offset:0
    v_mfma_f32_16x16x32_bf16 v[180:183], v[236:239], a[104:107], v[180:183]
    buffer_load_dwordx4 v203, s[52:55], s18 offen offset:3072 lds
    v_mfma_f32_16x16x32_bf16 v[188:191], v[236:239], a[108:111], v[188:191]
    s_waitcnt vmcnt(12) lgkmcnt(3)
    ds_read_b128 a[140:143], v111 offset:40960
    v_mfma_f32_16x16x32_bf16 v[128:131], v[240:243], a[112:115], v[128:131]
    s_add_u32 m0, s8, 36864
    ds_read_b64_tr_b16 v[224:225], v213 offset:20480
    v_mfma_f32_16x16x32_bf16 v[136:139], v[240:243], a[116:119], v[136:139]
    s_add_u32 s18, s18, 114688
    ds_read_b64_tr_b16 v[226:227], v213 offset:20992
    v_mfma_f32_16x16x32_bf16 v[144:147], v[240:243], a[120:123], v[144:147]
    s_cmp_ge_u32 s18, 1835008
    s_cselect_b32 s18, s19, s18
    ds_read_b64_tr_b16 v[228:229], v214 offset:20480
    v_mfma_f32_16x16x32_bf16 v[152:155], v[240:243], a[124:127], v[152:155]
    buffer_load_dwordx4 v200, s[52:55], s18 offen offset:0 lds
    v_mfma_f32_16x16x32_bf16 v[132:135], v[244:247], a[112:115], v[132:135]
    s_add_u32 s28, s28, 64
    ds_read_b64_tr_b16 v[230:231], v214 offset:20992
    v_mfma_f32_16x16x32_bf16 v[140:143], v[244:247], a[116:119], v[140:143]
    s_and_b32 s28, s28, 0x3ff
    ds_read_b64_tr_b16 v[232:233], v213 offset:20736
    v_add_u32 v110, s28, v194
    v_mfma_f32_16x16x32_bf16 v[148:151], v[244:247], a[120:123], v[148:151]
    ds_read_b64_tr_b16 v[234:235], v213 offset:21248
    v_add_u32 v111, s28, v195
    v_mfma_f32_16x16x32_bf16 v[156:159], v[244:247], a[124:127], v[156:159]
    buffer_load_dwordx4 v201, s[52:55], s18 offen offset:1024 lds
    v_mfma_f32_16x16x32_bf16 v[160:163], v[248:251], a[112:115], v[160:163]
    ds_read_b64_tr_b16 v[236:237], v214 offset:20736
    v_mfma_f32_16x16x32_bf16 v[168:171], v[248:251], a[116:119], v[168:171]
    ds_read_b64_tr_b16 v[238:239], v214 offset:21248
    v_mfma_f32_16x16x32_bf16 v[176:179], v[248:251], a[120:123], v[176:179]
    ds_read_b128 a[144:147], v110 offset:0
    v_mfma_f32_16x16x32_bf16 v[184:187], v[248:251], a[124:127], v[184:187]
    buffer_load_dwordx4 v202, s[52:55], s18 offen offset:2048 lds
    v_mfma_f32_16x16x32_bf16 v[164:167], v[252:255], a[112:115], v[164:167]
    ds_read_b128 a[148:151], v110 offset:40960
    v_mfma_f32_16x16x32_bf16 v[172:175], v[252:255], a[116:119], v[172:175]
    ds_read_b128 a[152:155], v111 offset:0
    v_mfma_f32_16x16x32_bf16 v[180:183], v[252:255], a[120:123], v[180:183]
    buffer_load_dwordx4 v203, s[52:55], s18 offen offset:3072 lds
    v_mfma_f32_16x16x32_bf16 v[188:191], v[252:255], a[124:127], v[188:191]
    s_waitcnt vmcnt(12) lgkmcnt(3)
    ds_read_b128 a[156:159], v111 offset:40960
    v_mfma_f32_16x16x32_bf16 v[128:131], v[224:227], a[128:131], v[128:131]
    s_add_u32 m0, s8, 20480
    ds_read_b64_tr_b16 v[240:241], v213 offset:24576
    v_mfma_f32_16x16x32_bf16 v[136:139], v[224:227], a[132:135], v[136:139]
    s_add_u32 s18, s18, 114688
    ds_read_b64_tr_b16 v[242:243], v213 offset:25088
    v_mfma_f32_16x16x32_bf16 v[144:147], v[224:227], a[136:139], v[144:147]
    s_cmp_ge_u32 s18, 1835008
    s_cselect_b32 s18, s19, s18
    ds_read_b64_tr_b16 v[244:245], v214 offset:24576
    v_mfma_f32_16x16x32_bf16 v[152:155], v[224:227], a[140:143], v[152:155]
    buffer_load_dwordx4 v200, s[52:55], s18 offen offset:0 lds
    v_mfma_f32_16x16x32_bf16 v[132:135], v[228:231], a[128:131], v[132:135]
    s_add_u32 s28, s28, 64
    ds_read_b64_tr_b16 v[246:247], v214 offset:25088
    v_mfma_f32_16x16x32_bf16 v[140:143], v[228:231], a[132:135], v[140:143]
    s_and_b32 s28, s28, 0x3ff
    ds_read_b64_tr_b16 v[248:249], v213 offset:24832
    v_add_u32 v110, s28, v194
    v_mfma_f32_16x16x32_bf16 v[148:151], v[228:231], a[136:139], v[148:151]
    ds_read_b64_tr_b16 v[250:251], v213 offset:25344
    v_add_u32 v111, s28, v195
    v_mfma_f32_16x16x32_bf16 v[156:159], v[228:231], a[140:143], v[156:159]
    buffer_load_dwordx4 v201, s[52:55], s18 offen offset:1024 lds
    v_mfma_f32_16x16x32_bf16 v[160:163], v[232:235], a[128:131], v[160:163]
    ds_read_b64_tr_b16 v[252:253], v214 offset:24832
    v_mfma_f32_16x16x32_bf16 v[168:171], v[232:235], a[132:135], v[168:171]
    ds_read_b64_tr_b16 v[254:255], v214 offset:25344
    v_mfma_f32_16x16x32_bf16 v[176:179], v[232:235], a[136:139], v[176:179]
    ds_read_b128 a[160:163], v110 offset:0
    v_mfma_f32_16x16x32_bf16 v[184:187], v[232:235], a[140:143], v[184:187]
    buffer_load_dwordx4 v202, s[52:55], s18 offen offset:2048 lds
    v_mfma_f32_16x16x32_bf16 v[164:167], v[236:239], a[128:131], v[164:167]
    ds_read_b128 a[164:167], v110 offset:40960
    v_mfma_f32_16x16x32_bf16 v[172:175], v[236:239], a[132:135], v[172:175]
    ds_read_b128 a[168:171], v111 offset:0
    v_mfma_f32_16x16x32_bf16 v[180:183], v[236:239], a[136:139], v[180:183]
    buffer_load_dwordx4 v203, s[52:55], s18 offen offset:3072 lds
    v_mfma_f32_16x16x32_bf16 v[188:191], v[236:239], a[140:143], v[188:191]
    s_waitcnt vmcnt(12) lgkmcnt(3)
    ds_read_b128 a[172:175], v111 offset:40960
    v_mfma_f32_16x16x32_bf16 v[128:131], v[240:243], a[144:147], v[128:131]
    s_add_u32 m0, s8, 24576
    ds_read_b64_tr_b16 v[224:225], v213 offset:28672
    v_mfma_f32_16x16x32_bf16 v[136:139], v[240:243], a[148:151], v[136:139]
    s_add_u32 s18, s18, 114688
    ds_read_b64_tr_b16 v[226:227], v213 offset:29184
    v_mfma_f32_16x16x32_bf16 v[144:147], v[240:243], a[152:155], v[144:147]
    s_cmp_ge_u32 s18, 1835008
    s_cselect_b32 s18, s19, s18
    ds_read_b64_tr_b16 v[228:229], v214 offset:28672
    v_mfma_f32_16x16x32_bf16 v[152:155], v[240:243], a[156:159], v[152:155]
    buffer_load_dwordx4 v200, s[52:55], s18 offen offset:0 lds
    v_mfma_f32_16x16x32_bf16 v[132:135], v[244:247], a[144:147], v[132:135]
    s_add_u32 s28, s28, 64
    ds_read_b64_tr_b16 v[230:231], v214 offset:29184
    v_mfma_f32_16x16x32_bf16 v[140:143], v[244:247], a[148:151], v[140:143]
    s_and_b32 s28, s28, 0x3ff
    ds_read_b64_tr_b16 v[232:233], v213 offset:28928
    v_add_u32 v110, s28, v194
    v_mfma_f32_16x16x32_bf16 v[148:151], v[244:247], a[152:155], v[148:151]
    ds_read_b64_tr_b16 v[234:235], v213 offset:29440
    v_add_u32 v111, s28, v195
    v_mfma_f32_16x16x32_bf16 v[156:159], v[244:247], a[156:159], v[156:159]
    buffer_load_dwordx4 v201, s[52:55], s18 offen offset:1024 lds
    v_mfma_f32_16x16x32_bf16 v[160:163], v[248:251], a[144:147], v[160:163]
    ds_read_b64_tr_b16 v[236:237], v214 offset:28928
    v_mfma_f32_16x16x32_bf16 v[168:171], v[248:251], a[148:151], v[168:171]
    ds_read_b64_tr_b16 v[238:239], v214 offset:29440
    v_mfma_f32_16x16x32_bf16 v[176:179], v[248:251], a[152:155], v[176:179]
    ds_read_b128 a[176:179], v110 offset:0
    v_mfma_f32_16x16x32_bf16 v[184:187], v[248:251], a[156:159], v[184:187]
    buffer_load_dwordx4 v202, s[52:55], s18 offen offset:2048 lds
    v_mfma_f32_16x16x32_bf16 v[164:167], v[252:255], a[144:147], v[164:167]
    ds_read_b128 a[180:183], v110 offset:40960
    v_mfma_f32_16x16x32_bf16 v[172:175], v[252:255], a[148:151], v[172:175]
    ds_read_b128 a[184:187], v111 offset:0
    v_mfma_f32_16x16x32_bf16 v[180:183], v[252:255], a[152:155], v[180:183]
    buffer_load_dwordx4 v203, s[52:55], s18 offen offset:3072 lds
    v_mfma_f32_16x16x32_bf16 v[188:191], v[252:255], a[156:159], v[188:191]
    s_waitcnt vmcnt(12) lgkmcnt(3)
    ds_read_b128 a[188:191], v111 offset:40960
    v_mfma_f32_16x16x32_bf16 v[128:131], v[224:227], a[160:163], v[128:131]
    s_add_u32 m0, s8, 28672
    ds_read_b64_tr_b16 v[240:241], v213 offset:32768
    v_mfma_f32_16x16x32_bf16 v[136:139], v[224:227], a[164:167], v[136:139]
    s_add_u32 s18, s18, 114688
    ds_read_b64_tr_b16 v[242:243], v213 offset:33280
    v_mfma_f32_16x16x32_bf16 v[144:147], v[224:227], a[168:171], v[144:147]
    s_cmp_ge_u32 s18, 1835008
    s_cselect_b32 s18, s19, s18
    ds_read_b64_tr_b16 v[244:245], v214 offset:32768
    v_mfma_f32_16x16x32_bf16 v[152:155], v[224:227], a[172:175], v[152:155]
    buffer_load_dwordx4 v200, s[52:55], s18 offen offset:0 lds
    v_mfma_f32_16x16x32_bf16 v[132:135], v[228:231], a[160:163], v[132:135]
    s_add_u32 s28, s28, 64
    ds_read_b64_tr_b16 v[246:247], v214 offset:33280
    v_mfma_f32_16x16x32_bf16 v[140:143], v[228:231], a[164:167], v[140:143]
    s_and_b32 s28, s28, 0x3ff
    ds_read_b64_tr_b16 v[248:249], v213 offset:33024
    v_add_u32 v110, s28, v194
    v_mfma_f32_16x16x32_bf16 v[148:151], v[228:231], a[168:171], v[148:151]
    ds_read_b64_tr_b16 v[250:251], v213 offset:33536
    v_add_u32 v111, s28, v195
    v_mfma_f32_16x16x32_bf16 v[156:159], v[228:231], a[172:175], v[156:159]
    buffer_load_dwordx4 v201, s[52:55], s18 offen offset:1024 lds
    v_mfma_f32_16x16x32_bf16 v[160:163], v[232:235], a[160:163], v[160:163]
    ds_read_b64_tr_b16 v[252:253], v214 offset:33024
    v_mfma_f32_16x16x32_bf16 v[168:171], v[232:235], a[164:167], v[168:171]
    ds_read_b64_tr_b16 v[254:255], v214 offset:33536
    v_mfma_f32_16x16x32_bf16 v[176:179], v[232:235], a[168:171], v[176:179]
    ds_read_b128 a[192:195], v110 offset:0
    v_mfma_f32_16x16x32_bf16 v[184:187], v[232:235], a[172:175], v[184:187]
    buffer_load_dwordx4 v202, s[52:55], s18 offen offset:2048 lds
    v_mfma_f32_16x16x32_bf16 v[164:167], v[236:239], a[160:163], v[164:167]
    ds_read_b128 a[196:199], v110 offset:40960
    v_mfma_f32_16x16x32_bf16 v[172:175], v[236:239], a[164:167], v[172:175]
    ds_read_b128 a[200:203], v111 offset:0
    v_mfma_f32_16x16x32_bf16 v[180:183], v[236:239], a[168:171], v[180:183]
    buffer_load_dwordx4 v203, s[52:55], s18 offen offset:3072 lds
    v_mfma_f32_16x16x32_bf16 v[188:191], v[236:239], a[172:175], v[188:191]
    s_waitcnt vmcnt(12) lgkmcnt(3)
    ds_read_b128 a[204:207], v111 offset:40960
    v_mfma_f32_16x16x32_bf16 v[128:131], v[240:243], a[176:179], v[128:131]
    s_add_u32 m0, s8, 32768
    ds_read_b64_tr_b16 v[224:225], v213 offset:36864
    v_mfma_f32_16x16x32_bf16 v[136:139], v[240:243], a[180:183], v[136:139]
    s_mov_b32 s18, s95
    ds_read_b64_tr_b16 v[226:227], v213 offset:37376
    v_mfma_f32_16x16x32_bf16 v[144:147], v[240:243], a[184:187], v[144:147]
    s_lshl_b32 s89, s5, 7
    ds_read_b64_tr_b16 v[228:229], v214 offset:36864
    v_mfma_f32_16x16x32_bf16 v[152:155], v[240:243], a[188:191], v[152:155]
    buffer_load_dwordx4 v196, s[48:51], s18 offen offset:0 lds
    v_mfma_f32_16x16x32_bf16 v[132:135], v[244:247], a[176:179], v[132:135]
    s_add_u32 s28, s28, 64
    ds_read_b64_tr_b16 v[230:231], v214 offset:37376
    v_mfma_f32_16x16x32_bf16 v[140:143], v[244:247], a[180:183], v[140:143]
    s_and_b32 s28, s28, 0x3ff
    ds_read_b64_tr_b16 v[232:233], v213 offset:37120
    v_add_u32 v110, s28, v194
    v_mfma_f32_16x16x32_bf16 v[148:151], v[244:247], a[184:187], v[148:151]
    s_lshl_b32 s9, s3, 20
    ds_read_b64_tr_b16 v[234:235], v213 offset:37632
    v_add_u32 v111, s28, v195
    v_mfma_f32_16x16x32_bf16 v[156:159], v[244:247], a[188:191], v[156:159]
    buffer_load_dwordx4 v197, s[48:51], s18 offen offset:1024 lds
    v_mfma_f32_16x16x32_bf16 v[160:163], v[248:251], a[176:179], v[160:163]
    s_add_u32 s9, s9, s89
    ds_read_b64_tr_b16 v[236:237], v214 offset:37120
    v_mfma_f32_16x16x32_bf16 v[168:171], v[248:251], a[180:183], v[168:171]
    ds_read_b64_tr_b16 v[238:239], v214 offset:37632
    v_mfma_f32_16x16x32_bf16 v[176:179], v[248:251], a[184:187], v[176:179]
    ds_read_b128 a[208:211], v110 offset:0
    v_lshrrev_b32 v203, 3, v192
    v_mfma_f32_16x16x32_bf16 v[184:187], v[248:251], a[188:191], v[184:187]
    buffer_load_dwordx4 v198, s[48:51], s18 offen offset:2048 lds
    v_mfma_f32_16x16x32_bf16 v[164:167], v[252:255], a[176:179], v[164:167]
    ds_read_b128 a[212:215], v110 offset:40960
    v_mfma_f32_16x16x32_bf16 v[172:175], v[252:255], a[180:183], v[172:175]
    ds_read_b128 a[216:219], v111 offset:0
    buffer_load_ushort v203, v203, s[84:87], s9 offen
    v_mfma_f32_16x16x32_bf16 v[180:183], v[252:255], a[184:187], v[180:183]
    buffer_load_dwordx4 v199, s[48:51], s18 offen offset:3072 lds
    v_mfma_f32_16x16x32_bf16 v[188:191], v[252:255], a[188:191], v[188:191]
    s_waitcnt vmcnt(13) lgkmcnt(3)
    ds_read_b128 a[220:223], v111 offset:40960
    v_mfma_f32_16x16x32_bf16 v[128:131], v[224:227], a[192:195], v[128:131]
    s_add_u32 m0, s8, 36864
    ds_read_b64_tr_b16 v[240:241], v213 offset:20480
    v_mfma_f32_16x16x32_bf16 v[136:139], v[224:227], a[196:199], v[136:139]
    s_add_u32 s18, s18, 262144
    ds_read_b64_tr_b16 v[242:243], v213 offset:20992
    v_mfma_f32_16x16x32_bf16 v[144:147], v[224:227], a[200:203], v[144:147]
    s_and_b32 s18, s18, 0x3fffff
    ds_read_b64_tr_b16 v[244:245], v214 offset:20480
    v_mfma_f32_16x16x32_bf16 v[152:155], v[224:227], a[204:207], v[152:155]
    buffer_load_dwordx4 v196, s[48:51], s18 offen offset:0 lds
    v_mfma_f32_16x16x32_bf16 v[132:135], v[228:231], a[192:195], v[132:135]
    s_add_u32 s28, s28, 64
    ds_read_b64_tr_b16 v[246:247], v214 offset:20992
    v_mfma_f32_16x16x32_bf16 v[140:143], v[228:231], a[196:199], v[140:143]
    s_and_b32 s28, s28, 0x3ff
    ds_read_b64_tr_b16 v[248:249], v213 offset:20736
    v_add_u32 v110, s28, v194
    v_mfma_f32_16x16x32_bf16 v[148:151], v[228:231], a[200:203], v[148:151]
    ds_read_b64_tr_b16 v[250:251], v213 offset:21248
    v_add_u32 v111, s28, v195
    v_mfma_f32_16x16x32_bf16 v[156:159], v[228:231], a[204:207], v[156:159]
    buffer_load_dwordx4 v197, s[48:51], s18 offen offset:1024 lds
    v_mfma_f32_16x16x32_bf16 v[160:163], v[232:235], a[192:195], v[160:163]
    ds_read_b64_tr_b16 v[252:253], v214 offset:20736
    v_mfma_f32_16x16x32_bf16 v[168:171], v[232:235], a[196:199], v[168:171]
    ds_read_b64_tr_b16 v[254:255], v214 offset:21248
    v_mfma_f32_16x16x32_bf16 v[176:179], v[232:235], a[200:203], v[176:179]
    ds_read_b128 a[224:227], v110 offset:0
    v_mfma_f32_16x16x32_bf16 v[184:187], v[232:235], a[204:207], v[184:187]
    buffer_load_dwordx4 v198, s[48:51], s18 offen offset:2048 lds
    v_mfma_f32_16x16x32_bf16 v[164:167], v[236:239], a[192:195], v[164:167]
    ds_read_b128 a[228:231], v110 offset:40960
    v_mfma_f32_16x16x32_bf16 v[172:175], v[236:239], a[196:199], v[172:175]
    ds_read_b128 a[232:235], v111 offset:0
    v_mfma_f32_16x16x32_bf16 v[180:183], v[236:239], a[200:203], v[180:183]
    buffer_load_dwordx4 v199, s[48:51], s18 offen offset:3072 lds
    v_mfma_f32_16x16x32_bf16 v[188:191], v[236:239], a[204:207], v[188:191]
    s_waitcnt vmcnt(13) lgkmcnt(3)
    ds_read_b128 a[236:239], v111 offset:40960
    v_mfma_f32_16x16x32_bf16 v[128:131], v[240:243], a[208:211], v[128:131]
    s_add_u32 m0, s8, 20480
    ds_read_b64_tr_b16 v[224:225], v213 offset:24576
    v_mfma_f32_16x16x32_bf16 v[136:139], v[240:243], a[212:215], v[136:139]
    s_add_u32 s18, s18, 262144
    ds_read_b64_tr_b16 v[226:227], v213 offset:25088
    v_mfma_f32_16x16x32_bf16 v[144:147], v[240:243], a[216:219], v[144:147]
    s_and_b32 s18, s18, 0x3fffff
    ds_read_b64_tr_b16 v[228:229], v214 offset:24576
    v_mfma_f32_16x16x32_bf16 v[152:155], v[240:243], a[220:223], v[152:155]
    buffer_load_dwordx4 v196, s[48:51], s18 offen offset:0 lds
    v_mfma_f32_16x16x32_bf16 v[132:135], v[244:247], a[208:211], v[132:135]
    s_add_u32 s28, s28, 64
    ds_read_b64_tr_b16 v[230:231], v214 offset:25088
    v_mfma_f32_16x16x32_bf16 v[140:143], v[244:247], a[212:215], v[140:143]
    s_and_b32 s28, s28, 0x3ff
    ds_read_b64_tr_b16 v[232:233], v213 offset:24832
    v_add_u32 v110, s28, v194
    v_mfma_f32_16x16x32_bf16 v[148:151], v[244:247], a[216:219], v[148:151]
    ds_read_b64_tr_b16 v[234:235], v213 offset:25344
    v_add_u32 v111, s28, v195
    v_mfma_f32_16x16x32_bf16 v[156:159], v[244:247], a[220:223], v[156:159]
    buffer_load_dwordx4 v197, s[48:51], s18 offen offset:1024 lds
    v_mfma_f32_16x16x32_bf16 v[160:163], v[248:251], a[208:211], v[160:163]
    ds_read_b64_tr_b16 v[236:237], v214 offset:24832
    v_mfma_f32_16x16x32_bf16 v[168:171], v[248:251], a[212:215], v[168:171]
    ds_read_b64_tr_b16 v[238:239], v214 offset:25344
    v_mfma_f32_16x16x32_bf16 v[176:179], v[248:251], a[216:219], v[176:179]
    ds_read_b128 a[240:243], v110 offset:0
    v_mfma_f32_16x16x32_bf16 v[184:187], v[248:251], a[220:223], v[184:187]
    buffer_load_dwordx4 v198, s[48:51], s18 offen offset:2048 lds
    v_mfma_f32_16x16x32_bf16 v[164:167], v[252:255], a[208:211], v[164:167]
    ds_read_b128 a[244:247], v110 offset:40960
    v_mfma_f32_16x16x32_bf16 v[172:175], v[252:255], a[212:215], v[172:175]
    ds_read_b128 a[248:251], v111 offset:0
    v_mfma_f32_16x16x32_bf16 v[180:183], v[252:255], a[216:219], v[180:183]
    buffer_load_dwordx4 v199, s[48:51], s18 offen offset:3072 lds
    v_mfma_f32_16x16x32_bf16 v[188:191], v[252:255], a[220:223], v[188:191]
    s_waitcnt vmcnt(13) lgkmcnt(3)
    ds_read_b128 a[252:255], v111 offset:40960
    v_mfma_f32_16x16x32_bf16 v[128:131], v[224:227], a[224:227], v[128:131]
    s_add_u32 m0, s8, 24576
    ds_read_b64_tr_b16 v[240:241], v213 offset:28672
    v_mfma_f32_16x16x32_bf16 v[136:139], v[224:227], a[228:231], v[136:139]
    s_add_u32 s18, s18, 262144
    ds_read_b64_tr_b16 v[242:243], v213 offset:29184
    v_mfma_f32_16x16x32_bf16 v[144:147], v[224:227], a[232:235], v[144:147]
    s_and_b32 s18, s18, 0x3fffff
    ds_read_b64_tr_b16 v[244:245], v214 offset:28672
    v_mfma_f32_16x16x32_bf16 v[152:155], v[224:227], a[236:239], v[152:155]
    buffer_load_dwordx4 v196, s[48:51], s18 offen offset:0 lds
    v_mfma_f32_16x16x32_bf16 v[132:135], v[228:231], a[224:227], v[132:135]
    ds_read_b64_tr_b16 v[246:247], v214 offset:29184
    v_mfma_f32_16x16x32_bf16 v[140:143], v[228:231], a[228:231], v[140:143]
    ds_read_b64_tr_b16 v[248:249], v213 offset:28928
    v_mfma_f32_16x16x32_bf16 v[148:151], v[228:231], a[232:235], v[148:151]
    ds_read_b64_tr_b16 v[250:251], v213 offset:29440
    v_mfma_f32_16x16x32_bf16 v[156:159], v[228:231], a[236:239], v[156:159]
    buffer_load_dwordx4 v197, s[48:51], s18 offen offset:1024 lds
    v_mfma_f32_16x16x32_bf16 v[160:163], v[232:235], a[224:227], v[160:163]
    ds_read_b64_tr_b16 v[252:253], v214 offset:28928
    v_mfma_f32_16x16x32_bf16 v[168:171], v[232:235], a[228:231], v[168:171]
    ds_read_b64_tr_b16 v[254:255], v214 offset:29440
    v_mfma_f32_16x16x32_bf16 v[176:179], v[232:235], a[232:235], v[176:179]
    v_mfma_f32_16x16x32_bf16 v[184:187], v[232:235], a[236:239], v[184:187]
    buffer_load_dwordx4 v198, s[48:51], s18 offen offset:2048 lds
    v_mfma_f32_16x16x32_bf16 v[164:167], v[236:239], a[224:227], v[164:167]
    v_mfma_f32_16x16x32_bf16 v[172:175], v[236:239], a[228:231], v[172:175]
    v_mfma_f32_16x16x32_bf16 v[180:183], v[236:239], a[232:235], v[180:183]
    buffer_load_dwordx4 v199, s[48:51], s18 offen offset:3072 lds
    v_mfma_f32_16x16x32_bf16 v[188:191], v[236:239], a[236:239], v[188:191]
    s_waitcnt vmcnt(12) lgkmcnt(0)
    v_mfma_f32_16x16x32_bf16 v[128:131], v[240:243], a[240:243], v[128:131]
    s_add_u32 m0, s8, 28672
    ds_read_b64_tr_b16 v[224:225], v213 offset:32768
    v_mfma_f32_16x16x32_bf16 v[136:139], v[240:243], a[244:247], v[136:139]
    s_add_u32 s18, s18, 262144
    ds_read_b64_tr_b16 v[226:227], v213 offset:33280
    v_mfma_f32_16x16x32_bf16 v[144:147], v[240:243], a[248:251], v[144:147]
    s_and_b32 s18, s18, 0x3fffff
    ds_read_b64_tr_b16 v[228:229], v214 offset:32768
    v_mfma_f32_16x16x32_bf16 v[152:155], v[240:243], a[252:255], v[152:155]
    buffer_load_dwordx4 v196, s[48:51], s18 offen offset:0 lds
    v_mfma_f32_16x16x32_bf16 v[132:135], v[244:247], a[240:243], v[132:135]
    ds_read_b64_tr_b16 v[230:231], v214 offset:33280
    v_mfma_f32_16x16x32_bf16 v[140:143], v[244:247], a[244:247], v[140:143]
    ds_read_b64_tr_b16 v[232:233], v213 offset:33024
    v_mfma_f32_16x16x32_bf16 v[148:151], v[244:247], a[248:251], v[148:151]
    ds_read_b64_tr_b16 v[234:235], v213 offset:33536
    v_mfma_f32_16x16x32_bf16 v[156:159], v[244:247], a[252:255], v[156:159]
    buffer_load_dwordx4 v197, s[48:51], s18 offen offset:1024 lds
    v_mfma_f32_16x16x32_bf16 v[160:163], v[248:251], a[240:243], v[160:163]
    s_waitcnt vmcnt(63)
    ds_read_b64_tr_b16 v[236:237], v214 offset:33024
    v_lshlrev_b32 v90, 16, v112
    v_mfma_f32_16x16x32_bf16 v[168:171], v[248:251], a[244:247], v[168:171]
    ds_read_b64_tr_b16 v[238:239], v214 offset:33536
    v_and_b32 v91, 0xffff0000, v112
    v_mfma_f32_16x16x32_bf16 v[176:179], v[248:251], a[248:251], v[176:179]
    v_lshlrev_b32 v92, 16, v113
    v_and_b32 v93, 0xffff0000, v113
    v_mfma_f32_16x16x32_bf16 v[184:187], v[248:251], a[252:255], v[184:187]
    buffer_load_dwordx4 v198, s[48:51], s18 offen offset:2048 lds
    v_mfma_f32_16x16x32_bf16 v[164:167], v[252:255], a[240:243], v[164:167]
    v_lshlrev_b32 v94, 16, v114
    v_and_b32 v95, 0xffff0000, v114
    v_mfma_f32_16x16x32_bf16 v[172:175], v[252:255], a[244:247], v[172:175]
    v_lshlrev_b32 v96, 16, v115
    v_and_b32 v97, 0xffff0000, v115
    v_mfma_f32_16x16x32_bf16 v[180:183], v[252:255], a[248:251], v[180:183]
    buffer_load_dwordx4 v199, s[48:51], s18 offen offset:3072 lds
    v_mfma_f32_16x16x32_bf16 v[188:191], v[252:255], a[252:255], v[188:191]
    s_waitcnt vmcnt(12) lgkmcnt(0)
    v_lshlrev_b32 v98, 16, v116
    v_and_b32 v99, 0xffff0000, v116
    v_mfma_f32_16x16x32_bf16 v[0:3], v[224:227], a[0:3], 0
    s_add_u32 m0, s8, 32768
    ds_read_b64_tr_b16 v[240:241], v213 offset:36864
    v_lshlrev_b32 v100, 16, v117
    v_mfma_f32_16x16x32_bf16 v[8:11], v[224:227], a[4:7], 0
    s_add_u32 s18, s18, 262144
    ds_read_b64_tr_b16 v[242:243], v213 offset:37376
    v_and_b32 v101, 0xffff0000, v117
    v_mfma_f32_16x16x32_bf16 v[16:19], v[224:227], a[8:11], 0
    s_and_b32 s18, s18, 0x3fffff
    ds_read_b64_tr_b16 v[244:245], v214 offset:36864
    v_lshlrev_b32 v102, 16, v118
    v_mfma_f32_16x16x32_bf16 v[24:27], v[224:227], a[12:15], 0
    buffer_load_dwordx4 v196, s[48:51], s18 offen offset:0 lds
    v_mfma_f32_16x16x32_bf16 v[4:7], v[228:231], a[0:3], 0
    ds_read_b64_tr_b16 v[246:247], v214 offset:37376
    v_and_b32 v103, 0xffff0000, v118
    v_mfma_f32_16x16x32_bf16 v[12:15], v[228:231], a[4:7], 0
    ds_read_b64_tr_b16 v[248:249], v213 offset:37120
    v_lshlrev_b32 v104, 16, v119
    v_mfma_f32_16x16x32_bf16 v[20:23], v[228:231], a[8:11], 0
    ds_read_b64_tr_b16 v[250:251], v213 offset:37632
    v_and_b32 v105, 0xffff0000, v119
    v_mfma_f32_16x16x32_bf16 v[28:31], v[228:231], a[12:15], 0
    buffer_load_dwordx4 v197, s[48:51], s18 offen offset:1024 lds
    v_mfma_f32_16x16x32_bf16 v[32:35], v[232:235], a[0:3], 0
    ds_read_b64_tr_b16 v[252:253], v214 offset:37120
    v_fma_f32 v160, v160, v218, v98
    v_mfma_f32_16x16x32_bf16 v[40:43], v[232:235], a[4:7], 0
    ds_read_b64_tr_b16 v[254:255], v214 offset:37632
    v_fma_f32 v161, v161, v218, v99
    v_mfma_f32_16x16x32_bf16 v[48:51], v[232:235], a[8:11], 0
    v_fma_f32 v162, v162, v218, v100
    v_fma_f32 v163, v163, v218, v101
    v_mfma_f32_16x16x32_bf16 v[56:59], v[232:235], a[12:15], 0
    buffer_load_dwordx4 v198, s[48:51], s18 offen offset:2048 lds
    v_mfma_f32_16x16x32_bf16 v[36:39], v[236:239], a[0:3], 0
    v_fma_f32 v164, v164, v218, v102
    v_fma_f32 v165, v165, v218, v103
    v_mfma_f32_16x16x32_bf16 v[44:47], v[236:239], a[4:7], 0
    v_fma_f32 v166, v166, v218, v104
    v_fma_f32 v167, v167, v218, v105
    v_mfma_f32_16x16x32_bf16 v[52:55], v[236:239], a[8:11], 0
    buffer_load_dwordx4 v199, s[48:51], s18 offen offset:3072 lds
    v_mfma_f32_16x16x32_bf16 v[60:63], v[236:239], a[12:15], 0
    s_waitcnt vmcnt(12) lgkmcnt(0)
    v_fma_f32 v168, v168, v219, v98
    v_fma_f32 v169, v169, v219, v99
    v_mfma_f32_16x16x32_bf16 v[0:3], v[240:243], a[16:19], v[0:3]
    s_add_u32 m0, s8, 36864
    ds_read_b64_tr_b16 v[224:225], v213 offset:20480
    v_fma_f32 v170, v170, v219, v100
    v_mfma_f32_16x16x32_bf16 v[8:11], v[240:243], a[20:23], v[8:11]
    s_add_u32 s18, s18, 262144
    ds_read_b64_tr_b16 v[226:227], v213 offset:20992
    v_fma_f32 v171, v171, v219, v101
    v_mfma_f32_16x16x32_bf16 v[16:19], v[240:243], a[24:27], v[16:19]
    s_and_b32 s18, s18, 0x3fffff
    ds_read_b64_tr_b16 v[228:229], v214 offset:20480
    v_fma_f32 v172, v172, v219, v102
    v_mfma_f32_16x16x32_bf16 v[24:27], v[240:243], a[28:31], v[24:27]
    buffer_load_dwordx4 v196, s[48:51], s18 offen offset:0 lds
    v_mfma_f32_16x16x32_bf16 v[4:7], v[244:247], a[16:19], v[4:7]
    ds_read_b64_tr_b16 v[230:231], v214 offset:20992
    v_fma_f32 v173, v173, v219, v103
    v_mfma_f32_16x16x32_bf16 v[12:15], v[244:247], a[20:23], v[12:15]
    ds_read_b64_tr_b16 v[232:233], v213 offset:20736
    v_fma_f32 v174, v174, v219, v104
    v_mfma_f32_16x16x32_bf16 v[20:23], v[244:247], a[24:27], v[20:23]
    ds_read_b64_tr_b16 v[234:235], v213 offset:21248
    v_fma_f32 v175, v175, v219, v105
    v_mfma_f32_16x16x32_bf16 v[28:31], v[244:247], a[28:31], v[28:31]
    buffer_load_dwordx4 v197, s[48:51], s18 offen offset:1024 lds
    v_mfma_f32_16x16x32_bf16 v[32:35], v[248:251], a[16:19], v[32:35]
    ds_read_b64_tr_b16 v[236:237], v214 offset:20736
    v_fma_f32 v176, v176, v220, v98
    v_mfma_f32_16x16x32_bf16 v[40:43], v[248:251], a[20:23], v[40:43]
    ds_read_b64_tr_b16 v[238:239], v214 offset:21248
    v_fma_f32 v177, v177, v220, v99
    v_mfma_f32_16x16x32_bf16 v[48:51], v[248:251], a[24:27], v[48:51]
    v_fma_f32 v178, v178, v220, v100
    v_fma_f32 v179, v179, v220, v101
    v_mfma_f32_16x16x32_bf16 v[56:59], v[248:251], a[28:31], v[56:59]
    buffer_load_dwordx4 v198, s[48:51], s18 offen offset:2048 lds
    v_mfma_f32_16x16x32_bf16 v[36:39], v[252:255], a[16:19], v[36:39]
    v_fma_f32 v180, v180, v220, v102
    v_fma_f32 v181, v181, v220, v103
    v_mfma_f32_16x16x32_bf16 v[44:47], v[252:255], a[20:23], v[44:47]
    v_fma_f32 v182, v182, v220, v104
    v_fma_f32 v183, v183, v220, v105
    v_mfma_f32_16x16x32_bf16 v[52:55], v[252:255], a[24:27], v[52:55]
    buffer_load_dwordx4 v199, s[48:51], s18 offen offset:3072 lds
    v_mfma_f32_16x16x32_bf16 v[60:63], v[252:255], a[28:31], v[60:63]
    s_waitcnt vmcnt(12) lgkmcnt(0)
    v_fma_f32 v184, v184, v221, v98
    v_fma_f32 v185, v185, v221, v99
    v_mfma_f32_16x16x32_bf16 v[0:3], v[224:227], a[32:35], v[0:3]
    s_add_u32 m0, s8, 20480
    ds_read_b64_tr_b16 v[240:241], v213 offset:24576
    v_fma_f32 v186, v186, v221, v100
    v_mfma_f32_16x16x32_bf16 v[8:11], v[224:227], a[36:39], v[8:11]
    s_add_u32 s18, s18, 262144
    ds_read_b64_tr_b16 v[242:243], v213 offset:25088
    v_fma_f32 v187, v187, v221, v101
    v_mfma_f32_16x16x32_bf16 v[16:19], v[224:227], a[40:43], v[16:19]
    s_and_b32 s18, s18, 0x3fffff
    ds_read_b64_tr_b16 v[244:245], v214 offset:24576
    v_fma_f32 v188, v188, v221, v102
    v_mfma_f32_16x16x32_bf16 v[24:27], v[224:227], a[44:47], v[24:27]
    buffer_load_dwordx4 v196, s[48:51], s18 offen offset:0 lds
    v_mfma_f32_16x16x32_bf16 v[4:7], v[228:231], a[32:35], v[4:7]
    ds_read_b64_tr_b16 v[246:247], v214 offset:25088
    v_fma_f32 v189, v189, v221, v103
    v_mfma_f32_16x16x32_bf16 v[12:15], v[228:231], a[36:39], v[12:15]
    ds_read_b64_tr_b16 v[248:249], v213 offset:24832
    v_fma_f32 v190, v190, v221, v104
    v_mfma_f32_16x16x32_bf16 v[20:23], v[228:231], a[40:43], v[20:23]
    ds_read_b64_tr_b16 v[250:251], v213 offset:25344
    v_fma_f32 v191, v191, v221, v105
    v_mfma_f32_16x16x32_bf16 v[28:31], v[228:231], a[44:47], v[28:31]
    buffer_load_dwordx4 v197, s[48:51], s18 offen offset:1024 lds
    v_mfma_f32_16x16x32_bf16 v[32:35], v[232:235], a[32:35], v[32:35]
    ds_read_b64_tr_b16 v[252:253], v214 offset:24832
    v_fma_f32 v128, v128, v218, v90
    v_mfma_f32_16x16x32_bf16 v[40:43], v[232:235], a[36:39], v[40:43]
    ds_read_b64_tr_b16 v[254:255], v214 offset:25344
    v_fma_f32 v129, v129, v218, v91
    v_mfma_f32_16x16x32_bf16 v[48:51], v[232:235], a[40:43], v[48:51]
    v_fma_f32 v130, v130, v218, v92
    v_fma_f32 v131, v131, v218, v93
    v_mfma_f32_16x16x32_bf16 v[56:59], v[232:235], a[44:47], v[56:59]
    buffer_load_dwordx4 v198, s[48:51], s18 offen offset:2048 lds
    v_mfma_f32_16x16x32_bf16 v[36:39], v[236:239], a[32:35], v[36:39]
    v_fma_f32 v132, v132, v218, v94
    v_fma_f32 v133, v133, v218, v95
    v_mfma_f32_16x16x32_bf16 v[44:47], v[236:239], a[36:39], v[44:47]
    v_fma_f32 v134, v134, v218, v96
    v_fma_f32 v135, v135, v218, v97
    v_mfma_f32_16x16x32_bf16 v[52:55], v[236:239], a[40:43], v[52:55]
    buffer_load_dwordx4 v199, s[48:51], s18 offen offset:3072 lds
    v_mfma_f32_16x16x32_bf16 v[60:63], v[236:239], a[44:47], v[60:63]
    s_waitcnt vmcnt(12) lgkmcnt(0)
    v_fma_f32 v136, v136, v219, v90
    v_fma_f32 v137, v137, v219, v91
    v_mfma_f32_16x16x32_bf16 v[0:3], v[240:243], a[48:51], v[0:3]
    s_add_u32 m0, s8, 24576
    ds_read_b64_tr_b16 v[224:225], v213 offset:28672
    v_fma_f32 v138, v138, v219, v92
    v_mfma_f32_16x16x32_bf16 v[8:11], v[240:243], a[52:55], v[8:11]
    s_add_u32 s18, s18, 262144
    ds_read_b64_tr_b16 v[226:227], v213 offset:29184
    v_fma_f32 v139, v139, v219, v93
    v_mfma_f32_16x16x32_bf16 v[16:19], v[240:243], a[56:59], v[16:19]
    s_and_b32 s18, s18, 0x3fffff
    ds_read_b64_tr_b16 v[228:229], v214 offset:28672
    v_fma_f32 v140, v140, v219, v94
    v_mfma_f32_16x16x32_bf16 v[24:27], v[240:243], a[60:63], v[24:27]
    buffer_load_dwordx4 v196, s[48:51], s18 offen offset:0 lds
    v_mfma_f32_16x16x32_bf16 v[4:7], v[244:247], a[48:51], v[4:7]
    ds_read_b64_tr_b16 v[230:231], v214 offset:29184
    v_fma_f32 v141, v141, v219, v95
    v_mfma_f32_16x16x32_bf16 v[12:15], v[244:247], a[52:55], v[12:15]
    ds_read_b64_tr_b16 v[232:233], v213 offset:28928
    v_fma_f32 v142, v142, v219, v96
    v_mfma_f32_16x16x32_bf16 v[20:23], v[244:247], a[56:59], v[20:23]
    ds_read_b64_tr_b16 v[234:235], v213 offset:29440
    v_fma_f32 v143, v143, v219, v97
    v_mfma_f32_16x16x32_bf16 v[28:31], v[244:247], a[60:63], v[28:31]
    buffer_load_dwordx4 v197, s[48:51], s18 offen offset:1024 lds
    v_mfma_f32_16x16x32_bf16 v[32:35], v[248:251], a[48:51], v[32:35]
    ds_read_b64_tr_b16 v[236:237], v214 offset:28928
    v_fma_f32 v144, v144, v220, v90
    v_mfma_f32_16x16x32_bf16 v[40:43], v[248:251], a[52:55], v[40:43]
    ds_read_b64_tr_b16 v[238:239], v214 offset:29440
    v_fma_f32 v145, v145, v220, v91
    v_mfma_f32_16x16x32_bf16 v[48:51], v[248:251], a[56:59], v[48:51]
    v_fma_f32 v146, v146, v220, v92
    v_fma_f32 v147, v147, v220, v93
    v_mfma_f32_16x16x32_bf16 v[56:59], v[248:251], a[60:63], v[56:59]
    buffer_load_dwordx4 v198, s[48:51], s18 offen offset:2048 lds
    v_mfma_f32_16x16x32_bf16 v[36:39], v[252:255], a[48:51], v[36:39]
    v_fma_f32 v148, v148, v220, v94
    v_fma_f32 v149, v149, v220, v95
    v_mfma_f32_16x16x32_bf16 v[44:47], v[252:255], a[52:55], v[44:47]
    v_fma_f32 v150, v150, v220, v96
    v_fma_f32 v151, v151, v220, v97
    v_mfma_f32_16x16x32_bf16 v[52:55], v[252:255], a[56:59], v[52:55]
    buffer_load_dwordx4 v199, s[48:51], s18 offen offset:3072 lds
    v_mfma_f32_16x16x32_bf16 v[60:63], v[252:255], a[60:63], v[60:63]
    s_waitcnt vmcnt(12) lgkmcnt(0)
    v_fma_f32 v152, v152, v221, v90
    v_fma_f32 v153, v153, v221, v91
    v_mfma_f32_16x16x32_bf16 v[0:3], v[224:227], a[64:67], v[0:3]
    s_add_u32 m0, s8, 28672
    ds_read_b64_tr_b16 v[240:241], v213 offset:32768
    v_fma_f32 v154, v154, v221, v92
    v_mfma_f32_16x16x32_bf16 v[8:11], v[224:227], a[68:71], v[8:11]
    s_add_u32 s18, s18, 262144
    ds_read_b64_tr_b16 v[242:243], v213 offset:33280
    v_fma_f32 v155, v155, v221, v93
    v_mfma_f32_16x16x32_bf16 v[16:19], v[224:227], a[72:75], v[16:19]
    s_and_b32 s18, s18, 0x3fffff
    ds_read_b64_tr_b16 v[244:245], v214 offset:32768
    v_fma_f32 v156, v156, v221, v94
    v_mfma_f32_16x16x32_bf16 v[24:27], v[224:227], a[76:79], v[24:27]
    buffer_load_dwordx4 v196, s[48:51], s18 offen offset:0 lds
    v_mfma_f32_16x16x32_bf16 v[4:7], v[228:231], a[64:67], v[4:7]
    ds_read_b64_tr_b16 v[246:247], v214 offset:33280
    v_fma_f32 v157, v157, v221, v95
    v_mfma_f32_16x16x32_bf16 v[12:15], v[228:231], a[68:71], v[12:15]
    ds_read_b64_tr_b16 v[248:249], v213 offset:33024
    v_fma_f32 v158, v158, v221, v96
    v_mfma_f32_16x16x32_bf16 v[20:23], v[228:231], a[72:75], v[20:23]
    ds_read_b64_tr_b16 v[250:251], v213 offset:33536
    v_fma_f32 v159, v159, v221, v97
    v_mfma_f32_16x16x32_bf16 v[28:31], v[228:231], a[76:79], v[28:31]
    buffer_load_dwordx4 v197, s[48:51], s18 offen offset:1024 lds
    v_mfma_f32_16x16x32_bf16 v[32:35], v[232:235], a[64:67], v[32:35]
    s_mov_b32 s12, 0x3e0293ee
    ds_read_b64_tr_b16 v[252:253], v214 offset:33024
    v_mul_f32 v218, s12, v218
    v_mfma_f32_16x16x32_bf16 v[40:43], v[232:235], a[68:71], v[40:43]
    ds_read_b64_tr_b16 v[254:255], v214 offset:33536
    v_mul_f32 v219, s12, v219
    v_mfma_f32_16x16x32_bf16 v[48:51], v[232:235], a[72:75], v[48:51]
    v_mul_f32 v220, s12, v220
    v_mul_f32 v221, s12, v221
    v_mfma_f32_16x16x32_bf16 v[56:59], v[232:235], a[76:79], v[56:59]
    buffer_load_dwordx4 v198, s[48:51], s18 offen offset:2048 lds
    v_mfma_f32_16x16x32_bf16 v[36:39], v[236:239], a[64:67], v[36:39]
    v_max_f32 v160, 0, v160
    v_max_f32 v161, 0, v161
    v_mfma_f32_16x16x32_bf16 v[44:47], v[236:239], a[68:71], v[44:47]
    v_max_f32 v162, 0, v162
    v_max_f32 v163, 0, v163
    v_mfma_f32_16x16x32_bf16 v[52:55], v[236:239], a[72:75], v[52:55]
    buffer_load_dwordx4 v199, s[48:51], s18 offen offset:3072 lds
    v_mfma_f32_16x16x32_bf16 v[60:63], v[236:239], a[76:79], v[60:63]
    s_waitcnt vmcnt(12) lgkmcnt(0)
    v_max_f32 v164, 0, v164
    v_max_f32 v165, 0, v165
    v_mfma_f32_16x16x32_bf16 v[0:3], v[240:243], a[80:83], v[0:3]
    s_add_u32 m0, s8, 32768
    ds_read_b64_tr_b16 v[224:225], v213 offset:36864
    v_max_f32 v166, 0, v166
    v_mfma_f32_16x16x32_bf16 v[8:11], v[240:243], a[84:87], v[8:11]
    s_add_u32 s18, s18, 262144
    ds_read_b64_tr_b16 v[226:227], v213 offset:37376
    v_max_f32 v167, 0, v167
    v_mfma_f32_16x16x32_bf16 v[16:19], v[240:243], a[88:91], v[16:19]
    s_and_b32 s18, s18, 0x3fffff
    ds_read_b64_tr_b16 v[228:229], v214 offset:36864
    v_mul_f32 v160, v160, v160
    v_mfma_f32_16x16x32_bf16 v[24:27], v[240:243], a[92:95], v[24:27]
    buffer_load_dwordx4 v196, s[48:51], s18 offen offset:0 lds
    v_mfma_f32_16x16x32_bf16 v[4:7], v[244:247], a[80:83], v[4:7]
    ds_read_b64_tr_b16 v[230:231], v214 offset:37376
    v_mul_f32 v161, v161, v161
    v_mfma_f32_16x16x32_bf16 v[12:15], v[244:247], a[84:87], v[12:15]
    ds_read_b64_tr_b16 v[232:233], v213 offset:37120
    v_mul_f32 v162, v162, v162
    v_mfma_f32_16x16x32_bf16 v[20:23], v[244:247], a[88:91], v[20:23]
    ds_read_b64_tr_b16 v[234:235], v213 offset:37632
    v_mul_f32 v163, v163, v163
    v_mfma_f32_16x16x32_bf16 v[28:31], v[244:247], a[92:95], v[28:31]
    buffer_load_dwordx4 v197, s[48:51], s18 offen offset:1024 lds
    v_mfma_f32_16x16x32_bf16 v[32:35], v[248:251], a[80:83], v[32:35]
    ds_read_b64_tr_b16 v[236:237], v214 offset:37120
    v_mul_f32 v164, v164, v164
    v_mfma_f32_16x16x32_bf16 v[40:43], v[248:251], a[84:87], v[40:43]
    ds_read_b64_tr_b16 v[238:239], v214 offset:37632
    v_mul_f32 v165, v165, v165
    v_mfma_f32_16x16x32_bf16 v[48:51], v[248:251], a[88:91], v[48:51]
    v_mul_f32 v166, v166, v166
    v_mul_f32 v167, v167, v167
    v_mfma_f32_16x16x32_bf16 v[56:59], v[248:251], a[92:95], v[56:59]
    buffer_load_dwordx4 v198, s[48:51], s18 offen offset:2048 lds
    v_mfma_f32_16x16x32_bf16 v[36:39], v[252:255], a[80:83], v[36:39]
    v_cvt_pk_bf16_f32 v160, v160, v161
    v_cvt_pk_bf16_f32 v161, v162, v163
    v_mfma_f32_16x16x32_bf16 v[44:47], v[252:255], a[84:87], v[44:47]
    v_cvt_pk_bf16_f32 v162, v164, v165
    v_cvt_pk_bf16_f32 v163, v166, v167
    v_mfma_f32_16x16x32_bf16 v[52:55], v[252:255], a[88:91], v[52:55]
    buffer_load_dwordx4 v199, s[48:51], s18 offen offset:3072 lds
    v_mfma_f32_16x16x32_bf16 v[60:63], v[252:255], a[92:95], v[60:63]
    s_waitcnt vmcnt(12) lgkmcnt(0)
    v_max_f32 v168, 0, v168
    v_max_f32 v169, 0, v169
    v_mfma_f32_16x16x32_bf16 v[0:3], v[224:227], a[96:99], v[0:3]
    s_add_u32 m0, s8, 36864
    ds_read_b64_tr_b16 v[240:241], v213 offset:20480
    v_max_f32 v170, 0, v170
    v_mfma_f32_16x16x32_bf16 v[8:11], v[224:227], a[100:103], v[8:11]
    s_add_u32 s18, s18, 262144
    ds_read_b64_tr_b16 v[242:243], v213 offset:20992
    v_max_f32 v171, 0, v171
    v_mfma_f32_16x16x32_bf16 v[16:19], v[224:227], a[104:107], v[16:19]
    s_and_b32 s18, s18, 0x3fffff
    ds_read_b64_tr_b16 v[244:245], v214 offset:20480
    v_max_f32 v172, 0, v172
    v_mfma_f32_16x16x32_bf16 v[24:27], v[224:227], a[108:111], v[24:27]
    buffer_load_dwordx4 v196, s[48:51], s18 offen offset:0 lds
    v_mfma_f32_16x16x32_bf16 v[4:7], v[228:231], a[96:99], v[4:7]
    ds_read_b64_tr_b16 v[246:247], v214 offset:20992
    v_max_f32 v173, 0, v173
    v_mfma_f32_16x16x32_bf16 v[12:15], v[228:231], a[100:103], v[12:15]
    ds_read_b64_tr_b16 v[248:249], v213 offset:20736
    v_max_f32 v174, 0, v174
    v_mfma_f32_16x16x32_bf16 v[20:23], v[228:231], a[104:107], v[20:23]
    ds_read_b64_tr_b16 v[250:251], v213 offset:21248
    v_max_f32 v175, 0, v175
    v_mfma_f32_16x16x32_bf16 v[28:31], v[228:231], a[108:111], v[28:31]
    buffer_load_dwordx4 v197, s[48:51], s18 offen offset:1024 lds
    v_mfma_f32_16x16x32_bf16 v[32:35], v[232:235], a[96:99], v[32:35]
    ds_read_b64_tr_b16 v[252:253], v214 offset:20736
    v_mul_f32 v168, v168, v168
    v_mfma_f32_16x16x32_bf16 v[40:43], v[232:235], a[100:103], v[40:43]
    ds_read_b64_tr_b16 v[254:255], v214 offset:21248
    v_mul_f32 v169, v169, v169
    v_mfma_f32_16x16x32_bf16 v[48:51], v[232:235], a[104:107], v[48:51]
    v_mul_f32 v170, v170, v170
    v_mul_f32 v171, v171, v171
    v_mfma_f32_16x16x32_bf16 v[56:59], v[232:235], a[108:111], v[56:59]
    buffer_load_dwordx4 v198, s[48:51], s18 offen offset:2048 lds
    v_mfma_f32_16x16x32_bf16 v[36:39], v[236:239], a[96:99], v[36:39]
    v_mul_f32 v172, v172, v172
    v_mul_f32 v173, v173, v173
    v_mfma_f32_16x16x32_bf16 v[44:47], v[236:239], a[100:103], v[44:47]
    v_mul_f32 v174, v174, v174
    v_mul_f32 v175, v175, v175
    v_mfma_f32_16x16x32_bf16 v[52:55], v[236:239], a[104:107], v[52:55]
    buffer_load_dwordx4 v199, s[48:51], s18 offen offset:3072 lds
    v_mfma_f32_16x16x32_bf16 v[60:63], v[236:239], a[108:111], v[60:63]
    s_waitcnt vmcnt(12) lgkmcnt(0)
    v_cvt_pk_bf16_f32 v168, v168, v169
    v_cvt_pk_bf16_f32 v169, v170, v171
    v_mfma_f32_16x16x32_bf16 v[0:3], v[240:243], a[112:115], v[0:3]
    s_add_u32 m0, s8, 20480
    ds_read_b64_tr_b16 v[224:225], v213 offset:24576
    v_cvt_pk_bf16_f32 v170, v172, v173
    v_mfma_f32_16x16x32_bf16 v[8:11], v[240:243], a[116:119], v[8:11]
    s_add_u32 s18, s18, 262144
    ds_read_b64_tr_b16 v[226:227], v213 offset:25088
    v_cvt_pk_bf16_f32 v171, v174, v175
    v_mfma_f32_16x16x32_bf16 v[16:19], v[240:243], a[120:123], v[16:19]
    s_and_b32 s18, s18, 0x3fffff
    ds_read_b64_tr_b16 v[228:229], v214 offset:24576
    v_max_f32 v176, 0, v176
    v_mfma_f32_16x16x32_bf16 v[24:27], v[240:243], a[124:127], v[24:27]
    buffer_load_dwordx4 v196, s[48:51], s18 offen offset:0 lds
    v_mfma_f32_16x16x32_bf16 v[4:7], v[244:247], a[112:115], v[4:7]
    ds_read_b64_tr_b16 v[230:231], v214 offset:25088
    v_max_f32 v177, 0, v177
    v_mfma_f32_16x16x32_bf16 v[12:15], v[244:247], a[116:119], v[12:15]
    ds_read_b64_tr_b16 v[232:233], v213 offset:24832
    v_max_f32 v178, 0, v178
    v_mfma_f32_16x16x32_bf16 v[20:23], v[244:247], a[120:123], v[20:23]
    ds_read_b64_tr_b16 v[234:235], v213 offset:25344
    v_max_f32 v179, 0, v179
    v_mfma_f32_16x16x32_bf16 v[28:31], v[244:247], a[124:127], v[28:31]
    buffer_load_dwordx4 v197, s[48:51], s18 offen offset:1024 lds
    v_mfma_f32_16x16x32_bf16 v[32:35], v[248:251], a[112:115], v[32:35]
    ds_read_b64_tr_b16 v[236:237], v214 offset:24832
    v_max_f32 v180, 0, v180
    v_mfma_f32_16x16x32_bf16 v[40:43], v[248:251], a[116:119], v[40:43]
    ds_read_b64_tr_b16 v[238:239], v214 offset:25344
    v_max_f32 v181, 0, v181
    v_mfma_f32_16x16x32_bf16 v[48:51], v[248:251], a[120:123], v[48:51]
    v_max_f32 v182, 0, v182
    v_max_f32 v183, 0, v183
    v_mfma_f32_16x16x32_bf16 v[56:59], v[248:251], a[124:127], v[56:59]
    buffer_load_dwordx4 v198, s[48:51], s18 offen offset:2048 lds
    v_mfma_f32_16x16x32_bf16 v[36:39], v[252:255], a[112:115], v[36:39]
    v_mul_f32 v176, v176, v176
    v_mul_f32 v177, v177, v177
    v_mfma_f32_16x16x32_bf16 v[44:47], v[252:255], a[116:119], v[44:47]
    v_mul_f32 v178, v178, v178
    v_mul_f32 v179, v179, v179
    v_mfma_f32_16x16x32_bf16 v[52:55], v[252:255], a[120:123], v[52:55]
    buffer_load_dwordx4 v199, s[48:51], s18 offen offset:3072 lds
    v_mfma_f32_16x16x32_bf16 v[60:63], v[252:255], a[124:127], v[60:63]
    s_waitcnt vmcnt(12) lgkmcnt(0)
    v_mul_f32 v180, v180, v180
    v_mul_f32 v181, v181, v181
    v_mfma_f32_16x16x32_bf16 v[0:3], v[224:227], a[128:131], v[0:3]
    s_add_u32 m0, s8, 24576
    ds_read_b64_tr_b16 v[240:241], v213 offset:28672
    v_mul_f32 v182, v182, v182
    v_mfma_f32_16x16x32_bf16 v[8:11], v[224:227], a[132:135], v[8:11]
    s_add_u32 s18, s18, 262144
    ds_read_b64_tr_b16 v[242:243], v213 offset:29184
    v_mul_f32 v183, v183, v183
    v_mfma_f32_16x16x32_bf16 v[16:19], v[224:227], a[136:139], v[16:19]
    s_and_b32 s18, s18, 0x3fffff
    ds_read_b64_tr_b16 v[244:245], v214 offset:28672
    v_cvt_pk_bf16_f32 v176, v176, v177
    v_mfma_f32_16x16x32_bf16 v[24:27], v[224:227], a[140:143], v[24:27]
    buffer_load_dwordx4 v196, s[48:51], s18 offen offset:0 lds
    v_mfma_f32_16x16x32_bf16 v[4:7], v[228:231], a[128:131], v[4:7]
    s_mul_i32 s19, s4, 229376
    ds_read_b64_tr_b16 v[246:247], v214 offset:29184
    v_cvt_pk_bf16_f32 v177, v178, v179
    v_mfma_f32_16x16x32_bf16 v[12:15], v[228:231], a[132:135], v[12:15]
    s_lshl_b32 s9, s92, 13
    ds_read_b64_tr_b16 v[248:249], v213 offset:28928
    v_cvt_pk_bf16_f32 v178, v180, v181
    v_mfma_f32_16x16x32_bf16 v[20:23], v[228:231], a[136:139], v[20:23]
    s_add_u32 s19, s19, s9
    ds_read_b64_tr_b16 v[250:251], v213 offset:29440
    v_cvt_pk_bf16_f32 v179, v182, v183
    v_mfma_f32_16x16x32_bf16 v[28:31], v[228:231], a[140:143], v[28:31]
    buffer_load_dwordx4 v197, s[48:51], s18 offen offset:1024 lds
    v_mfma_f32_16x16x32_bf16 v[32:35], v[232:235], a[128:131], v[32:35]
    s_add_u32 s19, s19, s93
    ds_read_b64_tr_b16 v[252:253], v214 offset:28928
    v_max_f32 v184, 0, v184
    v_mfma_f32_16x16x32_bf16 v[40:43], v[232:235], a[132:135], v[40:43]
    s_add_u32 s29, s19, 4096
    ds_read_b64_tr_b16 v[254:255], v214 offset:29440
    v_max_f32 v185, 0, v185
    v_mfma_f32_16x16x32_bf16 v[48:51], v[232:235], a[136:139], v[48:51]
    s_add_u32 s21, s8, 20992
    v_max_f32 v186, 0, v186
    v_max_f32 v187, 0, v187
    v_mfma_f32_16x16x32_bf16 v[56:59], v[232:235], a[140:143], v[56:59]
    buffer_load_dwordx4 v198, s[48:51], s18 offen offset:2048 lds
    v_mfma_f32_16x16x32_bf16 v[36:39], v[236:239], a[128:131], v[36:39]
    s_add_u32 s23, s8, 33792
    v_max_f32 v188, 0, v188
    v_max_f32 v189, 0, v189
    v_mfma_f32_16x16x32_bf16 v[44:47], v[236:239], a[132:135], v[44:47]
    s_lshl_b32 s9, s8, 1
    v_max_f32 v190, 0, v190
    v_max_f32 v191, 0, v191
    v_mfma_f32_16x16x32_bf16 v[52:55], v[236:239], a[136:139], v[52:55]
    buffer_load_dwordx4 v199, s[48:51], s18 offen offset:3072 lds
    v_mfma_f32_16x16x32_bf16 v[60:63], v[236:239], a[140:143], v[60:63]
    s_waitcnt vmcnt(12) lgkmcnt(0)
    v_mul_f32 v184, v184, v184
    v_mul_f32 v185, v185, v185
    v_mfma_f32_16x16x32_bf16 v[0:3], v[240:243], a[144:147], v[0:3]
    s_add_u32 m0, s8, 28672
    ds_read_b64_tr_b16 v[224:225], v213 offset:32768
    v_mul_f32 v186, v186, v186
    v_mfma_f32_16x16x32_bf16 v[8:11], v[240:243], a[148:151], v[8:11]
    s_add_u32 s18, s18, 262144
    ds_read_b64_tr_b16 v[226:227], v213 offset:33280
    v_mul_f32 v187, v187, v187
    v_mfma_f32_16x16x32_bf16 v[16:19], v[240:243], a[152:155], v[16:19]
    s_and_b32 s18, s18, 0x3fffff
    ds_read_b64_tr_b16 v[228:229], v214 offset:32768
    v_mul_f32 v188, v188, v188
    v_mfma_f32_16x16x32_bf16 v[24:27], v[240:243], a[156:159], v[24:27]
    buffer_load_dwordx4 v196, s[48:51], s18 offen offset:0 lds
    v_mfma_f32_16x16x32_bf16 v[4:7], v[244:247], a[144:147], v[4:7]
    s_add_u32 s22, s9, 50432
    ds_read_b64_tr_b16 v[230:231], v214 offset:33280
    v_mul_f32 v189, v189, v189
    v_mfma_f32_16x16x32_bf16 v[12:15], v[244:247], a[148:151], v[12:15]
    s_add_u32 s24, s9, 59136
    ds_read_b64_tr_b16 v[232:233], v213 offset:33024
    v_mul_f32 v190, v190, v190
    v_mfma_f32_16x16x32_bf16 v[20:23], v[244:247], a[152:155], v[20:23]
    s_mov_b32 s25, 0xffffdf00
    ds_read_b64_tr_b16 v[234:235], v213 offset:33536
    v_mul_f32 v191, v191, v191
    v_mfma_f32_16x16x32_bf16 v[28:31], v[244:247], a[156:159], v[28:31]
    buffer_load_dwordx4 v197, s[48:51], s18 offen offset:1024 lds
    v_mfma_f32_16x16x32_bf16 v[32:35], v[248:251], a[144:147], v[32:35]
    s_mov_b32 s26, 0x2100
    ds_read_b64_tr_b16 v[236:237], v214 offset:33024
    v_cvt_pk_bf16_f32 v184, v184, v185
    v_mfma_f32_16x16x32_bf16 v[40:43], v[248:251], a[148:151], v[40:43]
    s_mov_b32 s32, 0
    ds_read_b64_tr_b16 v[238:239], v214 offset:33536
    v_cvt_pk_bf16_f32 v185, v186, v187
    v_mfma_f32_16x16x32_bf16 v[48:51], v[248:251], a[152:155], v[48:51]
    s_mul_i32 s41, s3, 458752
    v_cvt_pk_bf16_f32 v186, v188, v189
    v_cvt_pk_bf16_f32 v187, v190, v191
    v_mfma_f32_16x16x32_bf16 v[56:59], v[248:251], a[156:159], v[56:59]
    buffer_load_dwordx4 v198, s[48:51], s18 offen offset:2048 lds
    v_mfma_f32_16x16x32_bf16 v[36:39], v[252:255], a[144:147], v[36:39]
    s_lshl_b32 s9, s5, 7
    v_max_f32 v128, 0, v128
    v_max_f32 v129, 0, v129
    v_mfma_f32_16x16x32_bf16 v[44:47], v[252:255], a[148:151], v[44:47]
    s_add_u32 s41, s41, s9
    v_max_f32 v130, 0, v130
    v_max_f32 v131, 0, v131
    v_mfma_f32_16x16x32_bf16 v[52:55], v[252:255], a[152:155], v[52:55]
    buffer_load_dwordx4 v199, s[48:51], s18 offen offset:3072 lds
    v_mfma_f32_16x16x32_bf16 v[60:63], v[252:255], a[156:159], v[60:63]
    s_waitcnt vmcnt(12) lgkmcnt(0)
    v_max_f32 v132, 0, v132
    v_max_f32 v133, 0, v133
    v_mfma_f32_16x16x32_bf16 v[0:3], v[224:227], a[160:163], v[0:3]
    s_add_u32 m0, s8, 32768
    ds_read_b64_tr_b16 v[240:241], v213 offset:36864
    v_max_f32 v134, 0, v134
    v_mfma_f32_16x16x32_bf16 v[8:11], v[224:227], a[164:167], v[8:11]
    s_add_u32 s18, s18, 262144
    ds_read_b64_tr_b16 v[242:243], v213 offset:37376
    v_max_f32 v135, 0, v135
    v_mfma_f32_16x16x32_bf16 v[16:19], v[224:227], a[168:171], v[16:19]
    s_and_b32 s18, s18, 0x3fffff
    ds_read_b64_tr_b16 v[244:245], v214 offset:36864
    v_mul_f32 v128, v128, v128
    v_mfma_f32_16x16x32_bf16 v[24:27], v[224:227], a[172:175], v[24:27]
    buffer_load_dwordx4 v196, s[48:51], s18 offen offset:0 lds
    v_mfma_f32_16x16x32_bf16 v[4:7], v[228:231], a[160:163], v[4:7]
    s_lshl_b32 s20, s4, 8
    ds_read_b64_tr_b16 v[246:247], v214 offset:37376
    v_mul_f32 v129, v129, v129
    v_mfma_f32_16x16x32_bf16 v[12:15], v[228:231], a[164:167], v[12:15]
    s_lshl_b32 s9, s5, 5
    ds_read_b64_tr_b16 v[248:249], v213 offset:37120
    v_mul_f32 v130, v130, v130
    v_mfma_f32_16x16x32_bf16 v[20:23], v[228:231], a[168:171], v[20:23]
    s_add_u32 s20, s20, s9
    ds_read_b64_tr_b16 v[250:251], v213 offset:37632
    v_mul_f32 v131, v131, v131
    v_mfma_f32_16x16x32_bf16 v[28:31], v[228:231], a[172:175], v[28:31]
    buffer_load_dwordx4 v197, s[48:51], s18 offen offset:1024 lds
    v_mfma_f32_16x16x32_bf16 v[32:35], v[232:235], a[160:163], v[32:35]
    s_lshl_b32 s9, s3, 3
    ds_read_b64_tr_b16 v[252:253], v214 offset:37120
    v_mul_f32 v132, v132, v132
    v_mfma_f32_16x16x32_bf16 v[40:43], v[232:235], a[164:167], v[40:43]
    s_add_u32 s20, s20, s9
    ds_read_b64_tr_b16 v[254:255], v214 offset:37632
    v_mul_f32 v133, v133, v133
    v_mfma_f32_16x16x32_bf16 v[48:51], v[232:235], a[168:171], v[48:51]
    s_add_u32 s20, s20, 0x1810000
    v_mul_f32 v134, v134, v134
    v_mul_f32 v135, v135, v135
    v_mfma_f32_16x16x32_bf16 v[56:59], v[232:235], a[172:175], v[56:59]
    buffer_load_dwordx4 v198, s[48:51], s18 offen offset:2048 lds
    v_mfma_f32_16x16x32_bf16 v[36:39], v[236:239], a[160:163], v[36:39]
    s_lshl_b32 s94, s4, 8
    v_cvt_pk_bf16_f32 v164, v128, v129
    v_cvt_pk_bf16_f32 v165, v130, v131
    v_mfma_f32_16x16x32_bf16 v[44:47], v[236:239], a[164:167], v[44:47]
    s_lshl_b32 s9, s3, 6
    v_cvt_pk_bf16_f32 v166, v132, v133
    v_cvt_pk_bf16_f32 v167, v134, v135
    v_mfma_f32_16x16x32_bf16 v[52:55], v[236:239], a[168:171], v[52:55]
    buffer_load_dwordx4 v199, s[48:51], s18 offen offset:3072 lds
    v_mfma_f32_16x16x32_bf16 v[60:63], v[236:239], a[172:175], v[60:63]
    s_waitcnt vmcnt(12) lgkmcnt(0)
    v_max_f32 v136, 0, v136
    v_max_f32 v137, 0, v137
    v_mfma_f32_16x16x32_bf16 v[0:3], v[240:243], a[176:179], v[0:3]
    s_add_u32 m0, s8, 36864
    ds_read_b64_tr_b16 v[224:225], v213 offset:20480
    v_max_f32 v138, 0, v138
    v_mfma_f32_16x16x32_bf16 v[8:11], v[240:243], a[180:183], v[8:11]
    s_add_u32 s18, s18, 262272
    ds_read_b64_tr_b16 v[226:227], v213 offset:20992
    v_max_f32 v139, 0, v139
    v_mfma_f32_16x16x32_bf16 v[16:19], v[240:243], a[184:187], v[16:19]
    s_and_b32 s18, s18, 0x3fffff
    ds_read_b64_tr_b16 v[228:229], v214 offset:20480
    v_max_f32 v140, 0, v140
    v_mfma_f32_16x16x32_bf16 v[24:27], v[240:243], a[188:191], v[24:27]
    buffer_load_dwordx4 v196, s[48:51], s18 offen offset:0 lds
    v_mfma_f32_16x16x32_bf16 v[4:7], v[244:247], a[176:179], v[4:7]
    s_add_u32 s94, s94, s9
    ds_read_b64_tr_b16 v[230:231], v214 offset:20992
    v_max_f32 v141, 0, v141
    v_mfma_f32_16x16x32_bf16 v[12:15], v[244:247], a[180:183], v[12:15]
    s_add_u32 s94, s94, 0x1810000
    ds_read_b64_tr_b16 v[232:233], v213 offset:20736
    v_max_f32 v142, 0, v142
    v_mfma_f32_16x16x32_bf16 v[20:23], v[244:247], a[184:187], v[20:23]
    s_lshl_b32 s11, s2, 2
    ds_read_b64_tr_b16 v[234:235], v213 offset:21248
    v_max_f32 v143, 0, v143
    v_mfma_f32_16x16x32_bf16 v[28:31], v[244:247], a[188:191], v[28:31]
    buffer_load_dwordx4 v197, s[48:51], s18 offen offset:1024 lds
    v_mfma_f32_16x16x32_bf16 v[32:35], v[248:251], a[176:179], v[32:35]
    s_add_u32 s11, s11, s3
    ds_read_b64_tr_b16 v[236:237], v214 offset:20736
    v_mul_f32 v136, v136, v136
    v_mfma_f32_16x16x32_bf16 v[40:43], v[248:251], a[180:183], v[40:43]
    s_lshl_b32 s11, s11, 11
    ds_read_b64_tr_b16 v[238:239], v214 offset:21248
    v_mul_f32 v137, v137, v137
    v_mfma_f32_16x16x32_bf16 v[48:51], v[248:251], a[184:187], v[48:51]
    s_mul_i32 s95, s4, 229376
    v_mul_f32 v138, v138, v138
    v_mul_f32 v139, v139, v139
    v_mfma_f32_16x16x32_bf16 v[56:59], v[248:251], a[188:191], v[56:59]
    buffer_load_dwordx4 v198, s[48:51], s18 offen offset:2048 lds
    v_mfma_f32_16x16x32_bf16 v[36:39], v[252:255], a[176:179], v[36:39]
    s_mul_i32 s9, s3, 57344
    v_mul_f32 v140, v140, v140
    v_mul_f32 v141, v141, v141
    v_mfma_f32_16x16x32_bf16 v[44:47], v[252:255], a[180:183], v[44:47]
    s_add_u32 s95, s95, s9
    v_mul_f32 v142, v142, v142
    v_mul_f32 v143, v143, v143
    v_mfma_f32_16x16x32_bf16 v[52:55], v[252:255], a[184:187], v[52:55]
    buffer_load_dwordx4 v199, s[48:51], s18 offen offset:3072 lds
    v_mfma_f32_16x16x32_bf16 v[60:63], v[252:255], a[188:191], v[60:63]
    s_waitcnt vmcnt(12) lgkmcnt(0)
    v_cvt_pk_bf16_f32 v172, v136, v137
    v_cvt_pk_bf16_f32 v173, v138, v139
    v_mfma_f32_16x16x32_bf16 v[0:3], v[224:227], a[192:195], v[0:3]
    s_add_u32 m0, s8, 20480
    ds_read_b64_tr_b16 v[240:241], v213 offset:24576
    v_cvt_pk_bf16_f32 v174, v140, v141
    v_mfma_f32_16x16x32_bf16 v[8:11], v[224:227], a[196:199], v[8:11]
    s_add_u32 s18, s18, 262144
    ds_read_b64_tr_b16 v[242:243], v213 offset:25088
    v_cvt_pk_bf16_f32 v175, v142, v143
    v_mfma_f32_16x16x32_bf16 v[16:19], v[224:227], a[200:203], v[16:19]
    s_and_b32 s18, s18, 0x3fffff
    ds_read_b64_tr_b16 v[244:245], v214 offset:24576
    v_max_f32 v144, 0, v144
    v_mfma_f32_16x16x32_bf16 v[24:27], v[224:227], a[204:207], v[24:27]
    buffer_load_dwordx4 v196, s[48:51], s18 offen offset:0 lds
    v_mfma_f32_16x16x32_bf16 v[4:7], v[228:231], a[192:195], v[4:7]
    ds_read_b64_tr_b16 v[246:247], v214 offset:25088
    v_max_f32 v145, 0, v145
    v_mfma_f32_16x16x32_bf16 v[12:15], v[228:231], a[196:199], v[12:15]
    ds_read_b64_tr_b16 v[248:249], v213 offset:24832
    v_max_f32 v146, 0, v146
    v_mfma_f32_16x16x32_bf16 v[20:23], v[228:231], a[200:203], v[20:23]
    ds_read_b64_tr_b16 v[250:251], v213 offset:25344
    v_max_f32 v147, 0, v147
    v_mfma_f32_16x16x32_bf16 v[28:31], v[228:231], a[204:207], v[28:31]
    buffer_load_dwordx4 v197, s[48:51], s18 offen offset:1024 lds
    v_mfma_f32_16x16x32_bf16 v[32:35], v[232:235], a[192:195], v[32:35]
    ds_read_b64_tr_b16 v[252:253], v214 offset:24832
    v_max_f32 v148, 0, v148
    v_mfma_f32_16x16x32_bf16 v[40:43], v[232:235], a[196:199], v[40:43]
    ds_read_b64_tr_b16 v[254:255], v214 offset:25344
    v_max_f32 v149, 0, v149
    v_mfma_f32_16x16x32_bf16 v[48:51], v[232:235], a[200:203], v[48:51]
    v_max_f32 v150, 0, v150
    v_max_f32 v151, 0, v151
    v_mfma_f32_16x16x32_bf16 v[56:59], v[232:235], a[204:207], v[56:59]
    buffer_load_dwordx4 v198, s[48:51], s18 offen offset:2048 lds
    v_mfma_f32_16x16x32_bf16 v[36:39], v[236:239], a[192:195], v[36:39]
    v_mul_f32 v144, v144, v144
    v_mul_f32 v145, v145, v145
    v_mfma_f32_16x16x32_bf16 v[44:47], v[236:239], a[196:199], v[44:47]
    v_mul_f32 v146, v146, v146
    v_mul_f32 v147, v147, v147
    v_mfma_f32_16x16x32_bf16 v[52:55], v[236:239], a[200:203], v[52:55]
    buffer_load_dwordx4 v199, s[48:51], s18 offen offset:3072 lds
    v_mfma_f32_16x16x32_bf16 v[60:63], v[236:239], a[204:207], v[60:63]
    s_waitcnt vmcnt(12) lgkmcnt(0)
    v_mul_f32 v148, v148, v148
    v_mul_f32 v149, v149, v149
    v_mfma_f32_16x16x32_bf16 v[0:3], v[240:243], a[208:211], v[0:3]
    s_add_u32 m0, s8, 24576
    ds_read_b64_tr_b16 v[224:225], v213 offset:28672
    v_mul_f32 v150, v150, v150
    v_mfma_f32_16x16x32_bf16 v[8:11], v[240:243], a[212:215], v[8:11]
    s_add_u32 s18, s18, 262144
    ds_read_b64_tr_b16 v[226:227], v213 offset:29184
    v_mul_f32 v151, v151, v151
    v_mfma_f32_16x16x32_bf16 v[16:19], v[240:243], a[216:219], v[16:19]
    s_and_b32 s18, s18, 0x3fffff
    ds_read_b64_tr_b16 v[228:229], v214 offset:28672
    v_cvt_pk_bf16_f32 v180, v144, v145
    v_mfma_f32_16x16x32_bf16 v[24:27], v[240:243], a[220:223], v[24:27]
    buffer_load_dwordx4 v196, s[48:51], s18 offen offset:0 lds
    v_mfma_f32_16x16x32_bf16 v[4:7], v[244:247], a[208:211], v[4:7]
    ds_read_b64_tr_b16 v[230:231], v214 offset:29184
    v_cvt_pk_bf16_f32 v181, v146, v147
    v_mfma_f32_16x16x32_bf16 v[12:15], v[244:247], a[212:215], v[12:15]
    ds_read_b64_tr_b16 v[232:233], v213 offset:28928
    v_cvt_pk_bf16_f32 v182, v148, v149
    v_mfma_f32_16x16x32_bf16 v[20:23], v[244:247], a[216:219], v[20:23]
    ds_read_b64_tr_b16 v[234:235], v213 offset:29440
    v_cvt_pk_bf16_f32 v183, v150, v151
    v_mfma_f32_16x16x32_bf16 v[28:31], v[244:247], a[220:223], v[28:31]
    buffer_load_dwordx4 v197, s[48:51], s18 offen offset:1024 lds
    v_mfma_f32_16x16x32_bf16 v[32:35], v[248:251], a[208:211], v[32:35]
    ds_read_b64_tr_b16 v[236:237], v214 offset:28928
    v_max_f32 v152, 0, v152
    v_mfma_f32_16x16x32_bf16 v[40:43], v[248:251], a[212:215], v[40:43]
    ds_read_b64_tr_b16 v[238:239], v214 offset:29440
    v_max_f32 v153, 0, v153
    v_mfma_f32_16x16x32_bf16 v[48:51], v[248:251], a[216:219], v[48:51]
    v_max_f32 v154, 0, v154
    v_max_f32 v155, 0, v155
    v_mfma_f32_16x16x32_bf16 v[56:59], v[248:251], a[220:223], v[56:59]
    buffer_load_dwordx4 v198, s[48:51], s18 offen offset:2048 lds
    v_mfma_f32_16x16x32_bf16 v[36:39], v[252:255], a[208:211], v[36:39]
    v_max_f32 v156, 0, v156
    v_max_f32 v157, 0, v157
    v_mfma_f32_16x16x32_bf16 v[44:47], v[252:255], a[212:215], v[44:47]
    v_max_f32 v158, 0, v158
    v_max_f32 v159, 0, v159
    v_mfma_f32_16x16x32_bf16 v[52:55], v[252:255], a[216:219], v[52:55]
    buffer_load_dwordx4 v199, s[48:51], s18 offen offset:3072 lds
    v_mfma_f32_16x16x32_bf16 v[60:63], v[252:255], a[220:223], v[60:63]
    s_waitcnt vmcnt(12) lgkmcnt(0)
    v_mul_f32 v152, v152, v152
    v_mul_f32 v153, v153, v153
    v_mfma_f32_16x16x32_bf16 v[0:3], v[224:227], a[224:227], v[0:3]
    s_add_u32 m0, s8, 28672
    ds_read_b64_tr_b16 v[240:241], v213 offset:32768
    v_mul_f32 v154, v154, v154
    v_mfma_f32_16x16x32_bf16 v[8:11], v[224:227], a[228:231], v[8:11]
    s_add_u32 s18, s18, 262144
    ds_read_b64_tr_b16 v[242:243], v213 offset:33280
    v_mul_f32 v155, v155, v155
    v_mfma_f32_16x16x32_bf16 v[16:19], v[224:227], a[232:235], v[16:19]
    s_and_b32 s18, s18, 0x3fffff
    ds_read_b64_tr_b16 v[244:245], v214 offset:32768
    v_mul_f32 v156, v156, v156
    v_mfma_f32_16x16x32_bf16 v[24:27], v[224:227], a[236:239], v[24:27]
    buffer_load_dwordx4 v196, s[48:51], s18 offen offset:0 lds
    v_mfma_f32_16x16x32_bf16 v[4:7], v[228:231], a[224:227], v[4:7]
    ds_read_b64_tr_b16 v[246:247], v214 offset:33280
    v_mul_f32 v157, v157, v157
    v_mfma_f32_16x16x32_bf16 v[12:15], v[228:231], a[228:231], v[12:15]
    ds_read_b64_tr_b16 v[248:249], v213 offset:33024
    v_mul_f32 v158, v158, v158
    v_mfma_f32_16x16x32_bf16 v[20:23], v[228:231], a[232:235], v[20:23]
    ds_read_b64_tr_b16 v[250:251], v213 offset:33536
    v_mul_f32 v159, v159, v159
    v_mfma_f32_16x16x32_bf16 v[28:31], v[228:231], a[236:239], v[28:31]
    buffer_load_dwordx4 v197, s[48:51], s18 offen offset:1024 lds
    v_mfma_f32_16x16x32_bf16 v[32:35], v[232:235], a[224:227], v[32:35]
    ds_read_b64_tr_b16 v[252:253], v214 offset:33024
    v_cvt_pk_bf16_f32 v188, v152, v153
    v_mfma_f32_16x16x32_bf16 v[40:43], v[232:235], a[228:231], v[40:43]
    ds_read_b64_tr_b16 v[254:255], v214 offset:33536
    v_cvt_pk_bf16_f32 v189, v154, v155
    v_mfma_f32_16x16x32_bf16 v[48:51], v[232:235], a[232:235], v[48:51]
    v_cvt_pk_bf16_f32 v190, v156, v157
    v_cvt_pk_bf16_f32 v191, v158, v159
    v_mfma_f32_16x16x32_bf16 v[56:59], v[232:235], a[236:239], v[56:59]
    buffer_load_dwordx4 v198, s[48:51], s18 offen offset:2048 lds
    v_mfma_f32_16x16x32_bf16 v[36:39], v[236:239], a[224:227], v[36:39]
    v_mov_b32 v200, 0x3f803f80
    v_mov_b32 v201, 0x3f803f80
    v_mfma_f32_16x16x32_bf16 v[44:47], v[236:239], a[228:231], v[44:47]
    v_mov_b32 v202, 0x3f803f80
    v_mfma_f32_16x16x32_bf16 v[52:55], v[236:239], a[232:235], v[52:55]
    buffer_load_dwordx4 v199, s[48:51], s18 offen offset:3072 lds
    v_mfma_f32_16x16x32_bf16 v[60:63], v[236:239], a[236:239], v[60:63]
    s_waitcnt vmcnt(12) lgkmcnt(0)
    v_mfma_f32_16x16x32_bf16 v[0:3], v[240:243], a[240:243], v[0:3]
    s_add_u32 m0, s8, 32768
    ds_read_b64_tr_b16 v[224:225], v213 offset:36864
    v_mfma_f32_16x16x32_bf16 v[8:11], v[240:243], a[244:247], v[8:11]
    s_add_u32 s18, s18, 262144
    ds_read_b64_tr_b16 v[226:227], v213 offset:37376
    v_mfma_f32_16x16x32_bf16 v[16:19], v[240:243], a[248:251], v[16:19]
    s_and_b32 s18, s18, 0x3fffff
    ds_read_b64_tr_b16 v[228:229], v214 offset:36864
    v_mfma_f32_16x16x32_bf16 v[24:27], v[240:243], a[252:255], v[24:27]
    buffer_load_dwordx4 v196, s[48:51], s18 offen offset:0 lds
    v_mfma_f32_16x16x32_bf16 v[4:7], v[244:247], a[240:243], v[4:7]
    ds_read_b64_tr_b16 v[230:231], v214 offset:37376
    v_mfma_f32_16x16x32_bf16 v[12:15], v[244:247], a[244:247], v[12:15]
    ds_read_b64_tr_b16 v[232:233], v213 offset:37120
    v_mfma_f32_16x16x32_bf16 v[20:23], v[244:247], a[248:251], v[20:23]
    ds_read_b64_tr_b16 v[234:235], v213 offset:37632
    v_mfma_f32_16x16x32_bf16 v[28:31], v[244:247], a[252:255], v[28:31]
    buffer_load_dwordx4 v197, s[48:51], s18 offen offset:1024 lds
    v_mfma_f32_16x16x32_bf16 v[32:35], v[248:251], a[240:243], v[32:35]
    ds_read_b64_tr_b16 v[236:237], v214 offset:37120
    v_mfma_f32_16x16x32_bf16 v[40:43], v[248:251], a[244:247], v[40:43]
    ds_read_b64_tr_b16 v[238:239], v214 offset:37632
    v_mfma_f32_16x16x32_bf16 v[48:51], v[248:251], a[248:251], v[48:51]
    v_mfma_f32_16x16x32_bf16 v[56:59], v[248:251], a[252:255], v[56:59]
    buffer_load_dwordx4 v198, s[48:51], s18 offen offset:2048 lds
    v_mfma_f32_16x16x32_bf16 v[36:39], v[252:255], a[240:243], v[36:39]
    v_mfma_f32_16x16x32_bf16 v[44:47], v[252:255], a[244:247], v[44:47]
    v_mfma_f32_16x16x32_bf16 v[52:55], v[252:255], a[248:251], v[52:55]
    buffer_load_dwordx4 v199, s[48:51], s18 offen offset:3072 lds
    v_mfma_f32_16x16x32_bf16 v[60:63], v[252:255], a[252:255], v[60:63]
    s_waitcnt vmcnt(12) lgkmcnt(0)
    v_mfma_f32_16x16x32_bf16 v[64:67], v[224:227], a[0:3], 0
    s_add_u32 m0, s8, 36864
    ds_read_b64_tr_b16 v[240:241], v213 offset:20480
    v_mfma_f32_16x16x32_bf16 v[72:75], v[224:227], a[4:7], 0
    s_add_u32 s18, s18, 262144
    ds_read_b64_tr_b16 v[242:243], v213 offset:20992
    v_mfma_f32_16x16x32_bf16 v[80:83], v[224:227], a[8:11], 0
    s_and_b32 s18, s18, 0x3fffff
    ds_read_b64_tr_b16 v[244:245], v214 offset:20480
    v_mfma_f32_16x16x32_bf16 v[88:91], v[224:227], a[12:15], 0
    buffer_load_dwordx4 v196, s[48:51], s18 offen offset:0 lds
    v_mfma_f32_16x16x32_bf16 v[68:71], v[228:231], a[0:3], 0
    ds_read_b64_tr_b16 v[246:247], v214 offset:20992
    v_mfma_f32_16x16x32_bf16 v[76:79], v[228:231], a[4:7], 0
    ds_read_b64_tr_b16 v[248:249], v213 offset:20736
    v_mfma_f32_16x16x32_bf16 v[84:87], v[228:231], a[8:11], 0
    ds_read_b64_tr_b16 v[250:251], v213 offset:21248
    v_mfma_f32_16x16x32_bf16 v[92:95], v[228:231], a[12:15], 0
    buffer_load_dwordx4 v197, s[48:51], s18 offen offset:1024 lds
    v_mfma_f32_16x16x32_bf16 v[96:99], v[232:235], a[0:3], 0
    ds_read_b64_tr_b16 v[252:253], v214 offset:20736
    v_mul_f32 v0, v0, v218
    v_mfma_f32_16x16x32_bf16 v[104:107], v[232:235], a[4:7], 0
    ds_read_b64_tr_b16 v[254:255], v214 offset:21248
    v_mul_f32 v1, v1, v218
    v_mfma_f32_16x16x32_bf16 v[112:115], v[232:235], a[8:11], 0
    v_mul_f32 v2, v2, v218
    v_mul_f32 v3, v3, v218
    v_mfma_f32_16x16x32_bf16 v[120:123], v[232:235], a[12:15], 0
    buffer_load_dwordx4 v198, s[48:51], s18 offen offset:2048 lds
    v_mfma_f32_16x16x32_bf16 v[100:103], v[236:239], a[0:3], 0
    v_mul_f32 v4, v4, v218
    v_mul_f32 v5, v5, v218
    v_mfma_f32_16x16x32_bf16 v[108:111], v[236:239], a[4:7], 0
    v_mul_f32 v6, v6, v218
    v_mul_f32 v7, v7, v218
    v_mfma_f32_16x16x32_bf16 v[116:119], v[236:239], a[8:11], 0
    buffer_load_dwordx4 v199, s[48:51], s18 offen offset:3072 lds
    v_mfma_f32_16x16x32_bf16 v[124:127], v[236:239], a[12:15], 0
    s_waitcnt vmcnt(12) lgkmcnt(0)
    v_cvt_pk_bf16_f32 v0, v0, v1
    v_cvt_pk_bf16_f32 v1, v2, v3
    v_mfma_f32_16x16x32_bf16 v[64:67], v[240:243], a[16:19], v[64:67]
    s_add_u32 m0, s8, 20480
    ds_read_b64_tr_b16 v[224:225], v213 offset:24576
    v_cvt_pk_bf16_f32 v2, v4, v5
    v_mfma_f32_16x16x32_bf16 v[72:75], v[240:243], a[20:23], v[72:75]
    s_add_u32 s18, s18, 262144
    ds_read_b64_tr_b16 v[226:227], v213 offset:25088
    v_cvt_pk_bf16_f32 v3, v6, v7
    v_mfma_f32_16x16x32_bf16 v[80:83], v[240:243], a[24:27], v[80:83]
    s_and_b32 s18, s18, 0x3fffff
    ds_read_b64_tr_b16 v[228:229], v214 offset:24576
    v_mul_f32 v8, v8, v219
    v_mfma_f32_16x16x32_bf16 v[88:91], v[240:243], a[28:31], v[88:91]
    buffer_load_dwordx4 v196, s[48:51], s18 offen offset:0 lds
    v_mfma_f32_16x16x32_bf16 v[68:71], v[244:247], a[16:19], v[68:71]
    ds_read_b64_tr_b16 v[230:231], v214 offset:25088
    v_mul_f32 v9, v9, v219
    v_mfma_f32_16x16x32_bf16 v[76:79], v[244:247], a[20:23], v[76:79]
    ds_read_b64_tr_b16 v[232:233], v213 offset:24832
    v_mul_f32 v10, v10, v219
    v_mfma_f32_16x16x32_bf16 v[84:87], v[244:247], a[24:27], v[84:87]
    ds_read_b64_tr_b16 v[234:235], v213 offset:25344
    v_mul_f32 v11, v11, v219
    v_mfma_f32_16x16x32_bf16 v[92:95], v[244:247], a[28:31], v[92:95]
    buffer_load_dwordx4 v197, s[48:51], s18 offen offset:1024 lds
    v_mfma_f32_16x16x32_bf16 v[96:99], v[248:251], a[16:19], v[96:99]
    ds_read_b64_tr_b16 v[236:237], v214 offset:24832
    v_mul_f32 v12, v12, v219
    v_mfma_f32_16x16x32_bf16 v[104:107], v[248:251], a[20:23], v[104:107]
    ds_read_b64_tr_b16 v[238:239], v214 offset:25344
    v_mul_f32 v13, v13, v219
    v_mfma_f32_16x16x32_bf16 v[112:115], v[248:251], a[24:27], v[112:115]
    v_mul_f32 v14, v14, v219
    v_mul_f32 v15, v15, v219
    v_mfma_f32_16x16x32_bf16 v[120:123], v[248:251], a[28:31], v[120:123]
    buffer_load_dwordx4 v198, s[48:51], s18 offen offset:2048 lds
    v_mfma_f32_16x16x32_bf16 v[100:103], v[252:255], a[16:19], v[100:103]
    v_permlane16_swap_b32 v0, v2
    v_permlane16_swap_b32 v1, v3
    v_mfma_f32_16x16x32_bf16 v[108:111], v[252:255], a[20:23], v[108:111]
    v_cvt_pk_bf16_f32 v4, v8, v9
    v_cvt_pk_bf16_f32 v5, v10, v11
    v_mfma_f32_16x16x32_bf16 v[116:119], v[252:255], a[24:27], v[116:119]
    buffer_load_dwordx4 v199, s[48:51], s18 offen offset:3072 lds
    v_mfma_f32_16x16x32_bf16 v[124:127], v[252:255], a[28:31], v[124:127]
    s_waitcnt vmcnt(12) lgkmcnt(0)
    v_cvt_pk_bf16_f32 v6, v12, v13
    v_cvt_pk_bf16_f32 v7, v14, v15
    v_mfma_f32_16x16x32_bf16 v[64:67], v[224:227], a[32:35], v[64:67]
    s_add_u32 m0, s8, 24576
    ds_read_b64_tr_b16 v[240:241], v213 offset:28672
    v_mul_f32 v16, v16, v220
    v_mfma_f32_16x16x32_bf16 v[72:75], v[224:227], a[36:39], v[72:75]
    s_add_u32 s18, s18, 262144
    ds_read_b64_tr_b16 v[242:243], v213 offset:29184
    v_mul_f32 v17, v17, v220
    v_mfma_f32_16x16x32_bf16 v[80:83], v[224:227], a[40:43], v[80:83]
    s_and_b32 s18, s18, 0x3fffff
    ds_read_b64_tr_b16 v[244:245], v214 offset:28672
    v_mul_f32 v18, v18, v220
    v_mfma_f32_16x16x32_bf16 v[88:91], v[224:227], a[44:47], v[88:91]
    buffer_load_dwordx4 v196, s[48:51], s18 offen offset:0 lds
    v_mfma_f32_16x16x32_bf16 v[68:71], v[228:231], a[32:35], v[68:71]
    ds_read_b64_tr_b16 v[246:247], v214 offset:29184
    v_mul_f32 v19, v19, v220
    v_mfma_f32_16x16x32_bf16 v[76:79], v[228:231], a[36:39], v[76:79]
    ds_read_b64_tr_b16 v[248:249], v213 offset:28928
    v_mul_f32 v20, v20, v220
    v_mfma_f32_16x16x32_bf16 v[84:87], v[228:231], a[40:43], v[84:87]
    ds_read_b64_tr_b16 v[250:251], v213 offset:29440
    v_mul_f32 v21, v21, v220
    v_mfma_f32_16x16x32_bf16 v[92:95], v[228:231], a[44:47], v[92:95]
    buffer_load_dwordx4 v197, s[48:51], s18 offen offset:1024 lds
    v_mfma_f32_16x16x32_bf16 v[96:99], v[232:235], a[32:35], v[96:99]
    ds_read_b64_tr_b16 v[252:253], v214 offset:28928
    v_mul_f32 v22, v22, v220
    v_mfma_f32_16x16x32_bf16 v[104:107], v[232:235], a[36:39], v[104:107]
    ds_read_b64_tr_b16 v[254:255], v214 offset:29440
    v_mul_f32 v23, v23, v220
    v_mfma_f32_16x16x32_bf16 v[112:115], v[232:235], a[40:43], v[112:115]
    v_permlane16_swap_b32 v4, v6
    v_permlane16_swap_b32 v5, v7
    v_mfma_f32_16x16x32_bf16 v[120:123], v[232:235], a[44:47], v[120:123]
    buffer_load_dwordx4 v198, s[48:51], s18 offen offset:2048 lds
    v_mfma_f32_16x16x32_bf16 v[100:103], v[236:239], a[32:35], v[100:103]
    v_cvt_pk_bf16_f32 v8, v16, v17
    v_cvt_pk_bf16_f32 v9, v18, v19
    v_mfma_f32_16x16x32_bf16 v[108:111], v[236:239], a[36:39], v[108:111]
    v_cvt_pk_bf16_f32 v10, v20, v21
    v_cvt_pk_bf16_f32 v11, v22, v23
    v_mfma_f32_16x16x32_bf16 v[116:119], v[236:239], a[40:43], v[116:119]
    buffer_load_dwordx4 v199, s[48:51], s18 offen offset:3072 lds
    v_mfma_f32_16x16x32_bf16 v[124:127], v[236:239], a[44:47], v[124:127]
    s_waitcnt vmcnt(12) lgkmcnt(0)
    v_mul_f32 v24, v24, v221
    v_mul_f32 v25, v25, v221
    v_mfma_f32_16x16x32_bf16 v[64:67], v[240:243], a[48:51], v[64:67]
    s_add_u32 m0, s8, 28672
    ds_read_b64_tr_b16 v[224:225], v213 offset:32768
    v_mul_f32 v26, v26, v221
    v_mfma_f32_16x16x32_bf16 v[72:75], v[240:243], a[52:55], v[72:75]
    s_add_u32 s18, s18, 262144
    ds_read_b64_tr_b16 v[226:227], v213 offset:33280
    v_mul_f32 v27, v27, v221
    v_mfma_f32_16x16x32_bf16 v[80:83], v[240:243], a[56:59], v[80:83]
    s_and_b32 s18, s18, 0x3fffff
    ds_read_b64_tr_b16 v[228:229], v214 offset:32768
    v_mul_f32 v28, v28, v221
    v_mfma_f32_16x16x32_bf16 v[88:91], v[240:243], a[60:63], v[88:91]
    buffer_load_dwordx4 v196, s[48:51], s18 offen offset:0 lds
    v_mfma_f32_16x16x32_bf16 v[68:71], v[244:247], a[48:51], v[68:71]
    ds_read_b64_tr_b16 v[230:231], v214 offset:33280
    v_mul_f32 v29, v29, v221
    v_mfma_f32_16x16x32_bf16 v[76:79], v[244:247], a[52:55], v[76:79]
    ds_read_b64_tr_b16 v[232:233], v213 offset:33024
    v_mul_f32 v30, v30, v221
    v_mfma_f32_16x16x32_bf16 v[84:87], v[244:247], a[56:59], v[84:87]
    ds_read_b64_tr_b16 v[234:235], v213 offset:33536
    v_mul_f32 v31, v31, v221
    v_mfma_f32_16x16x32_bf16 v[92:95], v[244:247], a[60:63], v[92:95]
    buffer_load_dwordx4 v197, s[48:51], s18 offen offset:1024 lds
    v_mfma_f32_16x16x32_bf16 v[96:99], v[248:251], a[48:51], v[96:99]
    ds_read_b64_tr_b16 v[236:237], v214 offset:33024
    v_permlane16_swap_b32 v8, v10
    v_mfma_f32_16x16x32_bf16 v[104:107], v[248:251], a[52:55], v[104:107]
    ds_read_b64_tr_b16 v[238:239], v214 offset:33536
    v_permlane16_swap_b32 v9, v11
    v_mfma_f32_16x16x32_bf16 v[112:115], v[248:251], a[56:59], v[112:115]
    v_cvt_pk_bf16_f32 v12, v24, v25
    v_cvt_pk_bf16_f32 v13, v26, v27
    v_mfma_f32_16x16x32_bf16 v[120:123], v[248:251], a[60:63], v[120:123]
    buffer_load_dwordx4 v198, s[48:51], s18 offen offset:2048 lds
    v_mfma_f32_16x16x32_bf16 v[100:103], v[252:255], a[48:51], v[100:103]
    v_cvt_pk_bf16_f32 v14, v28, v29
    v_cvt_pk_bf16_f32 v15, v30, v31
    v_mfma_f32_16x16x32_bf16 v[108:111], v[252:255], a[52:55], v[108:111]
    v_mul_f32 v32, v32, v218
    v_mul_f32 v33, v33, v218
    v_mfma_f32_16x16x32_bf16 v[116:119], v[252:255], a[56:59], v[116:119]
    buffer_load_dwordx4 v199, s[48:51], s18 offen offset:3072 lds
    v_mfma_f32_16x16x32_bf16 v[124:127], v[252:255], a[60:63], v[124:127]
    s_waitcnt vmcnt(12) lgkmcnt(0)
    v_mul_f32 v34, v34, v218
    v_mul_f32 v35, v35, v218
    v_mfma_f32_16x16x32_bf16 v[64:67], v[224:227], a[64:67], v[64:67]
    s_add_u32 m0, s8, 32768
    ds_read_b64_tr_b16 v[240:241], v213 offset:36864
    v_mul_f32 v36, v36, v218
    v_mfma_f32_16x16x32_bf16 v[72:75], v[224:227], a[68:71], v[72:75]
    s_add_u32 s18, s18, 262144
    ds_read_b64_tr_b16 v[242:243], v213 offset:37376
    v_mul_f32 v37, v37, v218
    v_mfma_f32_16x16x32_bf16 v[80:83], v[224:227], a[72:75], v[80:83]
    s_and_b32 s18, s18, 0x3fffff
    ds_read_b64_tr_b16 v[244:245], v214 offset:36864
    v_mul_f32 v38, v38, v218
    v_mfma_f32_16x16x32_bf16 v[88:91], v[224:227], a[76:79], v[88:91]
    buffer_load_dwordx4 v196, s[48:51], s18 offen offset:0 lds
    v_mfma_f32_16x16x32_bf16 v[68:71], v[228:231], a[64:67], v[68:71]
    ds_read_b64_tr_b16 v[246:247], v214 offset:37376
    v_mul_f32 v39, v39, v218
    v_mfma_f32_16x16x32_bf16 v[76:79], v[228:231], a[68:71], v[76:79]
    ds_read_b64_tr_b16 v[248:249], v213 offset:37120
    v_permlane16_swap_b32 v12, v14
    v_mfma_f32_16x16x32_bf16 v[84:87], v[228:231], a[72:75], v[84:87]
    ds_read_b64_tr_b16 v[250:251], v213 offset:37632
    v_permlane16_swap_b32 v13, v15
    v_mfma_f32_16x16x32_bf16 v[92:95], v[228:231], a[76:79], v[92:95]
    buffer_load_dwordx4 v197, s[48:51], s18 offen offset:1024 lds
    v_mfma_f32_16x16x32_bf16 v[96:99], v[232:235], a[64:67], v[96:99]
    ds_read_b64_tr_b16 v[252:253], v214 offset:37120
    v_cvt_pk_bf16_f32 v16, v32, v33
    v_mfma_f32_16x16x32_bf16 v[104:107], v[232:235], a[68:71], v[104:107]
    ds_read_b64_tr_b16 v[254:255], v214 offset:37632
    v_cvt_pk_bf16_f32 v17, v34, v35
    v_mfma_f32_16x16x32_bf16 v[112:115], v[232:235], a[72:75], v[112:115]
    v_cvt_pk_bf16_f32 v18, v36, v37
    v_cvt_pk_bf16_f32 v19, v38, v39
    v_mfma_f32_16x16x32_bf16 v[120:123], v[232:235], a[76:79], v[120:123]
    buffer_load_dwordx4 v198, s[48:51], s18 offen offset:2048 lds
    v_mfma_f32_16x16x32_bf16 v[100:103], v[236:239], a[64:67], v[100:103]
    v_mul_f32 v40, v40, v219
    v_mul_f32 v41, v41, v219
    v_mfma_f32_16x16x32_bf16 v[108:111], v[236:239], a[68:71], v[108:111]
    v_mul_f32 v42, v42, v219
    v_mul_f32 v43, v43, v219
    v_mfma_f32_16x16x32_bf16 v[116:119], v[236:239], a[72:75], v[116:119]
    buffer_load_dwordx4 v199, s[48:51], s18 offen offset:3072 lds
    v_mfma_f32_16x16x32_bf16 v[124:127], v[236:239], a[76:79], v[124:127]
    s_waitcnt vmcnt(12) lgkmcnt(0)
    v_mul_f32 v44, v44, v219
    v_mul_f32 v45, v45, v219
    v_mfma_f32_16x16x32_bf16 v[64:67], v[240:243], a[80:83], v[64:67]
    s_add_u32 m0, s8, 36864
    ds_read_b64_tr_b16 v[224:225], v213 offset:20480
    v_mul_f32 v46, v46, v219
    v_mfma_f32_16x16x32_bf16 v[72:75], v[240:243], a[84:87], v[72:75]
    s_add_u32 s18, s18, 262144
    ds_read_b64_tr_b16 v[226:227], v213 offset:20992
    v_mul_f32 v47, v47, v219
    v_mfma_f32_16x16x32_bf16 v[80:83], v[240:243], a[88:91], v[80:83]
    s_and_b32 s18, s18, 0x3fffff
    ds_read_b64_tr_b16 v[228:229], v214 offset:20480
    v_permlane16_swap_b32 v16, v18
    v_mfma_f32_16x16x32_bf16 v[88:91], v[240:243], a[92:95], v[88:91]
    buffer_load_dwordx4 v196, s[48:51], s18 offen offset:0 lds
    v_mfma_f32_16x16x32_bf16 v[68:71], v[244:247], a[80:83], v[68:71]
    ds_read_b64_tr_b16 v[230:231], v214 offset:20992
    v_permlane16_swap_b32 v17, v19
    v_mfma_f32_16x16x32_bf16 v[76:79], v[244:247], a[84:87], v[76:79]
    ds_read_b64_tr_b16 v[232:233], v213 offset:20736
    v_cvt_pk_bf16_f32 v20, v40, v41
    v_mfma_f32_16x16x32_bf16 v[84:87], v[244:247], a[88:91], v[84:87]
    ds_read_b64_tr_b16 v[234:235], v213 offset:21248
    v_cvt_pk_bf16_f32 v21, v42, v43
    v_mfma_f32_16x16x32_bf16 v[92:95], v[244:247], a[92:95], v[92:95]
    buffer_load_dwordx4 v197, s[48:51], s18 offen offset:1024 lds
    v_mfma_f32_16x16x32_bf16 v[96:99], v[248:251], a[80:83], v[96:99]
    ds_read_b64_tr_b16 v[236:237], v214 offset:20736
    v_cvt_pk_bf16_f32 v22, v44, v45
    v_mfma_f32_16x16x32_bf16 v[104:107], v[248:251], a[84:87], v[104:107]
    ds_read_b64_tr_b16 v[238:239], v214 offset:21248
    v_cvt_pk_bf16_f32 v23, v46, v47
    v_mfma_f32_16x16x32_bf16 v[112:115], v[248:251], a[88:91], v[112:115]
    v_mul_f32 v48, v48, v220
    v_mul_f32 v49, v49, v220
    v_mfma_f32_16x16x32_bf16 v[120:123], v[248:251], a[92:95], v[120:123]
    buffer_load_dwordx4 v198, s[48:51], s18 offen offset:2048 lds
    v_mfma_f32_16x16x32_bf16 v[100:103], v[252:255], a[80:83], v[100:103]
    v_mul_f32 v50, v50, v220
    v_mul_f32 v51, v51, v220
    v_mfma_f32_16x16x32_bf16 v[108:111], v[252:255], a[84:87], v[108:111]
    v_mul_f32 v52, v52, v220
    v_mul_f32 v53, v53, v220
    v_mfma_f32_16x16x32_bf16 v[116:119], v[252:255], a[88:91], v[116:119]
    buffer_load_dwordx4 v199, s[48:51], s18 offen offset:3072 lds
    v_mfma_f32_16x16x32_bf16 v[124:127], v[252:255], a[92:95], v[124:127]
    s_waitcnt vmcnt(12) lgkmcnt(0)
    v_mul_f32 v54, v54, v220
    v_mul_f32 v55, v55, v220
    v_mfma_f32_16x16x32_bf16 v[64:67], v[224:227], a[96:99], v[64:67]
    s_add_u32 m0, s8, 20480
    ds_read_b64_tr_b16 v[240:241], v213 offset:24576
    v_permlane16_swap_b32 v20, v22
    v_mfma_f32_16x16x32_bf16 v[72:75], v[224:227], a[100:103], v[72:75]
    s_add_u32 s18, s18, 262144
    ds_read_b64_tr_b16 v[242:243], v213 offset:25088
    v_permlane16_swap_b32 v21, v23
    v_mfma_f32_16x16x32_bf16 v[80:83], v[224:227], a[104:107], v[80:83]
    s_and_b32 s18, s18, 0x3fffff
    ds_read_b64_tr_b16 v[244:245], v214 offset:24576
    v_cvt_pk_bf16_f32 v24, v48, v49
    v_mfma_f32_16x16x32_bf16 v[88:91], v[224:227], a[108:111], v[88:91]
    buffer_load_dwordx4 v196, s[48:51], s18 offen offset:0 lds
    v_mfma_f32_16x16x32_bf16 v[68:71], v[228:231], a[96:99], v[68:71]
    ds_read_b64_tr_b16 v[246:247], v214 offset:25088
    v_cvt_pk_bf16_f32 v25, v50, v51
    v_mfma_f32_16x16x32_bf16 v[76:79], v[228:231], a[100:103], v[76:79]
    ds_read_b64_tr_b16 v[248:249], v213 offset:24832
    v_cvt_pk_bf16_f32 v26, v52, v53
    v_mfma_f32_16x16x32_bf16 v[84:87], v[228:231], a[104:107], v[84:87]
    ds_read_b64_tr_b16 v[250:251], v213 offset:25344
    v_cvt_pk_bf16_f32 v27, v54, v55
    v_mfma_f32_16x16x32_bf16 v[92:95], v[228:231], a[108:111], v[92:95]
    buffer_load_dwordx4 v197, s[48:51], s18 offen offset:1024 lds
    v_mfma_f32_16x16x32_bf16 v[96:99], v[232:235], a[96:99], v[96:99]
    ds_read_b64_tr_b16 v[252:253], v214 offset:24832
    v_mul_f32 v56, v56, v221
    v_mfma_f32_16x16x32_bf16 v[104:107], v[232:235], a[100:103], v[104:107]
    ds_read_b64_tr_b16 v[254:255], v214 offset:25344
    v_mul_f32 v57, v57, v221
    v_mfma_f32_16x16x32_bf16 v[112:115], v[232:235], a[104:107], v[112:115]
    v_mul_f32 v58, v58, v221
    v_mul_f32 v59, v59, v221
    v_mfma_f32_16x16x32_bf16 v[120:123], v[232:235], a[108:111], v[120:123]
    buffer_load_dwordx4 v198, s[48:51], s18 offen offset:2048 lds
    v_mfma_f32_16x16x32_bf16 v[100:103], v[236:239], a[96:99], v[100:103]
    v_mul_f32 v60, v60, v221
    v_mul_f32 v61, v61, v221
    v_mfma_f32_16x16x32_bf16 v[108:111], v[236:239], a[100:103], v[108:111]
    v_mul_f32 v62, v62, v221
    v_mul_f32 v63, v63, v221
    v_mfma_f32_16x16x32_bf16 v[116:119], v[236:239], a[104:107], v[116:119]
    buffer_load_dwordx4 v199, s[48:51], s18 offen offset:3072 lds
    v_mfma_f32_16x16x32_bf16 v[124:127], v[236:239], a[108:111], v[124:127]
    s_waitcnt vmcnt(12) lgkmcnt(0)
    v_permlane16_swap_b32 v24, v26
    v_permlane16_swap_b32 v25, v27
    v_mfma_f32_16x16x32_bf16 v[64:67], v[240:243], a[112:115], v[64:67]
    s_add_u32 m0, s8, 24576
    ds_read_b64_tr_b16 v[224:225], v213 offset:28672
    v_cvt_pk_bf16_f32 v28, v56, v57
    v_mfma_f32_16x16x32_bf16 v[72:75], v[240:243], a[116:119], v[72:75]
    s_add_u32 s18, s18, 262144
    ds_read_b64_tr_b16 v[226:227], v213 offset:29184
    v_cvt_pk_bf16_f32 v29, v58, v59
    v_mfma_f32_16x16x32_bf16 v[80:83], v[240:243], a[120:123], v[80:83]
    s_and_b32 s18, s18, 0x3fffff
    ds_read_b64_tr_b16 v[228:229], v214 offset:28672
    v_cvt_pk_bf16_f32 v30, v60, v61
    v_mfma_f32_16x16x32_bf16 v[88:91], v[240:243], a[124:127], v[88:91]
    buffer_load_dwordx4 v196, s[48:51], s18 offen offset:0 lds
    v_mfma_f32_16x16x32_bf16 v[68:71], v[244:247], a[112:115], v[68:71]
    ds_read_b64_tr_b16 v[230:231], v214 offset:29184
    v_cvt_pk_bf16_f32 v31, v62, v63
    v_mfma_f32_16x16x32_bf16 v[76:79], v[244:247], a[116:119], v[76:79]
    ds_read_b64_tr_b16 v[232:233], v213 offset:28928
    v_mfma_f32_16x16x32_bf16 v[84:87], v[244:247], a[120:123], v[84:87]
    ds_read_b64_tr_b16 v[234:235], v213 offset:29440
    v_mfma_f32_16x16x32_bf16 v[92:95], v[244:247], a[124:127], v[92:95]
    buffer_load_dwordx4 v197, s[48:51], s18 offen offset:1024 lds
    v_mfma_f32_16x16x32_bf16 v[96:99], v[248:251], a[112:115], v[96:99]
    ds_read_b64_tr_b16 v[236:237], v214 offset:28928
    v_mfma_f32_16x16x32_bf16 v[104:107], v[248:251], a[116:119], v[104:107]
    ds_read_b64_tr_b16 v[238:239], v214 offset:29440
    v_mfma_f32_16x16x32_bf16 v[112:115], v[248:251], a[120:123], v[112:115]
    s_nop 1
    v_mfma_f32_16x16x32_bf16 v[120:123], v[248:251], a[124:127], v[120:123]
    buffer_load_dwordx4 v198, s[48:51], s18 offen offset:2048 lds
    v_mfma_f32_16x16x32_bf16 v[100:103], v[252:255], a[112:115], v[100:103]
    v_permlane16_swap_b32 v28, v30
    v_permlane16_swap_b32 v29, v31
    v_mfma_f32_16x16x32_bf16 v[108:111], v[252:255], a[116:119], v[108:111]
    v_mfma_f32_16x16x32_bf16 v[116:119], v[252:255], a[120:123], v[116:119]
    buffer_load_dwordx4 v199, s[48:51], s18 offen offset:3072 lds
    v_mfma_f32_16x16x32_bf16 v[124:127], v[252:255], a[124:127], v[124:127]
    s_waitcnt vmcnt(12) lgkmcnt(0)
    v_mfma_f32_16x16x32_bf16 v[64:67], v[224:227], a[128:131], v[64:67]
    s_add_u32 m0, s8, 28672
    ds_read_b64_tr_b16 v[240:241], v213 offset:32768
    v_mfma_f32_16x16x32_bf16 v[72:75], v[224:227], a[132:135], v[72:75]
    s_add_u32 s18, s18, 262144
    ds_read_b64_tr_b16 v[242:243], v213 offset:33280
    v_mfma_f32_16x16x32_bf16 v[80:83], v[224:227], a[136:139], v[80:83]
    s_and_b32 s18, s18, 0x3fffff
    ds_read_b64_tr_b16 v[244:245], v214 offset:32768
    v_mfma_f32_16x16x32_bf16 v[88:91], v[224:227], a[140:143], v[88:91]
    buffer_load_dwordx4 v196, s[48:51], s18 offen offset:0 lds
    v_mfma_f32_16x16x32_bf16 v[68:71], v[228:231], a[128:131], v[68:71]
    ds_read_b64_tr_b16 v[246:247], v214 offset:33280
    v_mfma_f32_16x16x32_bf16 v[76:79], v[228:231], a[132:135], v[76:79]
    ds_read_b64_tr_b16 v[248:249], v213 offset:33024
    v_mfma_f32_16x16x32_bf16 v[84:87], v[228:231], a[136:139], v[84:87]
    ds_read_b64_tr_b16 v[250:251], v213 offset:33536
    v_mfma_f32_16x16x32_bf16 v[92:95], v[228:231], a[140:143], v[92:95]
    buffer_load_dwordx4 v197, s[48:51], s18 offen offset:1024 lds
    v_mfma_f32_16x16x32_bf16 v[96:99], v[232:235], a[128:131], v[96:99]
    ds_read_b64_tr_b16 v[252:253], v214 offset:33024
    v_mfma_f32_16x16x32_bf16 v[104:107], v[232:235], a[132:135], v[104:107]
    ds_read_b64_tr_b16 v[254:255], v214 offset:33536
    v_mfma_f32_16x16x32_bf16 v[112:115], v[232:235], a[136:139], v[112:115]
    v_mfma_f32_16x16x32_bf16 v[120:123], v[232:235], a[140:143], v[120:123]
    buffer_load_dwordx4 v198, s[48:51], s18 offen offset:2048 lds
    v_mfma_f32_16x16x32_bf16 v[100:103], v[236:239], a[128:131], v[100:103]
    v_mfma_f32_16x16x32_bf16 v[108:111], v[236:239], a[132:135], v[108:111]
    v_mfma_f32_16x16x32_bf16 v[116:119], v[236:239], a[136:139], v[116:119]
    buffer_load_dwordx4 v199, s[48:51], s18 offen offset:3072 lds
    v_mfma_f32_16x16x32_bf16 v[124:127], v[236:239], a[140:143], v[124:127]
    s_waitcnt vmcnt(12) lgkmcnt(0)
    v_mfma_f32_16x16x32_bf16 v[64:67], v[240:243], a[144:147], v[64:67]
    s_add_u32 m0, s8, 32768
    ds_read_b64_tr_b16 v[224:225], v213 offset:36864
    v_mfma_f32_16x16x32_bf16 v[72:75], v[240:243], a[148:151], v[72:75]
    s_add_u32 s18, s18, 262144
    ds_read_b64_tr_b16 v[226:227], v213 offset:37376
    v_mfma_f32_16x16x32_bf16 v[80:83], v[240:243], a[152:155], v[80:83]
    s_and_b32 s18, s18, 0x3fffff
    ds_read_b64_tr_b16 v[228:229], v214 offset:36864
    v_mfma_f32_16x16x32_bf16 v[88:91], v[240:243], a[156:159], v[88:91]
    buffer_load_dwordx4 v196, s[48:51], s18 offen offset:0 lds
    v_mfma_f32_16x16x32_bf16 v[68:71], v[244:247], a[144:147], v[68:71]
    ds_read_b64_tr_b16 v[230:231], v214 offset:37376
    v_mfma_f32_16x16x32_bf16 v[76:79], v[244:247], a[148:151], v[76:79]
    ds_read_b64_tr_b16 v[232:233], v213 offset:37120
    v_mfma_f32_16x16x32_bf16 v[84:87], v[244:247], a[152:155], v[84:87]
    ds_read_b64_tr_b16 v[234:235], v213 offset:37632
    v_mfma_f32_16x16x32_bf16 v[92:95], v[244:247], a[156:159], v[92:95]
    buffer_load_dwordx4 v197, s[48:51], s18 offen offset:1024 lds
    v_mfma_f32_16x16x32_bf16 v[96:99], v[248:251], a[144:147], v[96:99]
    ds_read_b64_tr_b16 v[236:237], v214 offset:37120
    v_mfma_f32_16x16x32_bf16 v[104:107], v[248:251], a[148:151], v[104:107]
    ds_read_b64_tr_b16 v[238:239], v214 offset:37632
    v_mfma_f32_16x16x32_bf16 v[112:115], v[248:251], a[152:155], v[112:115]
    v_mfma_f32_16x16x32_bf16 v[120:123], v[248:251], a[156:159], v[120:123]
    buffer_load_dwordx4 v198, s[48:51], s18 offen offset:2048 lds
    v_mfma_f32_16x16x32_bf16 v[100:103], v[252:255], a[144:147], v[100:103]
    v_mfma_f32_16x16x32_bf16 v[108:111], v[252:255], a[148:151], v[108:111]
    v_mfma_f32_16x16x32_bf16 v[116:119], v[252:255], a[152:155], v[116:119]
    buffer_load_dwordx4 v199, s[48:51], s18 offen offset:3072 lds
    v_mfma_f32_16x16x32_bf16 v[124:127], v[252:255], a[156:159], v[124:127]
    s_waitcnt vmcnt(12) lgkmcnt(0)
    v_mfma_f32_16x16x32_bf16 v[64:67], v[224:227], a[160:163], v[64:67]
    s_add_u32 m0, s8, 36864
    ds_read_b64_tr_b16 v[240:241], v213 offset:20480
    v_mfma_f32_16x16x32_bf16 v[72:75], v[224:227], a[164:167], v[72:75]
    s_add_u32 s18, s18, 262144
    ds_read_b64_tr_b16 v[242:243], v213 offset:20992
    v_mfma_f32_16x16x32_bf16 v[80:83], v[224:227], a[168:171], v[80:83]
    s_and_b32 s18, s18, 0x3fffff
    ds_read_b64_tr_b16 v[244:245], v214 offset:20480
    v_mfma_f32_16x16x32_bf16 v[88:91], v[224:227], a[172:175], v[88:91]
    buffer_load_dwordx4 v196, s[48:51], s18 offen offset:0 lds
    v_mfma_f32_16x16x32_bf16 v[68:71], v[228:231], a[160:163], v[68:71]
    ds_read_b64_tr_b16 v[246:247], v214 offset:20992
    v_mfma_f32_16x16x32_bf16 v[76:79], v[228:231], a[164:167], v[76:79]
    ds_read_b64_tr_b16 v[248:249], v213 offset:20736
    v_mfma_f32_16x16x32_bf16 v[84:87], v[228:231], a[168:171], v[84:87]
    ds_read_b64_tr_b16 v[250:251], v213 offset:21248
    v_mfma_f32_16x16x32_bf16 v[92:95], v[228:231], a[172:175], v[92:95]
    buffer_load_dwordx4 v197, s[48:51], s18 offen offset:1024 lds
    v_mfma_f32_16x16x32_bf16 v[96:99], v[232:235], a[160:163], v[96:99]
    ds_read_b64_tr_b16 v[252:253], v214 offset:20736
    v_mfma_f32_16x16x32_bf16 v[104:107], v[232:235], a[164:167], v[104:107]
    ds_read_b64_tr_b16 v[254:255], v214 offset:21248
    v_mfma_f32_16x16x32_bf16 v[112:115], v[232:235], a[168:171], v[112:115]
    v_mfma_f32_16x16x32_bf16 v[120:123], v[232:235], a[172:175], v[120:123]
    buffer_load_dwordx4 v198, s[48:51], s18 offen offset:2048 lds
    v_mfma_f32_16x16x32_bf16 v[100:103], v[236:239], a[160:163], v[100:103]
    v_mfma_f32_16x16x32_bf16 v[108:111], v[236:239], a[164:167], v[108:111]
    v_mfma_f32_16x16x32_bf16 v[116:119], v[236:239], a[168:171], v[116:119]
    buffer_load_dwordx4 v199, s[48:51], s18 offen offset:3072 lds
    v_mfma_f32_16x16x32_bf16 v[124:127], v[236:239], a[172:175], v[124:127]
    s_waitcnt vmcnt(12) lgkmcnt(0)
    v_mfma_f32_16x16x32_bf16 v[64:67], v[240:243], a[176:179], v[64:67]
    s_add_u32 m0, s8, 16640
    ds_read_b64_tr_b16 v[224:225], v213 offset:24576
    v_mfma_f32_16x16x32_bf16 v[72:75], v[240:243], a[180:183], v[72:75]
    ds_read_b64_tr_b16 v[226:227], v213 offset:25088
    v_mfma_f32_16x16x32_bf16 v[80:83], v[240:243], a[184:187], v[80:83]
    ds_read_b64_tr_b16 v[228:229], v214 offset:24576
    v_mfma_f32_16x16x32_bf16 v[88:91], v[240:243], a[188:191], v[88:91]
    buffer_load_dwordx4 v208, s[56:59], s16 offen offset:0 lds
    v_mfma_f32_16x16x32_bf16 v[68:71], v[244:247], a[176:179], v[68:71]
    s_add_u32 m0, s8, 16704
    ds_read_b64_tr_b16 v[230:231], v214 offset:25088
    v_mfma_f32_16x16x32_bf16 v[76:79], v[244:247], a[180:183], v[76:79]
    ds_read_b64_tr_b16 v[232:233], v213 offset:24832
    v_mfma_f32_16x16x32_bf16 v[84:87], v[244:247], a[184:187], v[84:87]
    ds_read_b64_tr_b16 v[234:235], v213 offset:25344
    v_mfma_f32_16x16x32_bf16 v[92:95], v[244:247], a[188:191], v[92:95]
    buffer_load_dwordx4 v208, s[56:59], s16 offen offset:1024 lds
    v_mfma_f32_16x16x32_bf16 v[96:99], v[248:251], a[176:179], v[96:99]
    s_add_u32 m0, s8, 16768
    ds_read_b64_tr_b16 v[236:237], v214 offset:24832
    v_mfma_f32_16x16x32_bf16 v[104:107], v[248:251], a[180:183], v[104:107]
    ds_read_b64_tr_b16 v[238:239], v214 offset:25344
    v_mfma_f32_16x16x32_bf16 v[112:115], v[248:251], a[184:187], v[112:115]
    v_mfma_f32_16x16x32_bf16 v[120:123], v[248:251], a[188:191], v[120:123]
    buffer_load_dwordx4 v208, s[56:59], s16 offen offset:2048 lds
    v_mfma_f32_16x16x32_bf16 v[100:103], v[252:255], a[176:179], v[100:103]
    s_add_u32 m0, s8, 16832
    v_mfma_f32_16x16x32_bf16 v[108:111], v[252:255], a[180:183], v[108:111]
    v_mfma_f32_16x16x32_bf16 v[116:119], v[252:255], a[184:187], v[116:119]
    buffer_load_dwordx4 v208, s[56:59], s16 offen offset:3072 lds
    v_mfma_f32_16x16x32_bf16 v[124:127], v[252:255], a[188:191], v[124:127]
    s_waitcnt vmcnt(12) lgkmcnt(0)
    v_mfma_f32_16x16x32_bf16 v[64:67], v[224:227], a[192:195], v[64:67]
    s_add_u32 s16, s16, 0x4000
    ds_read_b64_tr_b16 v[240:241], v213 offset:28672
    v_mfma_f32_16x16x32_bf16 v[72:75], v[224:227], a[196:199], v[72:75]
    s_and_b32 s16, s16, 0x1ffff
    ds_read_b64_tr_b16 v[242:243], v213 offset:29184
    v_mfma_f32_16x16x32_bf16 v[80:83], v[224:227], a[200:203], v[80:83]
    s_add_u32 m0, s8, 20992
    ds_read_b64_tr_b16 v[244:245], v214 offset:28672
    v_mfma_f32_16x16x32_bf16 v[88:91], v[224:227], a[204:207], v[88:91]
    buffer_load_dwordx4 v208, s[56:59], s16 offen offset:0 lds
    v_mfma_f32_16x16x32_bf16 v[68:71], v[228:231], a[192:195], v[68:71]
    s_add_u32 m0, s8, 21056
    ds_read_b64_tr_b16 v[246:247], v214 offset:29184
    v_mfma_f32_16x16x32_bf16 v[76:79], v[228:231], a[196:199], v[76:79]
    ds_read_b64_tr_b16 v[248:249], v213 offset:28928
    v_mfma_f32_16x16x32_bf16 v[84:87], v[228:231], a[200:203], v[84:87]
    ds_read_b64_tr_b16 v[250:251], v213 offset:29440
    v_mfma_f32_16x16x32_bf16 v[92:95], v[228:231], a[204:207], v[92:95]
    buffer_load_dwordx4 v208, s[56:59], s16 offen offset:1024 lds
    v_mfma_f32_16x16x32_bf16 v[96:99], v[232:235], a[192:195], v[96:99]
    s_add_u32 m0, s8, 21120
    ds_read_b64_tr_b16 v[252:253], v214 offset:28928
    v_mfma_f32_16x16x32_bf16 v[104:107], v[232:235], a[196:199], v[104:107]
    ds_read_b64_tr_b16 v[254:255], v214 offset:29440
    v_mfma_f32_16x16x32_bf16 v[112:115], v[232:235], a[200:203], v[112:115]
    v_mfma_f32_16x16x32_bf16 v[120:123], v[232:235], a[204:207], v[120:123]
    buffer_load_dwordx4 v208, s[56:59], s16 offen offset:2048 lds
    v_mfma_f32_16x16x32_bf16 v[100:103], v[236:239], a[192:195], v[100:103]
    s_add_u32 m0, s8, 21184
    v_mfma_f32_16x16x32_bf16 v[108:111], v[236:239], a[196:199], v[108:111]
    v_mfma_f32_16x16x32_bf16 v[116:119], v[236:239], a[200:203], v[116:119]
    buffer_load_dwordx4 v208, s[56:59], s16 offen offset:3072 lds
    v_mfma_f32_16x16x32_bf16 v[124:127], v[236:239], a[204:207], v[124:127]
    s_waitcnt vmcnt(12) lgkmcnt(0)
    v_mfma_f32_16x16x32_bf16 v[64:67], v[240:243], a[208:211], v[64:67]
    s_add_u32 s16, s16, 0x4000
    ds_read_b64_tr_b16 v[224:225], v213 offset:32768
    v_mfma_f32_16x16x32_bf16 v[72:75], v[240:243], a[212:215], v[72:75]
    s_and_b32 s16, s16, 0x1ffff
    ds_read_b64_tr_b16 v[226:227], v213 offset:33280
    v_mfma_f32_16x16x32_bf16 v[80:83], v[240:243], a[216:219], v[80:83]
    s_add_u32 m0, s8, 25344
    ds_read_b64_tr_b16 v[228:229], v214 offset:32768
    v_mfma_f32_16x16x32_bf16 v[88:91], v[240:243], a[220:223], v[88:91]
    buffer_load_dwordx4 v209, s[60:63], s17 offen offset:0 lds
    v_mfma_f32_16x16x32_bf16 v[68:71], v[244:247], a[208:211], v[68:71]
    ds_read_b64_tr_b16 v[230:231], v214 offset:33280
    v_mfma_f32_16x16x32_bf16 v[76:79], v[244:247], a[212:215], v[76:79]
    ds_read_b64_tr_b16 v[232:233], v213 offset:33024
    v_mfma_f32_16x16x32_bf16 v[84:87], v[244:247], a[216:219], v[84:87]
    ds_read_b64_tr_b16 v[234:235], v213 offset:33536
    v_mfma_f32_16x16x32_bf16 v[92:95], v[244:247], a[220:223], v[92:95]
    buffer_load_dwordx4 v210, s[60:63], s17 offen offset:1024 lds
    v_mfma_f32_16x16x32_bf16 v[96:99], v[248:251], a[208:211], v[96:99]
    ds_read_b64_tr_b16 v[236:237], v214 offset:33024
    v_mfma_f32_16x16x32_bf16 v[104:107], v[248:251], a[212:215], v[104:107]
    ds_read_b64_tr_b16 v[238:239], v214 offset:33536
    v_mfma_f32_16x16x32_bf16 v[112:115], v[248:251], a[216:219], v[112:115]
    v_mfma_f32_16x16x32_bf16 v[120:123], v[248:251], a[220:223], v[120:123]
    buffer_load_dwordx4 v209, s[60:63], s17 offen offset:2048 lds
    v_mfma_f32_16x16x32_bf16 v[100:103], v[252:255], a[208:211], v[100:103]
    v_mfma_f32_16x16x32_bf16 v[108:111], v[252:255], a[212:215], v[108:111]
    v_mfma_f32_16x16x32_bf16 v[116:119], v[252:255], a[216:219], v[116:119]
    buffer_load_dwordx4 v210, s[60:63], s17 offen offset:3072 lds
    v_mfma_f32_16x16x32_bf16 v[124:127], v[252:255], a[220:223], v[124:127]
    s_waitcnt vmcnt(12) lgkmcnt(0)
    v_mfma_f32_16x16x32_bf16 v[64:67], v[224:227], a[224:227], v[64:67]
    s_add_u32 s17, s17, 0x4000
    ds_read_b64_tr_b16 v[240:241], v213 offset:36864
    v_mfma_f32_16x16x32_bf16 v[72:75], v[224:227], a[228:231], v[72:75]
    s_and_b32 s17, s17, 0x1ffff
    ds_read_b64_tr_b16 v[242:243], v213 offset:37376
    v_mfma_f32_16x16x32_bf16 v[80:83], v[224:227], a[232:235], v[80:83]
    s_add_u32 m0, s8, 29440
    ds_read_b64_tr_b16 v[244:245], v214 offset:36864
    v_mfma_f32_16x16x32_bf16 v[88:91], v[224:227], a[236:239], v[88:91]
    buffer_load_dwordx4 v208, s[56:59], s16 offen offset:0 lds
    v_mfma_f32_16x16x32_bf16 v[68:71], v[228:231], a[224:227], v[68:71]
    s_add_u32 m0, s8, 29504
    ds_read_b64_tr_b16 v[246:247], v214 offset:37376
    v_mfma_f32_16x16x32_bf16 v[76:79], v[228:231], a[228:231], v[76:79]
    ds_read_b64_tr_b16 v[248:249], v213 offset:37120
    v_mfma_f32_16x16x32_bf16 v[84:87], v[228:231], a[232:235], v[84:87]
    ds_read_b64_tr_b16 v[250:251], v213 offset:37632
    v_mfma_f32_16x16x32_bf16 v[92:95], v[228:231], a[236:239], v[92:95]
    buffer_load_dwordx4 v208, s[56:59], s16 offen offset:1024 lds
    v_mfma_f32_16x16x32_bf16 v[96:99], v[232:235], a[224:227], v[96:99]
    s_add_u32 m0, s8, 29568
    ds_read_b64_tr_b16 v[252:253], v214 offset:37120
    v_mfma_f32_16x16x32_bf16 v[104:107], v[232:235], a[228:231], v[104:107]
    ds_read_b64_tr_b16 v[254:255], v214 offset:37632
    v_mfma_f32_16x16x32_bf16 v[112:115], v[232:235], a[232:235], v[112:115]
    v_mfma_f32_16x16x32_bf16 v[120:123], v[232:235], a[236:239], v[120:123]
    buffer_load_dwordx4 v208, s[56:59], s16 offen offset:2048 lds
    v_mfma_f32_16x16x32_bf16 v[100:103], v[236:239], a[224:227], v[100:103]
    s_add_u32 m0, s8, 29632
    v_mfma_f32_16x16x32_bf16 v[108:111], v[236:239], a[228:231], v[108:111]
    v_mfma_f32_16x16x32_bf16 v[116:119], v[236:239], a[232:235], v[116:119]
    buffer_load_dwordx4 v208, s[56:59], s16 offen offset:3072 lds
    v_mfma_f32_16x16x32_bf16 v[124:127], v[236:239], a[236:239], v[124:127]
    s_waitcnt lgkmcnt(0)
    v_mfma_f32_16x16x32_bf16 v[64:67], v[240:243], a[240:243], v[64:67]
    s_add_u32 s16, s16, 0x4000
    v_add_u32 v213, 4294885376, v215
    v_add_u32 v214, 4294885376, v223
    v_mfma_f32_16x16x32_bf16 v[72:75], v[240:243], a[244:247], v[72:75]
    s_and_b32 s16, s16, 0x1ffff
    v_mfma_f32_16x16x32_bf16 v[80:83], v[240:243], a[248:251], v[80:83]
    v_mfma_f32_16x16x32_bf16 v[88:91], v[240:243], a[252:255], v[88:91]
    v_mfma_f32_16x16x32_bf16 v[68:71], v[244:247], a[240:243], v[68:71]
    v_mfma_f32_16x16x32_bf16 v[76:79], v[244:247], a[244:247], v[76:79]
    v_mfma_f32_16x16x32_bf16 v[84:87], v[244:247], a[248:251], v[84:87]
    v_mfma_f32_16x16x32_bf16 v[92:95], v[244:247], a[252:255], v[92:95]
    v_mfma_f32_16x16x32_bf16 v[96:99], v[248:251], a[240:243], v[96:99]
    v_mfma_f32_16x16x32_bf16 v[104:107], v[248:251], a[244:247], v[104:107]
    v_mfma_f32_16x16x32_bf16 v[112:115], v[248:251], a[248:251], v[112:115]
    v_mfma_f32_16x16x32_bf16 v[120:123], v[248:251], a[252:255], v[120:123]
    v_mfma_f32_16x16x32_bf16 v[100:103], v[252:255], a[240:243], v[100:103]
    v_mfma_f32_16x16x32_bf16 v[108:111], v[252:255], a[244:247], v[108:111]
    v_mfma_f32_16x16x32_bf16 v[116:119], v[252:255], a[248:251], v[116:119]
    v_mfma_f32_16x16x32_bf16 v[124:127], v[252:255], a[252:255], v[124:127]
    s_waitcnt vmcnt(8)
    s_barrier
    ds_read_b128 a[128:131], v212 offset:16640
    ds_read_b128 a[132:135], v212 offset:57600
    ds_read_b128 a[136:139], v212 offset:16704
    ds_read_b128 a[140:143], v212 offset:57664
    ds_read_b128 a[144:147], v212 offset:16768
    ds_read_b128 a[148:151], v212 offset:57728
    ds_read_b128 a[152:155], v212 offset:16832
    ds_read_b128 a[156:159], v212 offset:57792
    ds_read_b128 a[160:163], v211 offset:20992
    ds_read_b128 a[164:167], v211 offset:61952
    ds_read_b128 a[168:171], v211 offset:21056
    ds_read_b128 a[172:175], v211 offset:62016
    ds_read_b128 a[176:179], v211 offset:21120
    ds_read_b128 a[180:183], v211 offset:62080
    ds_read_b128 a[184:187], v211 offset:21184
    ds_read_b128 a[188:191], v211 offset:62144
    v_mul_f32 v64, v64, v218
    v_mul_f32 v65, v65, v218
    v_mul_f32 v66, v66, v218
    v_mul_f32 v67, v67, v218
    v_mul_f32 v68, v68, v218
    v_mul_f32 v69, v69, v218
    v_mul_f32 v70, v70, v218
    v_mul_f32 v71, v71, v218
    v_cvt_pk_bf16_f32 v32, v64, v65
    v_cvt_pk_bf16_f32 v33, v66, v67
    v_cvt_pk_bf16_f32 v34, v68, v69
    v_cvt_pk_bf16_f32 v35, v70, v71
    v_mul_f32 v72, v72, v219
    v_mul_f32 v73, v73, v219
    v_mul_f32 v74, v74, v219
    v_mul_f32 v75, v75, v219
    v_mul_f32 v76, v76, v219
    v_mul_f32 v77, v77, v219
    v_mul_f32 v78, v78, v219
    v_mul_f32 v79, v79, v219
    v_permlane16_swap_b32 v32, v34
    v_permlane16_swap_b32 v33, v35
    v_cvt_pk_bf16_f32 v36, v72, v73
    v_cvt_pk_bf16_f32 v37, v74, v75
    v_cvt_pk_bf16_f32 v38, v76, v77
    v_cvt_pk_bf16_f32 v39, v78, v79
    v_mul_f32 v80, v80, v220
    v_mul_f32 v81, v81, v220
    v_mul_f32 v82, v82, v220
    v_mul_f32 v83, v83, v220
    s_waitcnt lgkmcnt(8)
    v_mfma_f32_16x16x32_bf16 v[128:131], a[128:131], v[0:3], 0
    buffer_store_dwordx4 v[164:167], v192, s[72:75], s19 offen offset:0 sc1
    v_mul_f32 v84, v84, v220
    v_mfma_f32_16x16x32_bf16 v[136:139], a[128:131], v[4:7], 0
    v_mul_f32 v85, v85, v220
    v_mul_f32 v86, v86, v220
    v_mul_f32 v87, v87, v220
    v_mfma_f32_16x16x32_bf16 v[144:147], a[128:131], v[8:11], 0
    v_permlane16_swap_b32 v36, v38
    v_permlane16_swap_b32 v37, v39
    v_cvt_pk_bf16_f32 v40, v80, v81
    v_mfma_f32_16x16x32_bf16 v[152:155], a[128:131], v[12:15], 0
    buffer_store_dwordx4 v[160:163], v192, s[72:75], s29 offen offset:0 sc1
    v_cvt_pk_bf16_f32 v41, v82, v83
    v_mfma_f32_16x16x32_bf16 v[132:135], a[132:135], v[0:3], 0
    v_cvt_pk_bf16_f32 v42, v84, v85
    v_cvt_pk_bf16_f32 v43, v86, v87
    v_mfma_f32_16x16x32_bf16 v[140:143], a[132:135], v[4:7], 0
    v_mul_f32 v88, v88, v221
    v_mul_f32 v89, v89, v221
    v_mul_f32 v90, v90, v221
    v_mfma_f32_16x16x32_bf16 v[148:151], a[132:135], v[8:11], 0
    buffer_store_dwordx4 v[172:175], v192, s[72:75], s19 offen offset:1024 sc1
    v_mul_f32 v91, v91, v221
    v_mfma_f32_16x16x32_bf16 v[156:159], a[132:135], v[12:15], 0
    v_mul_f32 v92, v92, v221
    v_mul_f32 v93, v93, v221
    v_mul_f32 v94, v94, v221
    v_mfma_f32_16x16x32_bf16 v[128:131], a[136:139], v[16:19], v[128:131]
    v_mul_f32 v95, v95, v221
    v_permlane16_swap_b32 v40, v42
    v_permlane16_swap_b32 v41, v43
    v_mfma_f32_16x16x32_bf16 v[136:139], a[136:139], v[20:23], v[136:139]
    buffer_store_dwordx4 v[168:171], v192, s[72:75], s29 offen offset:1024 sc1
    v_cvt_pk_bf16_f32 v44, v88, v89
    v_mfma_f32_16x16x32_bf16 v[144:147], a[136:139], v[24:27], v[144:147]
    v_cvt_pk_bf16_f32 v45, v90, v91
    v_cvt_pk_bf16_f32 v46, v92, v93
    v_cvt_pk_bf16_f32 v47, v94, v95
    v_mfma_f32_16x16x32_bf16 v[152:155], a[136:139], v[28:31], v[152:155]
    v_mul_f32 v96, v96, v218
    v_mul_f32 v97, v97, v218
    v_mul_f32 v98, v98, v218
    v_mfma_f32_16x16x32_bf16 v[132:135], a[140:143], v[16:19], v[132:135]
    v_mul_f32 v99, v99, v218
    v_mul_f32 v100, v100, v218
    v_mfma_f32_16x16x32_bf16 v[140:143], a[140:143], v[20:23], v[140:143]
    buffer_store_dwordx4 v[180:183], v192, s[72:75], s19 offen offset:2048 sc1
    v_mul_f32 v101, v101, v218
    v_mfma_f32_16x16x32_bf16 v[148:151], a[140:143], v[24:27], v[148:151]
    v_mul_f32 v102, v102, v218
    v_mul_f32 v103, v103, v218
    v_permlane16_swap_b32 v44, v46
    v_mfma_f32_16x16x32_bf16 v[156:159], a[140:143], v[28:31], v[156:159]
    v_permlane16_swap_b32 v45, v47
    v_cvt_pk_bf16_f32 v48, v96, v97
    s_nop 0
    v_cvt_pk_bf16_f32 v49, v98, v99
    v_cvt_pk_bf16_f32 v50, v100, v101
    v_cvt_pk_bf16_f32 v51, v102, v103
    v_mul_f32 v104, v104, v219
    v_mul_f32 v105, v105, v219
    v_mfma_f32_16x16x32_bf16 v[128:131], a[144:147], v[32:35], v[128:131]
    buffer_store_dwordx4 v[176:179], v192, s[72:75], s29 offen offset:2048 sc1
    v_mul_f32 v106, v106, v219
    v_mul_f32 v107, v107, v219
    v_mul_f32 v108, v108, v219
    v_mul_f32 v109, v109, v219
    v_mfma_f32_16x16x32_bf16 v[136:139], a[144:147], v[36:39], v[136:139]
    v_mul_f32 v110, v110, v219
    v_mul_f32 v111, v111, v219
    v_permlane16_swap_b32 v48, v50
    v_permlane16_swap_b32 v49, v51
    v_cvt_pk_bf16_f32 v52, v104, v105
    v_cvt_pk_bf16_f32 v53, v106, v107
    v_cvt_pk_bf16_f32 v54, v108, v109
    v_mfma_f32_16x16x32_bf16 v[144:147], a[144:147], v[40:43], v[144:147]
    v_cvt_pk_bf16_f32 v55, v110, v111
    v_mul_f32 v112, v112, v220
    v_mul_f32 v113, v113, v220
    v_mul_f32 v114, v114, v220
    v_mul_f32 v115, v115, v220
    v_mul_f32 v116, v116, v220
    v_mfma_f32_16x16x32_bf16 v[152:155], a[144:147], v[44:47], v[152:155]
    buffer_store_dwordx4 v[188:191], v192, s[72:75], s19 offen offset:3072 sc1
    v_mul_f32 v117, v117, v220
    v_mul_f32 v118, v118, v220
    v_mul_f32 v119, v119, v220
    v_permlane16_swap_b32 v52, v54
    v_permlane16_swap_b32 v53, v55
    v_mfma_f32_16x16x32_bf16 v[132:135], a[148:151], v[32:35], v[132:135]
    v_cvt_pk_bf16_f32 v56, v112, v113
    v_cvt_pk_bf16_f32 v57, v114, v115
    v_cvt_pk_bf16_f32 v58, v116, v117
    v_cvt_pk_bf16_f32 v59, v118, v119
    v_mul_f32 v120, v120, v221
    v_mul_f32 v121, v121, v221
    v_mfma_f32_16x16x32_bf16 v[140:143], a[148:151], v[36:39], v[140:143]
    v_mul_f32 v122, v122, v221
    v_mul_f32 v123, v123, v221
    v_mul_f32 v124, v124, v221
    v_mul_f32 v125, v125, v221
    v_mul_f32 v126, v126, v221
    v_mul_f32 v127, v127, v221
    v_permlane16_swap_b32 v56, v58
    v_mfma_f32_16x16x32_bf16 v[148:151], a[148:151], v[40:43], v[148:151]
    buffer_store_dwordx4 v[184:187], v192, s[72:75], s29 offen offset:3072 sc1
    v_permlane16_swap_b32 v57, v59
    v_cvt_pk_bf16_f32 v60, v120, v121
    v_cvt_pk_bf16_f32 v61, v122, v123
    v_cvt_pk_bf16_f32 v62, v124, v125
    v_mfma_f32_16x16x32_bf16 v[156:159], a[148:151], v[44:47], v[156:159]
    v_cvt_pk_bf16_f32 v63, v126, v127
    s_nop 1
    v_permlane16_swap_b32 v60, v62
    v_permlane16_swap_b32 v61, v63
    s_nop 1
    v_mfma_f32_16x16x32_bf16 v[128:131], a[152:155], v[48:51], v[128:131]
    v_mov_b32 v240, 0
    v_lshrrev_b32 v245, 2, v192
    v_mfma_f32_16x16x32_bf16 v[136:139], a[152:155], v[52:55], v[136:139]
    v_add_u32 v245, s8, v245
    v_lshrrev_b32 v246, 4, v192
    v_mfma_f32_16x16x32_bf16 v[144:147], a[152:155], v[56:59], v[144:147]
    v_and_b32 v244, 0x780, v193
    v_and_b32 v246, 0x30, v246
    v_mfma_f32_16x16x32_bf16 v[152:155], a[152:155], v[60:63], v[152:155]
    v_add_u32 v246, s8, v246
    v_lshlrev_b32 v203, 16, v203
    v_mfma_f32_16x16x32_bf16 v[132:135], a[156:159], v[48:51], v[132:135]
    buffer_load_dword v244, v244, s[68:71], s11 offen
    v_mfma_f32_16x16x32_bf16 v[140:143], a[156:159], v[52:55], v[140:143]
    ds_write_b32 v245, v203 offset:40704
    v_and_b32 v241, 0x70, v192
    v_mfma_f32_16x16x32_bf16 v[148:151], a[156:159], v[56:59], v[148:151]
    v_lshrrev_b32 v241, 1, v241
    v_mfma_f32_16x16x32_bf16 v[156:159], a[156:159], v[60:63], v[156:159]
    s_mov_b32 s12, 0x41800000
    ds_read_b128 a[192:195], v246 offset:40704
    ds_read_b128 a[196:199], v246 offset:40768
    ds_read_b128 a[200:203], v246 offset:40832
    ds_read_b128 a[204:207], v246 offset:40896
    ds_read_b128 a[208:211], v246 offset:40704
    ds_read_b128 a[212:215], v246 offset:40768
    v_mov_b32 v203, 0x3f803f80
    v_and_b32 v193, 0x780, v193
    v_max3_f32 v232, v128, v129, v130
    v_max3_f32 v232, v232, v131, v132
    v_max3_f32 v232, v232, v133, v134
    v_max_f32 v232, v232, v135
    v_max3_f32 v233, v136, v137, v138
    v_max3_f32 v233, v233, v139, v140
    v_max3_f32 v233, v233, v141, v142
    v_max_f32 v233, v233, v143
    v_max3_f32 v234, v144, v145, v146
    v_max3_f32 v234, v234, v147, v148
    v_max3_f32 v234, v234, v149, v150
    v_max_f32 v234, v234, v151
    v_max3_f32 v235, v152, v153, v154
    v_max3_f32 v235, v235, v155, v156
    v_max3_f32 v235, v235, v157, v158
    v_max_f32 v235, v235, v159
    v_mov_b32 v236, v232
    v_mov_b32 v237, v233
    v_mov_b32 v238, v234
    v_mov_b32 v239, v235
    v_permlane16_swap_b32 v236, v232
    v_permlane16_swap_b32 v237, v233
    v_permlane16_swap_b32 v238, v234
    v_permlane16_swap_b32 v239, v235
    v_max_f32 v232, v232, v236
    v_max_f32 v233, v233, v237
    v_max_f32 v234, v234, v238
    v_max_f32 v235, v235, v239
    v_mov_b32 v236, v232
    v_mov_b32 v237, v233
    v_mov_b32 v238, v234
    v_mov_b32 v239, v235
    v_permlane32_swap_b32 v236, v232
    v_permlane32_swap_b32 v237, v233
    v_permlane32_swap_b32 v238, v234
    v_permlane32_swap_b32 v239, v235
    v_max_f32 v232, v232, v236
    v_max_f32 v233, v233, v237
    v_max_f32 v234, v234, v238
    v_max_f32 v235, v235, v239
    v_add_f32 v232, s12, v232
    v_add_f32 v233, s12, v233
    v_add_f32 v234, s12, v234
    v_add_f32 v235, s12, v235
    v_sub_f32 v160, 0, v232
    v_sub_f32 v161, 0, v232
    v_sub_f32 v162, 0, v232
    v_sub_f32 v163, 0, v232
    v_sub_f32 v164, 0, v233
    v_sub_f32 v165, 0, v233
    v_sub_f32 v166, 0, v233
    v_sub_f32 v167, 0, v233
    v_sub_f32 v168, 0, v234
    v_sub_f32 v169, 0, v234
    v_sub_f32 v170, 0, v234
    v_sub_f32 v171, 0, v234
    v_sub_f32 v172, 0, v235
    v_sub_f32 v173, 0, v235
    v_sub_f32 v174, 0, v235
    v_sub_f32 v175, 0, v235
    s_waitcnt lgkmcnt(7)
    v_mfma_f32_16x16x32_bf16 v[64:67], a[160:163], v[0:3], v[160:163]
    ds_read_b128 a[128:131], v212 offset:20992
    v_sub_f32 v128, v128, v232
    v_exp_f32 v224, v128
    v_mfma_f32_16x16x32_bf16 v[72:75], a[160:163], v[4:7], v[164:167]
    v_sub_f32 v129, v129, v232
    v_exp_f32 v225, v129
    v_mfma_f32_16x16x32_bf16 v[80:83], a[160:163], v[8:11], v[168:171]
    ds_read_b128 a[132:135], v212 offset:61952
    v_cvt_pk_bf16_f32 v96, v224, v225
    v_mfma_f32_16x16x32_bf16 v[88:91], a[160:163], v[12:15], v[172:175]
    v_sub_f32 v130, v130, v232
    v_exp_f32 v226, v130
    v_mfma_f32_16x16x32_bf16 v[68:71], a[164:167], v[0:3], v[160:163]
    ds_read_b128 a[136:139], v212 offset:21056
    v_sub_f32 v131, v131, v232
    v_exp_f32 v227, v131
    v_mfma_f32_16x16x32_bf16 v[76:79], a[164:167], v[4:7], v[164:167]
    v_cvt_pk_bf16_f32 v97, v226, v227
    v_sub_f32 v132, v132, v232
    v_exp_f32 v228, v132
    v_mfma_f32_16x16x32_bf16 v[84:87], a[164:167], v[8:11], v[168:171]
    ds_read_b128 a[140:143], v212 offset:62016
    v_sub_f32 v133, v133, v232
    v_exp_f32 v229, v133
    v_mfma_f32_16x16x32_bf16 v[92:95], a[164:167], v[12:15], v[172:175]
    v_cvt_pk_bf16_f32 v98, v228, v229
    v_sub_f32 v134, v134, v232
    v_exp_f32 v224, v134
    v_mfma_f32_16x16x32_bf16 v[64:67], a[168:171], v[16:19], v[64:67]
    ds_read_b128 a[144:147], v212 offset:21120
    v_sub_f32 v135, v135, v232
    v_exp_f32 v225, v135
    v_mfma_f32_16x16x32_bf16 v[72:75], a[168:171], v[20:23], v[72:75]
    v_cvt_pk_bf16_f32 v99, v224, v225
    v_sub_f32 v136, v136, v233
    v_exp_f32 v226, v136
    v_mfma_f32_16x16x32_bf16 v[80:83], a[168:171], v[24:27], v[80:83]
    ds_read_b128 a[148:151], v212 offset:62080
    v_sub_f32 v137, v137, v233
    v_exp_f32 v227, v137
    v_mfma_f32_16x16x32_bf16 v[88:91], a[168:171], v[28:31], v[88:91]
    v_cvt_pk_bf16_f32 v100, v226, v227
    v_sub_f32 v138, v138, v233
    v_exp_f32 v228, v138
    v_mfma_f32_16x16x32_bf16 v[68:71], a[172:175], v[16:19], v[68:71]
    ds_read_b128 a[152:155], v212 offset:21184
    v_sub_f32 v139, v139, v233
    v_exp_f32 v229, v139
    v_mfma_f32_16x16x32_bf16 v[76:79], a[172:175], v[20:23], v[76:79]
    v_cvt_pk_bf16_f32 v101, v228, v229
    v_sub_f32 v140, v140, v233
    v_exp_f32 v224, v140
    v_mfma_f32_16x16x32_bf16 v[84:87], a[172:175], v[24:27], v[84:87]
    ds_read_b128 a[156:159], v212 offset:62144
    v_sub_f32 v141, v141, v233
    v_exp_f32 v225, v141
    v_mfma_f32_16x16x32_bf16 v[92:95], a[172:175], v[28:31], v[92:95]
    v_cvt_pk_bf16_f32 v102, v224, v225
    v_sub_f32 v142, v142, v233
    v_exp_f32 v226, v142
    v_sub_f32 v143, v143, v233
    v_exp_f32 v227, v143
    v_mfma_f32_16x16x32_bf16 v[64:67], a[176:179], v[32:35], v[64:67]
    v_add_u32 v211, 29440, v211
    v_cvt_pk_bf16_f32 v103, v226, v227
    v_mfma_f32_16x16x32_bf16 v[72:75], a[176:179], v[36:39], v[72:75]
    v_sub_f32 v144, v144, v234
    v_exp_f32 v228, v144
    v_sub_f32 v145, v145, v234
    v_exp_f32 v229, v145
    v_mfma_f32_16x16x32_bf16 v[80:83], a[176:179], v[40:43], v[80:83]
    v_add_u32 v212, 29440, v212
    v_cvt_pk_bf16_f32 v104, v228, v229
    v_mfma_f32_16x16x32_bf16 v[88:91], a[176:179], v[44:47], v[88:91]
    v_sub_f32 v146, v146, v234
    v_exp_f32 v224, v146
    v_sub_f32 v147, v147, v234
    v_exp_f32 v225, v147
    v_mfma_f32_16x16x32_bf16 v[68:71], a[180:183], v[32:35], v[68:71]
    v_cvt_pk_bf16_f32 v105, v224, v225
    v_sub_f32 v148, v148, v234
    v_exp_f32 v226, v148
    v_mfma_f32_16x16x32_bf16 v[76:79], a[180:183], v[36:39], v[76:79]
    v_sub_f32 v149, v149, v234
    v_exp_f32 v227, v149
    v_mfma_f32_16x16x32_bf16 v[84:87], a[180:183], v[40:43], v[84:87]
    v_cvt_pk_bf16_f32 v106, v226, v227
    v_sub_f32 v150, v150, v234
    v_exp_f32 v228, v150
    v_mfma_f32_16x16x32_bf16 v[92:95], a[180:183], v[44:47], v[92:95]
    v_sub_f32 v151, v151, v234
    v_exp_f32 v229, v151
    v_sub_f32 v152, v152, v235
    v_exp_f32 v224, v152
    v_mfma_f32_16x16x32_bf16 v[64:67], a[184:187], v[48:51], v[64:67]
    v_cvt_pk_bf16_f32 v107, v228, v229
    v_sub_f32 v153, v153, v235
    v_exp_f32 v225, v153
    v_mfma_f32_16x16x32_bf16 v[72:75], a[184:187], v[52:55], v[72:75]
    v_cvt_pk_bf16_f32 v108, v224, v225
    v_sub_f32 v154, v154, v235
    v_exp_f32 v226, v154
    v_mfma_f32_16x16x32_bf16 v[80:83], a[184:187], v[56:59], v[80:83]
    v_sub_f32 v155, v155, v235
    v_exp_f32 v227, v155
    v_mfma_f32_16x16x32_bf16 v[88:91], a[184:187], v[60:63], v[88:91]
    v_cvt_pk_bf16_f32 v109, v226, v227
    s_waitcnt vmcnt(9) lgkmcnt(0)
    s_barrier
    v_mfma_f32_16x16x32_bf16 v[68:71], a[188:191], v[48:51], v[68:71]
    v_sub_f32 v156, v156, v235
    v_exp_f32 v228, v156
    v_sub_f32 v157, v157, v235
    v_exp_f32 v229, v157
    v_mfma_f32_16x16x32_bf16 v[76:79], a[188:191], v[52:55], v[76:79]
    v_cvt_pk_bf16_f32 v110, v228, v229
    v_sub_f32 v158, v158, v235
    v_exp_f32 v224, v158
    v_mfma_f32_16x16x32_bf16 v[84:87], a[188:191], v[56:59], v[84:87]
    v_sub_f32 v159, v159, v235
    v_exp_f32 v225, v159
    v_mfma_f32_16x16x32_bf16 v[92:95], a[188:191], v[60:63], v[92:95]
    v_cvt_pk_bf16_f32 v111, v224, v225
    v_mfma_f32_16x16x32_bf16 v[128:131], a[128:131], v[0:3], v[160:163]
    v_cmp_eq_u32 vcc, 0, v216
    s_cbranch_vccnz L_tagwait
L_tagok:
    s_waitcnt vmcnt(1)
    s_mov_b64 exec, 1
    buffer_store_dwordx2 v[216:217], v240, s[72:75], s20 offen sc1
    s_mov_b64 exec, -1
    v_mfma_f32_16x16x32_bf16 v[136:139], a[128:131], v[4:7], v[164:167]
    v_bfe_u32 v245, v192, 8, 1
    v_mfma_f32_16x16x32_bf16 v[144:147], a[128:131], v[8:11], v[168:171]
    v_lshrrev_b32 v247, 9, v192
    v_exp_f32 v224, v64
    v_mfma_f32_16x16x32_bf16 v[152:155], a[128:131], v[12:15], v[172:175]
    ds_read_b64_tr_b16 a[160:161], v213 offset:0
    ds_read_b64_tr_b16 a[162:163], v213 offset:40960
    v_mfma_f32_16x16x32_bf16 v[132:135], a[132:135], v[0:3], v[160:163]
    s_add_u32 m0, s21, 0
    v_lshl_add_u32 v245, v245, 1, v247
    v_exp_f32 v225, v65
    v_mfma_f32_16x16x32_bf16 v[140:143], a[132:135], v[4:7], v[164:167]
    v_lshlrev_b32 v245, 4, v245
    v_cvt_pk_bf16_f32 v112, v224, v225
    v_mfma_f32_16x16x32_bf16 v[148:151], a[132:135], v[8:11], v[168:171]
    buffer_load_dwordx4 v208, s[56:59], s16 offen offset:0 lds
    v_mfma_f32_16x16x32_bf16 v[156:159], a[132:135], v[12:15], v[172:175]
    s_add_u32 m0, s21, 64
    v_and_b32 v247, 0xf0, v192
    v_exp_f32 v226, v66
    v_mfma_f32_16x16x32_bf16 v[128:131], a[136:139], v[16:19], v[128:131]
    ds_read_b64_tr_b16 a[164:165], v214 offset:0
    ds_read_b64_tr_b16 a[166:167], v214 offset:40960
    v_mfma_f32_16x16x32_bf16 v[136:139], a[136:139], v[20:23], v[136:139]
    v_lshl_add_u32 v247, v247, 6, v245
    v_exp_f32 v227, v67
    v_mfma_f32_16x16x32_bf16 v[144:147], a[136:139], v[24:27], v[144:147]
    s_lshl_b32 s9, s3, 14
    ds_read_b64_tr_b16 a[168:169], v213 offset:256
    ds_read_b64_tr_b16 a[170:171], v213 offset:41216
    v_mfma_f32_16x16x32_bf16 v[152:155], a[136:139], v[28:31], v[152:155]
    buffer_load_dwordx4 v208, s[56:59], s16 offen offset:1024 lds
    v_mfma_f32_16x16x32_bf16 v[132:135], a[140:143], v[16:19], v[132:135]
    s_lshl_b32 s31, s4, 16
    ds_read_b64_tr_b16 a[172:173], v214 offset:256
    ds_read_b64_tr_b16 a[174:175], v214 offset:41216
    v_mfma_f32_16x16x32_bf16 v[140:143], a[140:143], v[20:23], v[140:143]
    s_add_u32 s31, s31, s9
    ds_read_b64_tr_b16 a[176:177], v213 offset:512
    ds_read_b64_tr_b16 a[178:179], v213 offset:41472
    v_cvt_pk_bf16_f32 v113, v226, v227
    v_mfma_f32_16x16x32_bf16 v[148:151], a[140:143], v[24:27], v[148:151]
    s_add_u32 m0, s21, 128
    v_exp_f32 v228, v68
    v_mfma_f32_16x16x32_bf16 v[156:159], a[140:143], v[28:31], v[156:159]
    s_add_u32 s31, s31, s89
    v_exp_f32 v229, v69
    v_mfma_f32_16x16x32_bf16 v[128:131], a[144:147], v[32:35], v[128:131]
    buffer_load_dwordx4 v208, s[56:59], s16 offen offset:2048 lds
    v_cvt_pk_bf16_f32 v114, v228, v229
    v_mfma_f32_16x16x32_bf16 v[136:139], a[144:147], v[36:39], v[136:139]
    s_add_u32 m0, s21, 192
    ds_read_b64_tr_b16 a[180:181], v214 offset:512
    ds_read_b64_tr_b16 a[182:183], v214 offset:41472
    v_mfma_f32_16x16x32_bf16 v[144:147], a[144:147], v[40:43], v[144:147]
    buffer_load_dwordx4 v208, s[56:59], s16 offen offset:3072 lds
    v_or3_b32 v230, v112, v113, v114
    v_mfma_f32_16x16x32_bf16 v[152:155], a[144:147], v[44:47], v[152:155]
    s_add_u32 s16, s16, 0x4000
    v_exp_f32 v224, v70
    v_mfma_f32_16x16x32_bf16 v[132:135], a[148:151], v[32:35], v[132:135]
    s_and_b32 s16, s16, 0x1ffff
    ds_read_b64_tr_b16 a[184:185], v213 offset:768
    ds_read_b64_tr_b16 a[186:187], v213 offset:41728
    v_mfma_f32_16x16x32_bf16 v[140:143], a[148:151], v[36:39], v[140:143]
    v_exp_f32 v225, v71
    v_mfma_f32_16x16x32_bf16 v[148:151], a[148:151], v[40:43], v[148:151]
    s_sub_u32 s21, s22, s21
    v_exp_f32 v226, v72
    v_cvt_pk_bf16_f32 v115, v224, v225
    v_mfma_f32_16x16x32_bf16 v[156:159], a[148:151], v[44:47], v[156:159]
    ds_read_b64_tr_b16 a[188:189], v214 offset:768
    ds_read_b64_tr_b16 a[190:191], v214 offset:41728
    v_mfma_f32_16x16x32_bf16 v[128:131], a[152:155], v[48:51], v[128:131]
    s_add_u32 m0, s8, 37888
    v_exp_f32 v227, v73
    v_mfma_f32_16x16x32_bf16 v[136:139], a[152:155], v[52:55], v[136:139]
    v_exp_f32 v228, v74
    v_cvt_pk_bf16_f32 v116, v226, v227
    v_or3_b32 v230, v230, v115, v116
    v_mfma_f32_16x16x32_bf16 v[144:147], a[152:155], v[56:59], v[144:147]
    buffer_load_dwordx4 v247, s[44:47], s31 offen offset:0 lds
    v_mfma_f32_16x16x32_bf16 v[152:155], a[152:155], v[60:63], v[152:155]
    s_add_u32 m0, s8, 38848
    v_exp_f32 v229, v75
    v_mfma_f32_16x16x32_bf16 v[132:135], a[156:159], v[48:51], v[132:135]
    v_exp_f32 v224, v76
    v_cvt_pk_bf16_f32 v117, v228, v229
    v_mfma_f32_16x16x32_bf16 v[140:143], a[156:159], v[52:55], v[140:143]
    buffer_load_dwordx4 v247, s[44:47], s31 offen offset:64 lds
    v_mfma_f32_16x16x32_bf16 v[148:151], a[156:159], v[56:59], v[148:151]
    ds_read_b128 a[216:219], v246 offset:40832
    ds_read_b128 a[220:223], v246 offset:40896
    v_mfma_f32_16x16x32_bf16 v[156:159], a[156:159], v[60:63], v[156:159]
    s_add_u32 m0, s8, 0
    v_exp_f32 v225, v77
    v_mfma_f32_16x16x32_bf16 v[184:187], v[200:203], v[96:99], 0
    ds_read_b128 a[128:131], v211 offset:0
    v_cvt_pk_bf16_f32 v118, v224, v225
    v_or3_b32 v230, v230, v117, v118
    v_mfma_f32_16x16x32_bf16 v[188:191], v[200:203], v[100:103], 0
    buffer_load_dwordx4 v204, s[68:71], s41 offen offset:0 lds
    v_mfma_f32_16x16x32_bf16 v[196:199], v[200:203], v[104:107], 0
    v_exp_f32 v226, v78
    v_mfma_f32_16x16x32_bf16 v[218:221], v[200:203], v[108:111], 0
    s_waitcnt lgkmcnt(3)
    ds_read_b128 a[132:135], v211 offset:40960
    v_exp_f32 v227, v79
    v_mfma_f32_16x16x32_bf16 a[0:3], a[160:163], v[96:99], 0
    buffer_load_dwordx4 v205, s[68:71], s41 offen offset:1024 lds
    v_cvt_pk_bf16_f32 v119, v226, v227
    v_mfma_f32_16x16x32_bf16 a[8:11], a[160:163], v[100:103], 0
    s_add_u32 s41, s41, 0x4000
    ds_read_b128 a[224:227], v246 offset:40704
    ds_read_b128 a[228:231], v246 offset:40768
    v_mfma_f32_16x16x32_bf16 a[16:19], a[160:163], v[104:107], 0
    s_add_u32 m0, s8, 2048
    ds_read_b128 a[136:139], v211 offset:64
    v_exp_f32 v228, v80
    v_mfma_f32_16x16x32_bf16 a[24:27], a[160:163], v[108:111], 0
    v_exp_f32 v229, v81
    v_mfma_f32_16x16x32_bf16 a[4:7], a[164:167], v[96:99], 0
    buffer_load_dwordx4 v204, s[68:71], s41 offen offset:0 lds
    v_cvt_pk_bf16_f32 v120, v228, v229
    v_mfma_f32_16x16x32_bf16 a[12:15], a[164:167], v[100:103], 0
    v_exp_f32 v224, v82
    v_or3_b32 v230, v230, v119, v120
    v_mfma_f32_16x16x32_bf16 a[20:23], a[164:167], v[104:107], 0
    buffer_load_dwordx4 v205, s[68:71], s41 offen offset:1024 lds
    v_mfma_f32_16x16x32_bf16 a[28:31], a[164:167], v[108:111], 0
    ds_read_b128 a[140:143], v211 offset:41024
    v_exp_f32 v225, v83
    v_mfma_f32_16x16x32_bf16 a[32:35], a[168:171], v[96:99], 0
    s_add_u32 s41, s41, 0x4000
    ds_read_b128 a[232:235], v246 offset:40832
    ds_read_b128 a[236:239], v246 offset:40896
    v_mfma_f32_16x16x32_bf16 a[40:43], a[168:171], v[100:103], 0
    ds_read_b128 a[144:147], v211 offset:128
    v_cvt_pk_bf16_f32 v121, v224, v225
    v_mfma_f32_16x16x32_bf16 a[48:51], a[168:171], v[104:107], 0
    s_mov_b32 m0, s23
    v_exp_f32 v226, v84
    v_mfma_f32_16x16x32_bf16 a[56:59], a[168:171], v[108:111], 0
    v_exp_f32 v227, v85
    v_mfma_f32_16x16x32_bf16 a[36:39], a[172:175], v[96:99], 0
    buffer_load_dwordx4 v209, s[60:63], s17 offen offset:0 lds
    v_cvt_pk_bf16_f32 v122, v226, v227
    v_or3_b32 v230, v230, v121, v122
    v_mfma_f32_16x16x32_bf16 a[44:47], a[172:175], v[100:103], 0
    buffer_load_dwordx4 v210, s[60:63], s17 offen offset:1024 lds
    v_mfma_f32_16x16x32_bf16 a[52:55], a[172:175], v[104:107], 0
    ds_read_b128 a[148:151], v211 offset:41088
    v_exp_f32 v228, v86
    v_mfma_f32_16x16x32_bf16 a[60:63], a[172:175], v[108:111], 0
    buffer_load_dwordx4 v209, s[60:63], s17 offen offset:2048 lds
    v_mfma_f32_16x16x32_bf16 a[64:67], a[176:179], v[96:99], 0
    ds_read_b128 a[152:155], v211 offset:192
    v_exp_f32 v229, v87
    v_mfma_f32_16x16x32_bf16 a[72:75], a[176:179], v[100:103], 0
    buffer_load_dwordx4 v210, s[60:63], s17 offen offset:3072 lds
    v_mfma_f32_16x16x32_bf16 a[80:83], a[176:179], v[104:107], 0
    ds_read_b128 a[240:243], v246 offset:40704
    ds_read_b128 a[244:247], v246 offset:40768
    v_cvt_pk_bf16_f32 v123, v228, v229
    v_mfma_f32_16x16x32_bf16 a[88:91], a[176:179], v[108:111], 0
    s_add_u32 s17, s17, 0x4000
    ds_read_b128 a[156:159], v211 offset:41152
    v_exp_f32 v224, v88
    v_mfma_f32_16x16x32_bf16 a[68:71], a[180:183], v[96:99], 0
    ds_read_b128 a[248:251], v246 offset:40832
    ds_read_b128 a[252:255], v246 offset:40896
    v_mfma_f32_16x16x32_bf16 a[76:79], a[180:183], v[100:103], 0
    s_and_b32 s17, s17, 0x1ffff
    v_exp_f32 v225, v89
    v_mfma_f32_16x16x32_bf16 a[84:87], a[180:183], v[104:107], 0
    v_exp_f32 v226, v90
    v_mfma_f32_16x16x32_bf16 a[92:95], a[180:183], v[108:111], 0
    s_sub_u32 s23, s24, s23
    v_exp_f32 v227, v91
    v_cvt_pk_bf16_f32 v124, v224, v225
    v_mfma_f32_16x16x32_bf16 a[96:99], a[184:187], v[96:99], 0
    v_exp_f32 v228, v92
    v_mfma_f32_16x16x32_bf16 a[104:107], a[184:187], v[100:103], 0
    v_exp_f32 v229, v93
    v_or3_b32 v230, v230, v123, v124
    v_mfma_f32_16x16x32_bf16 a[112:115], a[184:187], v[104:107], 0
    v_exp_f32 v224, v94
    v_mfma_f32_16x16x32_bf16 a[120:123], a[184:187], v[108:111], 0
    v_exp_f32 v225, v95
    v_cvt_pk_bf16_f32 v125, v226, v227
    v_mfma_f32_16x16x32_bf16 a[100:103], a[188:191], v[96:99], 0
    v_cvt_pk_bf16_f32 v126, v228, v229
    v_or3_b32 v230, v230, v125, v126
    v_mfma_f32_16x16x32_bf16 a[108:111], a[188:191], v[100:103], 0
    v_cvt_pk_bf16_f32 v127, v224, v225
    v_or_b32 v230, v230, v127
    v_mfma_f32_16x16x32_bf16 a[116:119], a[188:191], v[104:107], 0
    v_and_b32 v230, s33, v230
    v_cmp_ne_u32 vcc, 0, v230
    s_cbranch_vccnz L_rarep00
L_backp00:
    v_mfma_f32_16x16x32_bf16 a[124:127], a[188:191], v[108:111], 0
    s_waitcnt lgkmcnt(2)
    v_mfma_f32_16x16x32_bf16 v[64:67], a[128:131], v[0:3], v[160:163]
    ds_read_b64_tr_b16 a[160:161], v215 offset:0
    ds_read_b64_tr_b16 a[162:163], v215 offset:40960
    v_mfma_f32_16x16x32_bf16 v[72:75], a[128:131], v[4:7], v[164:167]
    v_exp_f32 v224, v128
    v_mfma_f32_16x16x32_bf16 v[80:83], a[128:131], v[8:11], v[168:171]
    buffer_load_dwordx2 v[242:243], v241, s[72:75], s94 offen sc1
    v_mfma_f32_16x16x32_bf16 v[88:91], a[128:131], v[12:15], v[172:175]
    ds_read_b64_tr_b16 a[164:165], v223 offset:0
    ds_read_b64_tr_b16 a[166:167], v223 offset:40960
    v_mfma_f32_16x16x32_bf16 v[68:71], a[132:135], v[0:3], v[160:163]
    v_exp_f32 v225, v129
    v_mfma_f32_16x16x32_bf16 v[76:79], a[132:135], v[4:7], v[164:167]
    v_exp_f32 v226, v130
    v_cvt_pk_bf16_f32 v96, v224, v225
    v_mfma_f32_16x16x32_bf16 v[84:87], a[132:135], v[8:11], v[168:171]
    ds_read_b64_tr_b16 a[168:169], v215 offset:256
    ds_read_b64_tr_b16 a[170:171], v215 offset:41216
    v_mfma_f32_16x16x32_bf16 v[92:95], a[132:135], v[12:15], v[172:175]
    v_exp_f32 v227, v131
    v_mfma_f32_16x16x32_bf16 v[64:67], a[136:139], v[16:19], v[64:67]
    v_exp_f32 v228, v132
    v_cvt_pk_bf16_f32 v97, v226, v227
    v_mfma_f32_16x16x32_bf16 v[72:75], a[136:139], v[20:23], v[72:75]
    v_exp_f32 v229, v133
    v_mfma_f32_16x16x32_bf16 v[80:83], a[136:139], v[24:27], v[80:83]
    ds_read_b64_tr_b16 a[172:173], v223 offset:256
    ds_read_b64_tr_b16 a[174:175], v223 offset:41216
    v_cvt_pk_bf16_f32 v98, v228, v229
    v_mfma_f32_16x16x32_bf16 v[88:91], a[136:139], v[28:31], v[88:91]
    v_exp_f32 v224, v134
    v_or3_b32 v230, v96, v97, v98
    v_mfma_f32_16x16x32_bf16 v[68:71], a[140:143], v[16:19], v[68:71]
    v_exp_f32 v225, v135
    v_mfma_f32_16x16x32_bf16 v[76:79], a[140:143], v[20:23], v[76:79]
    ds_read_b64_tr_b16 a[176:177], v215 offset:512
    ds_read_b64_tr_b16 a[178:179], v215 offset:41472
    v_cvt_pk_bf16_f32 v99, v224, v225
    v_mfma_f32_16x16x32_bf16 v[84:87], a[140:143], v[24:27], v[84:87]
    v_exp_f32 v226, v136
    v_mfma_f32_16x16x32_bf16 v[92:95], a[140:143], v[28:31], v[92:95]
    v_exp_f32 v227, v137
    v_mfma_f32_16x16x32_bf16 v[64:67], a[144:147], v[32:35], v[64:67]
    ds_read_b64_tr_b16 a[180:181], v223 offset:512
    ds_read_b64_tr_b16 a[182:183], v223 offset:41472
    v_cvt_pk_bf16_f32 v100, v226, v227
    v_mfma_f32_16x16x32_bf16 v[72:75], a[144:147], v[36:39], v[72:75]
    v_exp_f32 v228, v138
    v_mfma_f32_16x16x32_bf16 v[80:83], a[144:147], v[40:43], v[80:83]
    v_exp_f32 v229, v139
    v_or3_b32 v230, v230, v99, v100
    v_mfma_f32_16x16x32_bf16 v[88:91], a[144:147], v[44:47], v[88:91]
    v_exp_f32 v224, v140
    v_mfma_f32_16x16x32_bf16 v[68:71], a[148:151], v[32:35], v[68:71]
    ds_read_b64_tr_b16 a[184:185], v215 offset:768
    ds_read_b64_tr_b16 a[186:187], v215 offset:41728
    v_cvt_pk_bf16_f32 v101, v228, v229
    v_mfma_f32_16x16x32_bf16 v[76:79], a[148:151], v[36:39], v[76:79]
    v_exp_f32 v225, v141
    v_mfma_f32_16x16x32_bf16 v[84:87], a[148:151], v[40:43], v[84:87]
    v_exp_f32 v226, v142
    v_cvt_pk_bf16_f32 v102, v224, v225
    v_mfma_f32_16x16x32_bf16 v[92:95], a[148:151], v[44:47], v[92:95]
    ds_read_b64_tr_b16 a[188:189], v223 offset:768
    ds_read_b64_tr_b16 a[190:191], v223 offset:41728
    v_mfma_f32_16x16x32_bf16 v[64:67], a[152:155], v[48:51], v[64:67]
    v_exp_f32 v227, v143
    v_mfma_f32_16x16x32_bf16 v[72:75], a[152:155], v[52:55], v[72:75]
    v_exp_f32 v228, v144
    v_or3_b32 v230, v230, v101, v102
    v_mfma_f32_16x16x32_bf16 v[80:83], a[152:155], v[56:59], v[80:83]
    v_exp_f32 v229, v145
    v_mfma_f32_16x16x32_bf16 v[88:91], a[152:155], v[60:63], v[88:91]
    v_exp_f32 v224, v146
    v_cvt_pk_bf16_f32 v103, v226, v227
    v_mfma_f32_16x16x32_bf16 v[68:71], a[156:159], v[48:51], v[68:71]
    v_exp_f32 v225, v147
    v_mfma_f32_16x16x32_bf16 v[76:79], a[156:159], v[52:55], v[76:79]
    v_exp_f32 v226, v148
    v_cvt_pk_bf16_f32 v104, v228, v229
    v_mfma_f32_16x16x32_bf16 v[84:87], a[156:159], v[56:59], v[84:87]
    v_exp_f32 v227, v149
    v_mfma_f32_16x16x32_bf16 v[92:95], a[156:159], v[60:63], v[92:95]
    v_exp_f32 v228, v150
    v_or3_b32 v230, v230, v103, v104
    v_mfma_f32_16x16x32_bf16 v[184:187], v[200:203], v[112:115], v[184:187]
    s_waitcnt vmcnt(0)
    v_cmp_ne_u64 vcc, v[242:243], v[216:217]
    s_cbranch_vccnz L_hwait
L_hok:
    v_mfma_f32_16x16x32_bf16 v[188:191], v[200:203], v[116:119], v[188:191]
    buffer_load_dwordx4 v[248:251], v192, s[72:75], s95 offen offset:0 sc1
    v_mfma_f32_16x16x32_bf16 v[196:199], v[200:203], v[120:123], v[196:199]
    buffer_load_dwordx4 v[252:255], v192, s[72:75], s95 offen offset:1024 sc1
    v_cvt_pk_bf16_f32 v105, v224, v225
    v_mfma_f32_16x16x32_bf16 v[218:221], v[200:203], v[124:127], v[218:221]
    s_waitcnt vmcnt(7) lgkmcnt(0)
    ds_read_b128 a[128:131], v212 offset:0
    v_add_u32 v213, s26, v213
    v_mfma_f32_16x16x32_bf16 a[0:3], a[160:163], v[112:115], a[0:3]
    buffer_load_dwordx4 v[176:179], v192, s[72:75], s95 offen offset:2048 sc1
    v_cvt_pk_bf16_f32 v106, v226, v227
    v_mfma_f32_16x16x32_bf16 a[8:11], a[160:163], v[116:119], a[8:11]
    buffer_load_dwordx4 v[180:183], v192, s[72:75], s95 offen offset:3072 sc1
    v_mfma_f32_16x16x32_bf16 a[16:19], a[160:163], v[120:123], a[16:19]
    s_add_u32 s95, s95, 4096
    ds_read_b128 a[132:135], v212 offset:40960
    v_add_u32 v214, s26, v214
    v_or3_b32 v230, v230, v105, v106
    v_mfma_f32_16x16x32_bf16 a[24:27], a[160:163], v[124:127], a[24:27]
    s_add_u32 m0, s8, 4096
    ds_read_b128 a[136:139], v212 offset:64
    v_exp_f32 v229, v151
    v_mfma_f32_16x16x32_bf16 a[4:7], a[164:167], v[112:115], a[4:7]
    buffer_load_dwordx4 v204, s[68:71], s41 offen offset:0 lds
    v_mfma_f32_16x16x32_bf16 a[12:15], a[164:167], v[116:119], a[12:15]
    buffer_load_dwordx4 v205, s[68:71], s41 offen offset:1024 lds
    v_mfma_f32_16x16x32_bf16 a[20:23], a[164:167], v[120:123], a[20:23]
    s_add_u32 s41, s41, 0x4000
    ds_read_b128 a[140:143], v212 offset:41024
    v_add_u32 v215, s26, v215
    v_mfma_f32_16x16x32_bf16 a[28:31], a[164:167], v[124:127], a[28:31]
    s_add_u32 m0, s8, 6144
    ds_read_b128 a[144:147], v212 offset:128
    v_cvt_pk_bf16_f32 v107, v228, v229
    v_mfma_f32_16x16x32_bf16 a[32:35], a[168:171], v[112:115], a[32:35]
    buffer_load_dwordx4 v204, s[68:71], s41 offen offset:0 lds
    v_mfma_f32_16x16x32_bf16 a[40:43], a[168:171], v[116:119], a[40:43]
    buffer_load_dwordx4 v205, s[68:71], s41 offen offset:1024 lds
    v_mfma_f32_16x16x32_bf16 a[48:51], a[168:171], v[120:123], a[48:51]
    s_add_u32 s41, s41, 0x4000
    ds_read_b128 a[148:151], v212 offset:41088
    v_exp_f32 v224, v152
    v_mfma_f32_16x16x32_bf16 a[56:59], a[168:171], v[124:127], a[56:59]
    ds_read_b128 a[152:155], v212 offset:192
    v_exp_f32 v225, v153
    v_mfma_f32_16x16x32_bf16 a[36:39], a[172:175], v[112:115], a[36:39]
    ds_read_b128 a[156:159], v212 offset:41152
    v_add_u32 v223, s26, v223
    v_cvt_pk_bf16_f32 v108, v224, v225
    v_mfma_f32_16x16x32_bf16 a[44:47], a[172:175], v[116:119], a[44:47]
    ds_read_b64_tr_b16 v[232:233], v206 offset:0
    v_or3_b32 v230, v230, v107, v108
    v_mfma_f32_16x16x32_bf16 a[52:55], a[172:175], v[120:123], a[52:55]
    ds_read_b64_tr_b16 v[234:235], v206 offset:2048
    v_exp_f32 v226, v154
    v_mfma_f32_16x16x32_bf16 a[60:63], a[172:175], v[124:127], a[60:63]
    ds_read_b64_tr_b16 v[236:237], v207 offset:0
    v_add_u32 v211, s25, v211
    v_mfma_f32_16x16x32_bf16 a[64:67], a[176:179], v[112:115], a[64:67]
    ds_read_b64_tr_b16 v[238:239], v207 offset:2048
    v_exp_f32 v227, v155
    v_mfma_f32_16x16x32_bf16 a[72:75], a[176:179], v[116:119], a[72:75]
    s_sub_u32 s26, 0, s26
    ds_read_b64_tr_b16 v[240:241], v206 offset:256
    v_cvt_pk_bf16_f32 v109, v226, v227
    v_mfma_f32_16x16x32_bf16 a[80:83], a[176:179], v[120:123], a[80:83]
    ds_read_b64_tr_b16 v[242:243], v206 offset:2304
    v_exp_f32 v228, v156
    v_mfma_f32_16x16x32_bf16 a[88:91], a[176:179], v[124:127], a[88:91]
    ds_read_b64_tr_b16 v[244:245], v207 offset:256
    v_exp_f32 v229, v157
    v_mfma_f32_16x16x32_bf16 a[68:71], a[180:183], v[112:115], a[68:71]
    ds_read_b64_tr_b16 v[246:247], v207 offset:2304
    v_add_u32 v212, s25, v212
    v_mfma_f32_16x16x32_bf16 a[76:79], a[180:183], v[116:119], a[76:79]
    v_exp_f32 v224, v158
    v_mfma_f32_16x16x32_bf16 a[84:87], a[180:183], v[120:123], a[84:87]
    v_exp_f32 v225, v159
    v_mfma_f32_16x16x32_bf16 a[92:95], a[180:183], v[124:127], a[92:95]
    s_waitcnt vmcnt(9) lgkmcnt(8)
    v_cvt_pk_bf16_f32 v110, v228, v229
    s_barrier
    v_mfma_f32_16x16x32_bf16 a[96:99], a[184:187], v[112:115], a[96:99]
    ds_read_b64_tr_b16 a[160:161], v213 offset:0
    ds_read_b64_tr_b16 a[162:163], v213 offset:40960
    v_mfma_f32_16x16x32_bf16 a[104:107], a[184:187], v[116:119], a[104:107]
    s_sub_u32 s25, 0, s25
    ds_read_b64_tr_b16 a[164:165], v214 offset:0
    v_or3_b32 v230, v230, v109, v110
    v_cvt_pk_bf16_f32 v111, v224, v225
    v_mfma_f32_16x16x32_bf16 a[112:115], a[184:187], v[120:123], a[112:115]
    ds_read_b64_tr_b16 a[166:167], v214 offset:40960
    v_or_b32 v230, v230, v111
    v_mfma_f32_16x16x32_bf16 a[120:123], a[184:187], v[124:127], a[120:123]
    ds_read_b64_tr_b16 a[168:169], v213 offset:256
    v_and_b32 v230, s33, v230
    v_cmp_ne_u32 vcc, 0, v230
    v_mfma_f32_16x16x32_bf16 a[100:103], a[188:191], v[112:115], a[100:103]
    ds_read_b64_tr_b16 a[170:171], v213 offset:41216
    s_cbranch_vccnz L_rarep01
L_backp01:
    v_mfma_f32_16x16x32_bf16 a[108:111], a[188:191], v[116:119], a[108:111]
    ds_read_b64_tr_b16 a[172:173], v214 offset:256
    v_mfma_f32_16x16x32_bf16 a[116:119], a[188:191], v[120:123], a[116:119]
    ds_read_b64_tr_b16 a[174:175], v214 offset:41216
    v_mfma_f32_16x16x32_bf16 a[124:127], a[188:191], v[124:127], a[124:127]
    s_waitcnt vmcnt(4) lgkmcnt(8)
    .p2align 3
L_attn:
    v_mfma_f32_16x16x32_bf16 a[192:195], v[232:235], v[248:251], a[192:195]
    ds_read_b64_tr_b16 a[176:177], v213 offset:512
    ds_read_b64_tr_b16 a[178:179], v213 offset:41472
    v_mfma_f32_16x16x32_bf16 a[208:211], v[232:235], v[252:255], a[208:211]
    v_exp_f32 v224, v64
    v_mfma_f32_16x16x32_bf16 a[224:227], v[232:235], v[176:179], a[224:227]
    v_exp_f32 v225, v65
    v_mfma_f32_16x16x32_bf16 a[240:243], v[232:235], v[180:183], a[240:243]
    v_exp_f32 v226, v66
    v_mfma_f32_16x16x32_bf16 a[196:199], v[236:239], v[248:251], a[196:199]
    v_exp_f32 v227, v67
    v_mfma_f32_16x16x32_bf16 a[212:215], v[236:239], v[252:255], a[212:215]
    v_exp_f32 v228, v68
    v_mfma_f32_16x16x32_bf16 a[228:231], v[236:239], v[176:179], a[228:231]
    v_exp_f32 v229, v69
    v_mfma_f32_16x16x32_bf16 a[244:247], v[236:239], v[180:183], a[244:247]
    v_cvt_pk_bf16_f32 v112, v224, v225
    v_cvt_pk_bf16_f32 v113, v226, v227
    v_mfma_f32_16x16x32_bf16 a[200:203], v[240:243], v[248:251], a[200:203]
    v_exp_f32 v224, v70
    v_mfma_f32_16x16x32_bf16 a[216:219], v[240:243], v[252:255], a[216:219]
    v_exp_f32 v225, v71
    v_mfma_f32_16x16x32_bf16 a[232:235], v[240:243], v[176:179], a[232:235]
    ds_read_b64_tr_b16 a[180:181], v214 offset:512
    ds_read_b64_tr_b16 a[182:183], v214 offset:41472
    v_mfma_f32_16x16x32_bf16 a[248:251], v[240:243], v[180:183], a[248:251]
    v_exp_f32 v226, v72
    v_mfma_f32_16x16x32_bf16 a[204:207], v[244:247], v[248:251], a[204:207]
    v_exp_f32 v227, v73
    v_mfma_f32_16x16x32_bf16 a[220:223], v[244:247], v[252:255], a[220:223]
    v_cvt_pk_bf16_f32 v114, v228, v229
    v_or3_b32 v230, v112, v113, v114
    v_mfma_f32_16x16x32_bf16 a[236:239], v[244:247], v[176:179], a[236:239]
    v_exp_f32 v228, v74
    v_mfma_f32_16x16x32_bf16 a[252:255], v[244:247], v[180:183], a[252:255]
    v_exp_f32 v229, v75
    v_mfma_f32_16x16x32_bf16 v[128:131], a[128:131], v[0:3], v[160:163]
    buffer_load_dwordx4 v[248:251], v192, s[72:75], s95 offen offset:0 sc1
    v_mfma_f32_16x16x32_bf16 v[136:139], a[128:131], v[4:7], v[164:167]
    buffer_load_dwordx4 v[252:255], v192, s[72:75], s95 offen offset:1024 sc1
    v_mfma_f32_16x16x32_bf16 v[144:147], a[128:131], v[8:11], v[168:171]
    v_cvt_pk_bf16_f32 v115, v224, v225
    v_cvt_pk_bf16_f32 v116, v226, v227
    v_mfma_f32_16x16x32_bf16 v[152:155], a[128:131], v[12:15], v[172:175]
    buffer_load_dwordx4 v[176:179], v192, s[72:75], s95 offen offset:2048 sc1
    v_mfma_f32_16x16x32_bf16 v[132:135], a[132:135], v[0:3], v[160:163]
    buffer_load_dwordx4 v[180:183], v192, s[72:75], s95 offen offset:3072 sc1
    v_mfma_f32_16x16x32_bf16 v[140:143], a[132:135], v[4:7], v[164:167]
    ds_read_b64_tr_b16 a[184:185], v213 offset:768
    ds_read_b64_tr_b16 a[186:187], v213 offset:41728
    v_mfma_f32_16x16x32_bf16 v[148:151], a[132:135], v[8:11], v[168:171]
    s_add_u32 s95, s95, 4096
    v_exp_f32 v224, v76
    v_mfma_f32_16x16x32_bf16 v[156:159], a[132:135], v[12:15], v[172:175]
    v_exp_f32 v225, v77
    v_mfma_f32_16x16x32_bf16 v[128:131], a[136:139], v[16:19], v[128:131]
    s_add_u32 m0, s8, 0
    v_exp_f32 v226, v78
    v_mfma_f32_16x16x32_bf16 v[136:139], a[136:139], v[20:23], v[136:139]
    v_exp_f32 v227, v79
    v_mfma_f32_16x16x32_bf16 v[144:147], a[136:139], v[24:27], v[144:147]
    buffer_load_dwordx4 v204, s[68:71], s41 offen offset:0 lds
    v_mfma_f32_16x16x32_bf16 v[152:155], a[136:139], v[28:31], v[152:155]
    v_or3_b32 v230, v230, v115, v116
    v_cvt_pk_bf16_f32 v117, v228, v229
    v_mfma_f32_16x16x32_bf16 v[132:135], a[140:143], v[16:19], v[132:135]
    buffer_load_dwordx4 v205, s[68:71], s41 offen offset:1024 lds
    v_mfma_f32_16x16x32_bf16 v[140:143], a[140:143], v[20:23], v[140:143]
    v_exp_f32 v228, v80
    v_mfma_f32_16x16x32_bf16 v[148:151], a[140:143], v[24:27], v[148:151]
    s_add_u32 s41, s41, 0x4000
    v_exp_f32 v229, v81
    v_mfma_f32_16x16x32_bf16 v[156:159], a[140:143], v[28:31], v[156:159]
    v_cvt_pk_bf16_f32 v118, v224, v225
    v_or3_b32 v230, v230, v117, v118
    v_mfma_f32_16x16x32_bf16 v[128:131], a[144:147], v[32:35], v[128:131]
    s_add_u32 m0, s8, 2048
    ds_read_b64_tr_b16 a[188:189], v214 offset:768
    ds_read_b64_tr_b16 a[190:191], v214 offset:41728
    v_mfma_f32_16x16x32_bf16 v[136:139], a[144:147], v[36:39], v[136:139]
    v_exp_f32 v224, v82
    v_mfma_f32_16x16x32_bf16 v[144:147], a[144:147], v[40:43], v[144:147]
    buffer_load_dwordx4 v204, s[68:71], s41 offen offset:0 lds
    v_mfma_f32_16x16x32_bf16 v[152:155], a[144:147], v[44:47], v[152:155]
    v_exp_f32 v225, v83
    v_mfma_f32_16x16x32_bf16 v[132:135], a[148:151], v[32:35], v[132:135]
    buffer_load_dwordx4 v205, s[68:71], s41 offen offset:1024 lds
    v_mfma_f32_16x16x32_bf16 v[140:143], a[148:151], v[36:39], v[140:143]
    v_cvt_pk_bf16_f32 v119, v226, v227
    v_cvt_pk_bf16_f32 v120, v228, v229
    v_mfma_f32_16x16x32_bf16 v[148:151], a[148:151], v[40:43], v[148:151]
    s_add_u32 s41, s41, 0x4000
    v_exp_f32 v226, v84
    v_mfma_f32_16x16x32_bf16 v[156:159], a[148:151], v[44:47], v[156:159]
    v_exp_f32 v227, v85
    v_mfma_f32_16x16x32_bf16 v[128:131], a[152:155], v[48:51], v[128:131]
    s_add_u32 m0, s21, 0
    v_exp_f32 v228, v86
    v_mfma_f32_16x16x32_bf16 v[136:139], a[152:155], v[52:55], v[136:139]
    v_exp_f32 v229, v87
    v_mfma_f32_16x16x32_bf16 v[144:147], a[152:155], v[56:59], v[144:147]
    v_or3_b32 v230, v230, v119, v120
    v_cvt_pk_bf16_f32 v121, v224, v225
    v_mfma_f32_16x16x32_bf16 v[152:155], a[152:155], v[60:63], v[152:155]
    buffer_load_dwordx4 v208, s[56:59], s16 offen offset:0 lds
    v_mfma_f32_16x16x32_bf16 v[132:135], a[156:159], v[48:51], v[132:135]
    v_exp_f32 v224, v88
    v_mfma_f32_16x16x32_bf16 v[140:143], a[156:159], v[52:55], v[140:143]
    s_add_u32 m0, s21, 64
    v_exp_f32 v225, v89
    v_mfma_f32_16x16x32_bf16 v[148:151], a[156:159], v[56:59], v[148:151]
    v_cvt_pk_bf16_f32 v122, v226, v227
    v_or3_b32 v230, v230, v121, v122
    v_mfma_f32_16x16x32_bf16 v[156:159], a[156:159], v[60:63], v[156:159]
    buffer_load_dwordx4 v208, s[56:59], s16 offen offset:1024 lds
    v_mfma_f32_16x16x32_bf16 v[184:187], v[200:203], v[96:99], v[184:187]
    ds_read_b128 a[128:131], v211 offset:0
    v_cvt_pk_bf16_f32 v123, v228, v229
    v_mfma_f32_16x16x32_bf16 v[188:191], v[200:203], v[100:103], v[188:191]
    s_add_u32 m0, s21, 128
    v_exp_f32 v226, v90
    v_mfma_f32_16x16x32_bf16 v[196:199], v[200:203], v[104:107], v[196:199]
    v_exp_f32 v227, v91
    v_mfma_f32_16x16x32_bf16 v[218:221], v[200:203], v[108:111], v[218:221]
    s_waitcnt vmcnt(10) lgkmcnt(1)
    ds_read_b128 a[132:135], v211 offset:40960
    v_cvt_pk_bf16_f32 v124, v224, v225
    v_mfma_f32_16x16x32_bf16 a[0:3], a[160:163], v[96:99], a[0:3]
    buffer_load_dwordx4 v208, s[56:59], s16 offen offset:2048 lds
    v_mfma_f32_16x16x32_bf16 a[8:11], a[160:163], v[100:103], a[8:11]
    s_add_u32 m0, s21, 192
    ds_read_b64_tr_b16 v[232:233], v206 offset:4096
    v_or3_b32 v230, v230, v123, v124
    v_mfma_f32_16x16x32_bf16 a[16:19], a[160:163], v[104:107], a[16:19]
    ds_read_b64_tr_b16 v[234:235], v206 offset:6144
    v_cvt_pk_bf16_f32 v125, v226, v227
    v_mfma_f32_16x16x32_bf16 a[24:27], a[160:163], v[108:111], a[24:27]
    buffer_load_dwordx4 v208, s[56:59], s16 offen offset:3072 lds
    v_mfma_f32_16x16x32_bf16 a[4:7], a[164:167], v[96:99], a[4:7]
    ds_read_b128 a[136:139], v211 offset:64
    v_mfma_f32_16x16x32_bf16 a[12:15], a[164:167], v[100:103], a[12:15]
    s_add_u32 s16, s16, 0x4000
    ds_read_b64_tr_b16 v[236:237], v207 offset:4096
    v_mfma_f32_16x16x32_bf16 a[20:23], a[164:167], v[104:107], a[20:23]
    ds_read_b128 a[140:143], v211 offset:41024
    v_mfma_f32_16x16x32_bf16 a[28:31], a[164:167], v[108:111], a[28:31]
    s_and_b32 s16, s16, 0x1ffff
    v_exp_f32 v228, v92
    v_mfma_f32_16x16x32_bf16 a[32:35], a[168:171], v[96:99], a[32:35]
    ds_read_b64_tr_b16 v[238:239], v207 offset:6144
    v_mfma_f32_16x16x32_bf16 a[40:43], a[168:171], v[100:103], a[40:43]
    ds_read_b128 a[144:147], v211 offset:128
    v_mfma_f32_16x16x32_bf16 a[48:51], a[168:171], v[104:107], a[48:51]
    s_sub_u32 s21, s22, s21
    v_exp_f32 v229, v93
    v_mfma_f32_16x16x32_bf16 a[56:59], a[168:171], v[108:111], a[56:59]
    ds_read_b64_tr_b16 v[240:241], v206 offset:4352
    v_cvt_pk_bf16_f32 v126, v228, v229
    v_mfma_f32_16x16x32_bf16 a[36:39], a[172:175], v[96:99], a[36:39]
    s_mov_b32 m0, s23
    ds_read_b128 a[148:151], v211 offset:41088
    v_or3_b32 v230, v230, v125, v126
    v_mfma_f32_16x16x32_bf16 a[44:47], a[172:175], v[100:103], a[44:47]
    v_exp_f32 v224, v94
    v_mfma_f32_16x16x32_bf16 a[52:55], a[172:175], v[104:107], a[52:55]
    buffer_load_dwordx4 v209, s[60:63], s17 offen offset:0 lds
    v_mfma_f32_16x16x32_bf16 a[60:63], a[172:175], v[108:111], a[60:63]
    ds_read_b64_tr_b16 v[242:243], v206 offset:6400
    v_mfma_f32_16x16x32_bf16 a[64:67], a[176:179], v[96:99], a[64:67]
    buffer_load_dwordx4 v210, s[60:63], s17 offen offset:1024 lds
    v_mfma_f32_16x16x32_bf16 a[72:75], a[176:179], v[100:103], a[72:75]
    ds_read_b64_tr_b16 v[244:245], v207 offset:4352
    v_mfma_f32_16x16x32_bf16 a[80:83], a[176:179], v[104:107], a[80:83]
    buffer_load_dwordx4 v209, s[60:63], s17 offen offset:2048 lds
    v_mfma_f32_16x16x32_bf16 a[88:91], a[176:179], v[108:111], a[88:91]
    ds_read_b128 a[152:155], v211 offset:192
    v_mfma_f32_16x16x32_bf16 a[68:71], a[180:183], v[96:99], a[68:71]
    buffer_load_dwordx4 v210, s[60:63], s17 offen offset:3072 lds
    v_mfma_f32_16x16x32_bf16 a[76:79], a[180:183], v[100:103], a[76:79]
    ds_read_b64_tr_b16 v[246:247], v207 offset:6400
    v_mfma_f32_16x16x32_bf16 a[84:87], a[180:183], v[104:107], a[84:87]
    s_add_u32 s17, s17, 0x4000
    ds_read_b128 a[156:159], v211 offset:41152
    v_mfma_f32_16x16x32_bf16 a[92:95], a[180:183], v[108:111], a[92:95]
    v_exp_f32 v225, v95
    v_mfma_f32_16x16x32_bf16 a[96:99], a[184:187], v[96:99], a[96:99]
    s_and_b32 s17, s17, 0x1ffff
    v_cvt_pk_bf16_f32 v127, v224, v225
    v_or_b32 v230, v230, v127
    v_mfma_f32_16x16x32_bf16 a[104:107], a[184:187], v[100:103], a[104:107]
    v_and_b32 v230, s33, v230
    v_cmp_ne_u32 vcc, 0, v230
    v_mfma_f32_16x16x32_bf16 a[112:115], a[184:187], v[104:107], a[112:115]
    s_sub_u32 s23, s24, s23
    s_cbranch_vccnz L_rarel0
L_backl0:
    v_mfma_f32_16x16x32_bf16 a[120:123], a[184:187], v[108:111], a[120:123]
    v_mfma_f32_16x16x32_bf16 a[100:103], a[188:191], v[96:99], a[100:103]
    v_mfma_f32_16x16x32_bf16 a[108:111], a[188:191], v[100:103], a[108:111]
    v_mfma_f32_16x16x32_bf16 a[116:119], a[188:191], v[104:107], a[116:119]
    v_mfma_f32_16x16x32_bf16 a[124:127], a[188:191], v[108:111], a[124:127]
    s_waitcnt vmcnt(12) lgkmcnt(0)
    v_mfma_f32_16x16x32_bf16 a[192:195], v[232:235], v[248:251], a[192:195]
    ds_read_b64_tr_b16 a[160:161], v215 offset:0
    ds_read_b64_tr_b16 a[162:163], v215 offset:40960
    v_mfma_f32_16x16x32_bf16 a[208:211], v[232:235], v[252:255], a[208:211]
    v_exp_f32 v224, v128
    v_mfma_f32_16x16x32_bf16 a[224:227], v[232:235], v[176:179], a[224:227]
    v_exp_f32 v225, v129
    v_mfma_f32_16x16x32_bf16 a[240:243], v[232:235], v[180:183], a[240:243]
    v_exp_f32 v226, v130
    v_mfma_f32_16x16x32_bf16 a[196:199], v[236:239], v[248:251], a[196:199]
    v_exp_f32 v227, v131
    v_mfma_f32_16x16x32_bf16 a[212:215], v[236:239], v[252:255], a[212:215]
    ds_read_b64_tr_b16 a[164:165], v223 offset:0
    ds_read_b64_tr_b16 a[166:167], v223 offset:40960
    v_mfma_f32_16x16x32_bf16 a[228:231], v[236:239], v[176:179], a[228:231]
    v_exp_f32 v228, v132
    v_mfma_f32_16x16x32_bf16 a[244:247], v[236:239], v[180:183], a[244:247]
    v_exp_f32 v229, v133
    v_mfma_f32_16x16x32_bf16 a[200:203], v[240:243], v[248:251], a[200:203]
    v_cvt_pk_bf16_f32 v96, v224, v225
    v_cvt_pk_bf16_f32 v97, v226, v227
    v_mfma_f32_16x16x32_bf16 a[216:219], v[240:243], v[252:255], a[216:219]
    v_exp_f32 v224, v134
    v_mfma_f32_16x16x32_bf16 a[232:235], v[240:243], v[176:179], a[232:235]
    ds_read_b64_tr_b16 a[168:169], v215 offset:256
    ds_read_b64_tr_b16 a[170:171], v215 offset:41216
    v_mfma_f32_16x16x32_bf16 a[248:251], v[240:243], v[180:183], a[248:251]
    v_exp_f32 v225, v135
    v_mfma_f32_16x16x32_bf16 a[204:207], v[244:247], v[248:251], a[204:207]
    v_exp_f32 v226, v136
    v_mfma_f32_16x16x32_bf16 a[220:223], v[244:247], v[252:255], a[220:223]
    v_exp_f32 v227, v137
    v_mfma_f32_16x16x32_bf16 a[236:239], v[244:247], v[176:179], a[236:239]
    v_cvt_pk_bf16_f32 v98, v228, v229
    v_or3_b32 v230, v96, v97, v98
    v_mfma_f32_16x16x32_bf16 a[252:255], v[244:247], v[180:183], a[252:255]
    v_exp_f32 v228, v138
    v_mfma_f32_16x16x32_bf16 v[64:67], a[128:131], v[0:3], v[160:163]
    buffer_load_dwordx4 v[248:251], v192, s[72:75], s95 offen offset:0 sc1
    v_mfma_f32_16x16x32_bf16 v[72:75], a[128:131], v[4:7], v[164:167]
    buffer_load_dwordx4 v[252:255], v192, s[72:75], s95 offen offset:1024 sc1
    v_mfma_f32_16x16x32_bf16 v[80:83], a[128:131], v[8:11], v[168:171]
    ds_read_b64_tr_b16 a[172:173], v223 offset:256
    ds_read_b64_tr_b16 a[174:175], v223 offset:41216
    v_mfma_f32_16x16x32_bf16 v[88:91], a[128:131], v[12:15], v[172:175]
    buffer_load_dwordx4 v[176:179], v192, s[72:75], s95 offen offset:2048 sc1
    v_mfma_f32_16x16x32_bf16 v[68:71], a[132:135], v[0:3], v[160:163]
    buffer_load_dwordx4 v[180:183], v192, s[72:75], s95 offen offset:3072 sc1
    v_mfma_f32_16x16x32_bf16 v[76:79], a[132:135], v[4:7], v[164:167]
    ds_read_b64_tr_b16 a[176:177], v215 offset:512
    ds_read_b64_tr_b16 a[178:179], v215 offset:41472
    v_mfma_f32_16x16x32_bf16 v[84:87], a[132:135], v[8:11], v[168:171]
    s_add_u32 s95, s95, 4096
    v_exp_f32 v229, v139
    v_mfma_f32_16x16x32_bf16 v[92:95], a[132:135], v[12:15], v[172:175]
    v_cvt_pk_bf16_f32 v99, v224, v225
    v_cvt_pk_bf16_f32 v100, v226, v227
    v_mfma_f32_16x16x32_bf16 v[64:67], a[136:139], v[16:19], v[64:67]
    s_add_u32 m0, s8, 4096
    v_exp_f32 v224, v140
    v_mfma_f32_16x16x32_bf16 v[72:75], a[136:139], v[20:23], v[72:75]
    v_exp_f32 v225, v141
    v_mfma_f32_16x16x32_bf16 v[80:83], a[136:139], v[24:27], v[80:83]
    buffer_load_dwordx4 v204, s[68:71], s41 offen offset:0 lds
    v_mfma_f32_16x16x32_bf16 v[88:91], a[136:139], v[28:31], v[88:91]
    ds_read_b64_tr_b16 a[180:181], v223 offset:512
    ds_read_b64_tr_b16 a[182:183], v223 offset:41472
    v_mfma_f32_16x16x32_bf16 v[68:71], a[140:143], v[16:19], v[68:71]
    v_exp_f32 v226, v142
    v_mfma_f32_16x16x32_bf16 v[76:79], a[140:143], v[20:23], v[76:79]
    buffer_load_dwordx4 v205, s[68:71], s41 offen offset:1024 lds
    v_mfma_f32_16x16x32_bf16 v[84:87], a[140:143], v[24:27], v[84:87]
    v_exp_f32 v227, v143
    v_mfma_f32_16x16x32_bf16 v[92:95], a[140:143], v[28:31], v[92:95]
    s_add_u32 s41, s41, 0x4000
    v_or3_b32 v230, v230, v99, v100
    v_cvt_pk_bf16_f32 v101, v228, v229
    v_mfma_f32_16x16x32_bf16 v[64:67], a[144:147], v[32:35], v[64:67]
    ds_read_b64_tr_b16 a[184:185], v215 offset:768
    ds_read_b64_tr_b16 a[186:187], v215 offset:41728
    v_mfma_f32_16x16x32_bf16 v[72:75], a[144:147], v[36:39], v[72:75]
    v_exp_f32 v228, v144
    v_mfma_f32_16x16x32_bf16 v[80:83], a[144:147], v[40:43], v[80:83]
    s_add_u32 m0, s8, 6144
    v_exp_f32 v229, v145
    v_mfma_f32_16x16x32_bf16 v[88:91], a[144:147], v[44:47], v[88:91]
    v_cvt_pk_bf16_f32 v102, v224, v225
    v_or3_b32 v230, v230, v101, v102
    v_mfma_f32_16x16x32_bf16 v[68:71], a[148:151], v[32:35], v[68:71]
    buffer_load_dwordx4 v204, s[68:71], s41 offen offset:0 lds
    v_mfma_f32_16x16x32_bf16 v[76:79], a[148:151], v[36:39], v[76:79]
    ds_read_b64_tr_b16 a[188:189], v223 offset:768
    ds_read_b64_tr_b16 a[190:191], v223 offset:41728
    v_mfma_f32_16x16x32_bf16 v[84:87], a[148:151], v[40:43], v[84:87]
    v_exp_f32 v224, v146
    v_mfma_f32_16x16x32_bf16 v[92:95], a[148:151], v[44:47], v[92:95]
    buffer_load_dwordx4 v205, s[68:71], s41 offen offset:1024 lds
    v_mfma_f32_16x16x32_bf16 v[64:67], a[152:155], v[48:51], v[64:67]
    v_exp_f32 v225, v147
    v_mfma_f32_16x16x32_bf16 v[72:75], a[152:155], v[52:55], v[72:75]
    v_cvt_pk_bf16_f32 v103, v226, v227
    v_cvt_pk_bf16_f32 v104, v228, v229
    v_mfma_f32_16x16x32_bf16 v[80:83], a[152:155], v[56:59], v[80:83]
    s_add_u32 s41, s41, 0x4000
    v_exp_f32 v226, v148
    v_mfma_f32_16x16x32_bf16 v[88:91], a[152:155], v[60:63], v[88:91]
    v_exp_f32 v227, v149
    v_mfma_f32_16x16x32_bf16 v[68:71], a[156:159], v[48:51], v[68:71]
    buffer_load_dword v231, v193, s[64:67], s15 offen
    v_mfma_f32_16x16x32_bf16 v[76:79], a[156:159], v[52:55], v[76:79]
    v_exp_f32 v228, v150
    v_mfma_f32_16x16x32_bf16 v[84:87], a[156:159], v[56:59], v[84:87]
    v_exp_f32 v229, v151
    v_mfma_f32_16x16x32_bf16 v[92:95], a[156:159], v[60:63], v[92:95]
    s_add_u32 s15, s15, 2048
    v_or3_b32 v230, v230, v103, v104
    v_cvt_pk_bf16_f32 v105, v224, v225
    v_mfma_f32_16x16x32_bf16 v[184:187], v[200:203], v[112:115], v[184:187]
    ds_read_b128 a[128:131], v212 offset:0
    v_add_u32 v213, s26, v213
    v_mfma_f32_16x16x32_bf16 v[188:191], v[200:203], v[116:119], v[188:191]
    s_add_u32 s32, s32, 1
    v_exp_f32 v224, v152
    v_mfma_f32_16x16x32_bf16 v[196:199], v[200:203], v[120:123], v[196:199]
    ds_read_b128 a[132:135], v212 offset:40960
    v_cvt_pk_bf16_f32 v106, v226, v227
    v_mfma_f32_16x16x32_bf16 v[218:221], v[200:203], v[124:127], v[218:221]
    s_waitcnt vmcnt(17) lgkmcnt(2)
    v_exp_f32 v225, v153
    v_mfma_f32_16x16x32_bf16 a[0:3], a[160:163], v[112:115], a[0:3]
    s_cmp_eq_u32 s32, 5
    s_cselect_b32 s58, 0, s58
    ds_read_b128 a[136:139], v212 offset:64
    v_mfma_f32_16x16x32_bf16 a[8:11], a[160:163], v[116:119], a[8:11]
    ds_read_b64_tr_b16 v[232:233], v206 offset:0
    v_add_u32 v214, s26, v214
    v_mfma_f32_16x16x32_bf16 a[16:19], a[160:163], v[120:123], a[16:19]
    ds_read_b64_tr_b16 v[234:235], v206 offset:2048
    v_or3_b32 v230, v230, v105, v106
    v_mfma_f32_16x16x32_bf16 a[24:27], a[160:163], v[124:127], a[24:27]
    ds_read_b128 a[140:143], v212 offset:41024
    v_cvt_pk_bf16_f32 v107, v228, v229
    v_mfma_f32_16x16x32_bf16 a[4:7], a[164:167], v[112:115], a[4:7]
    v_exp_f32 v226, v154
    v_mfma_f32_16x16x32_bf16 a[12:15], a[164:167], v[116:119], a[12:15]
    ds_read_b128 a[144:147], v212 offset:128
    v_cvt_pk_bf16_f32 v108, v224, v225
    v_mfma_f32_16x16x32_bf16 a[20:23], a[164:167], v[120:123], a[20:23]
    ds_read_b64_tr_b16 v[236:237], v207 offset:0
    v_add_u32 v215, s26, v215
    v_mfma_f32_16x16x32_bf16 a[28:31], a[164:167], v[124:127], a[28:31]
    ds_read_b128 a[148:151], v212 offset:41088
    v_or3_b32 v230, v230, v107, v108
    v_mfma_f32_16x16x32_bf16 a[32:35], a[168:171], v[112:115], a[32:35]
    ds_read_b64_tr_b16 v[238:239], v207 offset:2048
    v_mfma_f32_16x16x32_bf16 a[40:43], a[168:171], v[116:119], a[40:43]
    v_exp_f32 v227, v155
    v_mfma_f32_16x16x32_bf16 a[48:51], a[168:171], v[120:123], a[48:51]
    ds_read_b128 a[152:155], v212 offset:192
    v_cvt_pk_bf16_f32 v109, v226, v227
    v_mfma_f32_16x16x32_bf16 a[56:59], a[168:171], v[124:127], a[56:59]
    ds_read_b64_tr_b16 v[240:241], v206 offset:256
    v_mfma_f32_16x16x32_bf16 a[36:39], a[172:175], v[112:115], a[36:39]
    ds_read_b128 a[156:159], v212 offset:41152
    v_add_u32 v223, s26, v223
    v_mfma_f32_16x16x32_bf16 a[44:47], a[172:175], v[116:119], a[44:47]
    ds_read_b64_tr_b16 v[242:243], v206 offset:2304
    v_mfma_f32_16x16x32_bf16 a[52:55], a[172:175], v[120:123], a[52:55]
    v_exp_f32 v228, v156
    v_mfma_f32_16x16x32_bf16 a[60:63], a[172:175], v[124:127], a[60:63]
    v_add_u32 v211, s25, v211
    v_mfma_f32_16x16x32_bf16 a[64:67], a[176:179], v[112:115], a[64:67]
    ds_read_b64_tr_b16 v[244:245], v207 offset:256
    v_mfma_f32_16x16x32_bf16 a[72:75], a[176:179], v[116:119], a[72:75]
    s_sub_u32 s26, 0, s26
    v_exp_f32 v229, v157
    v_mfma_f32_16x16x32_bf16 a[80:83], a[176:179], v[120:123], a[80:83]
    v_exp_f32 v224, v158
    v_mfma_f32_16x16x32_bf16 a[88:91], a[176:179], v[124:127], a[88:91]
    ds_read_b64_tr_b16 v[246:247], v207 offset:2304
    v_cvt_pk_bf16_f32 v110, v228, v229
    v_mfma_f32_16x16x32_bf16 a[68:71], a[180:183], v[112:115], a[68:71]
    v_add_u32 v212, s25, v212
    v_or3_b32 v230, v230, v109, v110
    v_mfma_f32_16x16x32_bf16 a[76:79], a[180:183], v[116:119], a[76:79]
    v_exp_f32 v225, v159
    v_mfma_f32_16x16x32_bf16 a[84:87], a[180:183], v[120:123], a[84:87]
    v_cvt_pk_bf16_f32 v111, v224, v225
    v_or_b32 v230, v230, v111
    v_mfma_f32_16x16x32_bf16 a[92:95], a[180:183], v[124:127], a[92:95]
    s_waitcnt vmcnt(9) lgkmcnt(3)
    s_barrier
    v_mfma_f32_16x16x32_bf16 a[96:99], a[184:187], v[112:115], a[96:99]
    ds_read_b64_tr_b16 a[160:161], v213 offset:0
    ds_read_b64_tr_b16 a[162:163], v213 offset:40960
    v_mfma_f32_16x16x32_bf16 a[104:107], a[184:187], v[116:119], a[104:107]
    s_sub_u32 s25, 0, s25
    ds_read_b64_tr_b16 a[164:165], v214 offset:0
    v_and_b32 v230, s33, v230
    v_mfma_f32_16x16x32_bf16 a[112:115], a[184:187], v[120:123], a[112:115]
    ds_read_b64_tr_b16 a[166:167], v214 offset:40960
    v_cmp_ne_u32 vcc, 0, v230
    v_mfma_f32_16x16x32_bf16 a[120:123], a[184:187], v[124:127], a[120:123]
    ds_read_b64_tr_b16 a[168:169], v213 offset:256
    s_cbranch_vccnz L_rarel1
L_backl1:
    v_mfma_f32_16x16x32_bf16 a[100:103], a[188:191], v[112:115], a[100:103]
    ds_read_b64_tr_b16 a[170:171], v213 offset:41216
    v_mfma_f32_16x16x32_bf16 a[108:111], a[188:191], v[116:119], a[108:111]
    ds_read_b64_tr_b16 a[172:173], v214 offset:256
    v_mfma_f32_16x16x32_bf16 a[116:119], a[188:191], v[120:123], a[116:119]
    s_waitcnt vmcnt(5) lgkmcnt(7)
    ds_read_b64_tr_b16 a[174:175], v214 offset:41216
    v_mfma_f32_16x16x32_bf16 a[124:127], a[188:191], v[124:127], a[124:127]
    s_cmp_lt_u32 s32, 6
    s_cbranch_scc1 L_attn
    v_mfma_f32_16x16x32_bf16 a[192:195], v[232:235], v[248:251], a[192:195]
    buffer_load_dwordx4 v[16:19], v192, s[72:75], s95 offen offset:0 sc1
    v_mfma_f32_16x16x32_bf16 a[208:211], v[232:235], v[252:255], a[208:211]
    ds_read_b64_tr_b16 a[176:177], v213 offset:512
    ds_read_b64_tr_b16 a[178:179], v213 offset:41472
    v_mfma_f32_16x16x32_bf16 a[224:227], v[232:235], v[176:179], a[224:227]
    buffer_load_dwordx4 v[20:23], v192, s[72:75], s95 offen offset:1024 sc1
    v_mfma_f32_16x16x32_bf16 a[240:243], v[232:235], v[180:183], a[240:243]
    ds_read_b64_tr_b16 a[180:181], v214 offset:512
    v_exp_f32 v224, v64
    v_mfma_f32_16x16x32_bf16 a[196:199], v[236:239], v[248:251], a[196:199]
    buffer_load_dwordx4 v[24:27], v192, s[72:75], s95 offen offset:2048 sc1
    v_mfma_f32_16x16x32_bf16 a[212:215], v[236:239], v[252:255], a[212:215]
    ds_read_b64_tr_b16 a[182:183], v214 offset:41472
    v_exp_f32 v225, v65
    v_mfma_f32_16x16x32_bf16 a[228:231], v[236:239], v[176:179], a[228:231]
    buffer_load_dwordx4 v[28:31], v192, s[72:75], s95 offen offset:3072 sc1
    v_mfma_f32_16x16x32_bf16 a[244:247], v[236:239], v[180:183], a[244:247]
    ds_read_b64_tr_b16 a[184:185], v213 offset:768
    ds_read_b64_tr_b16 a[186:187], v213 offset:41728
    v_mfma_f32_16x16x32_bf16 a[200:203], v[240:243], v[248:251], a[200:203]
    s_add_u32 s95, s95, 4096
    v_exp_f32 v226, v66
    v_mfma_f32_16x16x32_bf16 a[216:219], v[240:243], v[252:255], a[216:219]
    ds_read_b64_tr_b16 a[188:189], v214 offset:768
    v_cvt_pk_bf16_f32 v112, v224, v225
    v_mfma_f32_16x16x32_bf16 a[232:235], v[240:243], v[176:179], a[232:235]
    ds_read_b64_tr_b16 a[190:191], v214 offset:41728
    v_exp_f32 v227, v67
    v_mfma_f32_16x16x32_bf16 a[248:251], v[240:243], v[180:183], a[248:251]
    v_exp_f32 v228, v68
    v_mfma_f32_16x16x32_bf16 a[204:207], v[244:247], v[248:251], a[204:207]
    v_exp_f32 v229, v69
    v_mfma_f32_16x16x32_bf16 a[220:223], v[244:247], v[252:255], a[220:223]
    v_exp_f32 v224, v70
    v_cvt_pk_bf16_f32 v113, v226, v227
    v_mfma_f32_16x16x32_bf16 a[236:239], v[244:247], v[176:179], a[236:239]
    v_exp_f32 v225, v71
    v_mfma_f32_16x16x32_bf16 a[252:255], v[244:247], v[180:183], a[252:255]
    v_exp_f32 v226, v72
    v_cvt_pk_bf16_f32 v114, v228, v229
    v_mfma_f32_16x16x32_bf16 v[184:187], v[200:203], v[96:99], v[184:187]
    v_exp_f32 v227, v73
    v_mfma_f32_16x16x32_bf16 v[188:191], v[200:203], v[100:103], v[188:191]
    v_exp_f32 v228, v74
    v_mfma_f32_16x16x32_bf16 v[196:199], v[200:203], v[104:107], v[196:199]
    v_exp_f32 v229, v75
    v_or3_b32 v230, v112, v113, v114
    v_mfma_f32_16x16x32_bf16 v[218:221], v[200:203], v[108:111], v[218:221]
    s_waitcnt vmcnt(5) lgkmcnt(0)
    v_cvt_pk_bf16_f32 v115, v224, v225
    v_cvt_pk_bf16_f32 v116, v226, v227
    v_mfma_f32_16x16x32_bf16 a[0:3], a[160:163], v[96:99], a[0:3]
    ds_read_b64_tr_b16 v[0:1], v206 offset:4096
    v_or3_b32 v230, v230, v115, v116
    v_mfma_f32_16x16x32_bf16 a[8:11], a[160:163], v[100:103], a[8:11]
    ds_read_b64_tr_b16 v[2:3], v206 offset:6144
    v_cvt_pk_bf16_f32 v117, v228, v229
    v_mfma_f32_16x16x32_bf16 a[16:19], a[160:163], v[104:107], a[16:19]
    v_exp_f32 v224, v76
    v_mfma_f32_16x16x32_bf16 a[24:27], a[160:163], v[108:111], a[24:27]
    ds_read_b64_tr_b16 v[4:5], v207 offset:4096
    v_exp_f32 v225, v77
    v_mfma_f32_16x16x32_bf16 a[4:7], a[164:167], v[96:99], a[4:7]
    v_add_u32 v208, 14336, v204
    v_cvt_pk_bf16_f32 v118, v224, v225
    v_or3_b32 v230, v230, v117, v118
    v_mfma_f32_16x16x32_bf16 a[12:15], a[164:167], v[100:103], a[12:15]
    ds_read_b64_tr_b16 v[6:7], v207 offset:6144
    v_add_u32 v209, 14336, v205
    v_mfma_f32_16x16x32_bf16 a[20:23], a[164:167], v[104:107], a[20:23]
    v_exp_f32 v226, v78
    v_mfma_f32_16x16x32_bf16 a[28:31], a[164:167], v[108:111], a[28:31]
    s_add_u32 m0, s8, 16640
    ds_read_b64_tr_b16 v[8:9], v206 offset:4352
    v_exp_f32 v227, v79
    v_mfma_f32_16x16x32_bf16 a[32:35], a[168:171], v[96:99], a[32:35]
    v_exp_f32 v228, v80
    v_mfma_f32_16x16x32_bf16 a[40:43], a[168:171], v[100:103], a[40:43]
    s_lshl_b32 s6, s3, 1
    ds_read_b64_tr_b16 v[10:11], v206 offset:6400
    v_cvt_pk_bf16_f32 v119, v226, v227
    v_mfma_f32_16x16x32_bf16 a[48:51], a[168:171], v[104:107], a[48:51]
    ds_read_b64_tr_b16 a[128:129], v215 offset:0
    v_exp_f32 v229, v81
    v_mfma_f32_16x16x32_bf16 a[56:59], a[168:171], v[108:111], a[56:59]
    s_xor_b32 s6, s6, s5
    ds_read_b64_tr_b16 v[12:13], v207 offset:4352
    ds_read_b64_tr_b16 a[130:131], v215 offset:40960
    v_cvt_pk_bf16_f32 v120, v228, v229
    v_mfma_f32_16x16x32_bf16 a[36:39], a[172:175], v[96:99], a[36:39]
    v_exp_f32 v224, v82
    v_mfma_f32_16x16x32_bf16 a[44:47], a[172:175], v[100:103], a[44:47]
    s_xor_b32 s6, s6, 1
    ds_read_b64_tr_b16 v[14:15], v207 offset:6400
    ds_read_b64_tr_b16 a[132:133], v223 offset:0
    v_mfma_f32_16x16x32_bf16 a[52:55], a[172:175], v[104:107], a[52:55]
    v_exp_f32 v225, v83
    v_or3_b32 v230, v230, v119, v120
    v_mfma_f32_16x16x32_bf16 a[60:63], a[172:175], v[108:111], a[60:63]
    s_lshl_b32 s18, s3, 10
    ds_read_b64_tr_b16 a[134:135], v223 offset:40960
    v_cvt_pk_bf16_f32 v121, v224, v225
    v_mfma_f32_16x16x32_bf16 a[64:67], a[176:179], v[96:99], a[64:67]
    v_exp_f32 v226, v84
    v_mfma_f32_16x16x32_bf16 a[72:75], a[176:179], v[100:103], a[72:75]
    s_add_u32 s18, s18, s6
    ds_read_b64_tr_b16 a[136:137], v215 offset:256
    v_exp_f32 v227, v85
    v_mfma_f32_16x16x32_bf16 a[80:83], a[176:179], v[104:107], a[80:83]
    v_exp_f32 v228, v86
    v_mfma_f32_16x16x32_bf16 a[88:91], a[176:179], v[108:111], a[88:91]
    s_lshl_b32 s18, s18, 7
    ds_read_b64_tr_b16 a[138:139], v215 offset:41216
    v_cvt_pk_bf16_f32 v122, v226, v227
    v_or3_b32 v230, v230, v121, v122
    v_mfma_f32_16x16x32_bf16 a[68:71], a[180:183], v[96:99], a[68:71]
    v_exp_f32 v229, v87
    v_mfma_f32_16x16x32_bf16 a[76:79], a[180:183], v[100:103], a[76:79]
    ds_read_b64_tr_b16 a[140:141], v223 offset:256
    v_cvt_pk_bf16_f32 v123, v228, v229
    v_mfma_f32_16x16x32_bf16 a[84:87], a[180:183], v[104:107], a[84:87]
    buffer_load_dwordx4 v204, s[64:67], s18 offen offset:0 lds
    v_mfma_f32_16x16x32_bf16 a[92:95], a[180:183], v[108:111], a[92:95]
    ds_read_b64_tr_b16 a[142:143], v223 offset:41216
    v_exp_f32 v224, v88
    v_mfma_f32_16x16x32_bf16 a[96:99], a[184:187], v[96:99], a[96:99]
    buffer_load_dwordx4 v205, s[64:67], s18 offen offset:1024 lds
    v_mfma_f32_16x16x32_bf16 a[104:107], a[184:187], v[100:103], a[104:107]
    ds_read_b64_tr_b16 a[144:145], v215 offset:512
    v_exp_f32 v225, v89
    v_mfma_f32_16x16x32_bf16 a[112:115], a[184:187], v[104:107], a[112:115]
    buffer_load_dwordx4 v208, s[64:67], s18 offen offset:2048 lds
    v_mfma_f32_16x16x32_bf16 a[120:123], a[184:187], v[108:111], a[120:123]
    ds_read_b64_tr_b16 a[146:147], v215 offset:41472
    v_cvt_pk_bf16_f32 v124, v224, v225
    v_or3_b32 v230, v230, v123, v124
    v_mfma_f32_16x16x32_bf16 a[100:103], a[188:191], v[96:99], a[100:103]
    buffer_load_dwordx4 v209, s[64:67], s18 offen offset:3072 lds
    v_mfma_f32_16x16x32_bf16 a[108:111], a[188:191], v[100:103], a[108:111]
    s_add_u32 m0, s8, 20736
    ds_read_b64_tr_b16 a[148:149], v223 offset:512
    v_exp_f32 v226, v90
    v_mfma_f32_16x16x32_bf16 a[116:119], a[188:191], v[104:107], a[116:119]
    s_add_u32 s18, s18, 32768
    v_exp_f32 v227, v91
    v_mfma_f32_16x16x32_bf16 a[124:127], a[188:191], v[108:111], a[124:127]
    s_waitcnt vmcnt(4) lgkmcnt(9)
    ds_read_b64_tr_b16 a[150:151], v223 offset:41472
    v_cvt_pk_bf16_f32 v125, v226, v227
    v_mfma_f32_16x16x32_bf16 a[192:195], v[0:3], v[16:19], a[192:195]
    buffer_load_dwordx4 v204, s[64:67], s18 offen offset:0 lds
    v_mfma_f32_16x16x32_bf16 a[208:211], v[0:3], v[20:23], a[208:211]
    ds_read_b64_tr_b16 a[152:153], v215 offset:768
    v_exp_f32 v228, v92
    v_mfma_f32_16x16x32_bf16 a[224:227], v[0:3], v[24:27], a[224:227]
    buffer_load_dwordx4 v205, s[64:67], s18 offen offset:1024 lds
    v_mfma_f32_16x16x32_bf16 a[240:243], v[0:3], v[28:31], a[240:243]
    ds_read_b64_tr_b16 a[154:155], v215 offset:41728
    v_exp_f32 v229, v93
    v_mfma_f32_16x16x32_bf16 a[196:199], v[4:7], v[16:19], a[196:199]
    buffer_load_dwordx4 v208, s[64:67], s18 offen offset:2048 lds
    v_mfma_f32_16x16x32_bf16 a[212:215], v[4:7], v[20:23], a[212:215]
    ds_read_b64_tr_b16 a[156:157], v223 offset:768
    v_cvt_pk_bf16_f32 v126, v228, v229
    v_mfma_f32_16x16x32_bf16 a[228:231], v[4:7], v[24:27], a[228:231]
    buffer_load_dwordx4 v209, s[64:67], s18 offen offset:3072 lds
    v_or3_b32 v230, v230, v125, v126
    v_mfma_f32_16x16x32_bf16 a[244:247], v[4:7], v[28:31], a[244:247]
    ds_read_b64_tr_b16 a[158:159], v223 offset:41728
    v_exp_f32 v224, v94
    v_mfma_f32_16x16x32_bf16 a[200:203], v[8:11], v[16:19], a[200:203]
    s_add_u32 m0, s8, 24832
    v_exp_f32 v225, v95
    v_mfma_f32_16x16x32_bf16 a[216:219], v[8:11], v[20:23], a[216:219]
    v_cvt_pk_bf16_f32 v127, v224, v225
    v_or_b32 v230, v230, v127
    v_mfma_f32_16x16x32_bf16 a[232:235], v[8:11], v[24:27], a[232:235]
    s_add_u32 s18, s18, 32768
    v_and_b32 v230, s33, v230
    v_cmp_ne_u32 vcc, 0, v230
    v_mfma_f32_16x16x32_bf16 a[248:251], v[8:11], v[28:31], a[248:251]
    buffer_load_dwordx4 v204, s[64:67], s18 offen offset:0 lds
    s_cbranch_vccnz L_raret
L_backt:
    v_mfma_f32_16x16x32_bf16 a[204:207], v[12:15], v[16:19], a[204:207]
    v_mfma_f32_16x16x32_bf16 a[220:223], v[12:15], v[20:23], a[220:223]
    buffer_load_dwordx4 v205, s[64:67], s18 offen offset:1024 lds
    v_mfma_f32_16x16x32_bf16 a[236:239], v[12:15], v[24:27], a[236:239]
    v_mfma_f32_16x16x32_bf16 a[252:255], v[12:15], v[28:31], a[252:255]
    buffer_load_dwordx4 v208, s[64:67], s18 offen offset:2048 lds
    v_mfma_f32_16x16x32_bf16 v[184:187], v[200:203], v[112:115], v[184:187]
    s_lshl_b32 s28, s3, 8
    v_add_u32 v211, s28, v194
    v_add_u32 v212, s28, v195
    v_mfma_f32_16x16x32_bf16 v[188:191], v[200:203], v[116:119], v[188:191]
    buffer_load_dwordx4 v209, s[64:67], s18 offen offset:3072 lds
    v_mfma_f32_16x16x32_bf16 v[196:199], v[200:203], v[120:123], v[196:199]
    v_mfma_f32_16x16x32_bf16 v[218:221], v[200:203], v[124:127], v[218:221]
    s_add_u32 m0, s8, 28928
    s_waitcnt lgkmcnt(0)
    s_barrier
    v_mfma_f32_16x16x32_bf16 a[0:3], a[128:131], v[112:115], a[0:3]
    v_mfma_f32_16x16x32_bf16 a[8:11], a[128:131], v[116:119], a[8:11]
    s_add_u32 s18, s18, 32768
    v_mfma_f32_16x16x32_bf16 a[16:19], a[128:131], v[120:123], a[16:19]
    v_mfma_f32_16x16x32_bf16 a[24:27], a[128:131], v[124:127], a[24:27]
    buffer_load_dwordx4 v204, s[64:67], s18 offen offset:0 lds
    v_mfma_f32_16x16x32_bf16 a[4:7], a[132:135], v[112:115], a[4:7]
    s_add_u32 s28, s28, 256
    v_rcp_f32 v48, v184
    v_mfma_f32_16x16x32_bf16 a[12:15], a[132:135], v[116:119], a[12:15]
    buffer_load_dwordx4 v205, s[64:67], s18 offen offset:1024 lds
    v_mfma_f32_16x16x32_bf16 a[20:23], a[132:135], v[120:123], a[20:23]
    s_and_b32 s28, s28, 0x3ff
    v_rcp_f32 v50, v188
    v_mfma_f32_16x16x32_bf16 a[28:31], a[132:135], v[124:127], a[28:31]
    buffer_load_dwordx4 v208, s[64:67], s18 offen offset:2048 lds
    v_mfma_f32_16x16x32_bf16 a[32:35], a[136:139], v[112:115], a[32:35]
    v_rcp_f32 v52, v196
    v_mfma_f32_16x16x32_bf16 a[40:43], a[136:139], v[116:119], a[40:43]
    buffer_load_dwordx4 v209, s[64:67], s18 offen offset:3072 lds
    v_mfma_f32_16x16x32_bf16 a[48:51], a[136:139], v[120:123], a[48:51]
    v_rcp_f32 v54, v218
    v_mfma_f32_16x16x32_bf16 a[56:59], a[136:139], v[124:127], a[56:59]
    v_add_u32 v200, s28, v194
    v_add_u32 v201, s28, v195
    v_mfma_f32_16x16x32_bf16 a[36:39], a[140:143], v[112:115], a[36:39]
    v_accvgpr_read_b32 v32, a0
    v_accvgpr_read_b32 v33, a1
    v_mfma_f32_16x16x32_bf16 a[44:47], a[140:143], v[116:119], a[44:47]
    s_add_u32 m0, s8, 33024
    v_accvgpr_read_b32 v34, a2
    v_accvgpr_read_b32 v35, a3
    v_mfma_f32_16x16x32_bf16 a[52:55], a[140:143], v[120:123], a[52:55]
    v_accvgpr_read_b32 v36, a4
    v_accvgpr_read_b32 v37, a5
    v_mfma_f32_16x16x32_bf16 a[60:63], a[140:143], v[124:127], a[60:63]
    s_add_u32 s18, s18, 32768
    v_accvgpr_read_b32 v38, a6
    v_accvgpr_read_b32 v39, a7
    v_mfma_f32_16x16x32_bf16 a[64:67], a[144:147], v[112:115], a[64:67]
    s_waitcnt vmcnt(12)
    v_pk_mul_f32 v[32:33], v[32:33], v[48:49] op_sel_hi:[1,0]
    v_pk_mul_f32 v[34:35], v[34:35], v[48:49] op_sel_hi:[1,0]
    v_pk_mul_f32 v[36:37], v[36:37], v[48:49] op_sel_hi:[1,0]
    v_pk_mul_f32 v[38:39], v[38:39], v[48:49] op_sel_hi:[1,0]
    v_mfma_f32_16x16x32_bf16 a[72:75], a[144:147], v[116:119], a[72:75]
    s_and_b32 s18, s18, 0x7ffff
    ds_read_b64_tr_b16 v[224:225], v206 offset:16640
    v_cvt_pk_bf16_f32 v64, v32, v33
    v_mfma_f32_16x16x32_bf16 a[80:83], a[144:147], v[120:123], a[80:83]
    ds_read_b64_tr_b16 v[226:227], v206 offset:18688
    v_cvt_pk_bf16_f32 v65, v34, v35
    v_mfma_f32_16x16x32_bf16 a[88:91], a[144:147], v[124:127], a[88:91]
    buffer_load_dwordx4 v204, s[64:67], s18 offen offset:0 lds
    v_mfma_f32_16x16x32_bf16 a[68:71], a[148:151], v[112:115], a[68:71]
    ds_read_b64_tr_b16 v[228:229], v207 offset:16640
    v_cvt_pk_bf16_f32 v66, v36, v37
    v_mfma_f32_16x16x32_bf16 a[76:79], a[148:151], v[116:119], a[76:79]
    ds_read_b64_tr_b16 v[230:231], v207 offset:18688
    v_cvt_pk_bf16_f32 v67, v38, v39
    v_accvgpr_read_b32 v40, a8
    v_accvgpr_read_b32 v41, a9
    v_accvgpr_read_b32 v42, a10
    v_accvgpr_read_b32 v43, a11
    v_accvgpr_read_b32 v44, a12
    v_accvgpr_read_b32 v45, a13
    v_accvgpr_read_b32 v46, a14
    v_accvgpr_read_b32 v47, a15
    v_pk_mul_f32 v[40:41], v[40:41], v[50:51] op_sel_hi:[1,0]
    v_pk_mul_f32 v[42:43], v[42:43], v[50:51] op_sel_hi:[1,0]
    v_pk_mul_f32 v[44:45], v[44:45], v[50:51] op_sel_hi:[1,0]
    v_pk_mul_f32 v[46:47], v[46:47], v[50:51] op_sel_hi:[1,0]
    v_mfma_f32_16x16x32_bf16 a[84:87], a[148:151], v[120:123], a[84:87]
    buffer_load_dwordx4 v205, s[64:67], s18 offen offset:1024 lds
    ds_write_b128 v211, v[64:67] offset:0
    v_mfma_f32_16x16x32_bf16 a[92:95], a[148:151], v[124:127], a[92:95]
    ds_read_b64_tr_b16 v[232:233], v206 offset:16896
    v_cvt_pk_bf16_f32 v68, v40, v41
    v_cvt_pk_bf16_f32 v69, v42, v43
    v_mfma_f32_16x16x32_bf16 a[96:99], a[152:155], v[112:115], a[96:99]
    buffer_load_dwordx4 v208, s[64:67], s18 offen offset:2048 lds
    v_cvt_pk_bf16_f32 v70, v44, v45
    v_mfma_f32_16x16x32_bf16 a[104:107], a[152:155], v[116:119], a[104:107]
    ds_read_b64_tr_b16 v[234:235], v206 offset:18944
    ds_read_b64_tr_b16 v[236:237], v207 offset:16896
    ds_read_b64_tr_b16 v[238:239], v207 offset:18944
    v_mfma_f32_16x16x32_bf16 a[112:115], a[152:155], v[120:123], a[112:115]
    buffer_load_dwordx4 v209, s[64:67], s18 offen offset:3072 lds
    v_cvt_pk_bf16_f32 v71, v46, v47
    v_accvgpr_read_b32 v32, a16
    v_accvgpr_read_b32 v33, a17
    v_accvgpr_read_b32 v34, a18
    v_accvgpr_read_b32 v35, a19
    v_accvgpr_read_b32 v36, a20
    v_accvgpr_read_b32 v37, a21
    v_accvgpr_read_b32 v38, a22
    v_accvgpr_read_b32 v39, a23
    v_pk_mul_f32 v[32:33], v[32:33], v[52:53] op_sel_hi:[1,0]
    v_pk_mul_f32 v[34:35], v[34:35], v[52:53] op_sel_hi:[1,0]
    v_pk_mul_f32 v[36:37], v[36:37], v[52:53] op_sel_hi:[1,0]
    v_pk_mul_f32 v[38:39], v[38:39], v[52:53] op_sel_hi:[1,0]
    v_mfma_f32_16x16x32_bf16 a[120:123], a[152:155], v[124:127], a[120:123]
    ds_write_b128 v211, v[68:71] offset:40960
    v_cvt_pk_bf16_f32 v72, v32, v33
    v_mfma_f32_16x16x32_bf16 a[100:103], a[156:159], v[112:115], a[100:103]
    v_cvt_pk_bf16_f32 v73, v34, v35
    v_cvt_pk_bf16_f32 v74, v36, v37
    v_mfma_f32_16x16x32_bf16 a[108:111], a[156:159], v[116:119], a[108:111]
    v_cvt_pk_bf16_f32 v75, v38, v39
    v_accvgpr_read_b32 v40, a24
    v_mfma_f32_16x16x32_bf16 a[116:119], a[156:159], v[120:123], a[116:119]
    ds_write_b128 v212, v[72:75] offset:0
    v_accvgpr_read_b32 v41, a25
    v_mfma_f32_16x16x32_bf16 a[124:127], a[156:159], v[124:127], a[124:127]
    s_waitcnt vmcnt(12) lgkmcnt(2)
    v_accvgpr_read_b32 v42, a26
    v_accvgpr_read_b32 v43, a27
    v_accvgpr_read_b32 v44, a28
    v_accvgpr_read_b32 v45, a29
    v_accvgpr_read_b32 v46, a30
    v_accvgpr_read_b32 v47, a31
    v_pk_mul_f32 v[40:41], v[40:41], v[54:55] op_sel_hi:[1,0]
    v_pk_mul_f32 v[42:43], v[42:43], v[54:55] op_sel_hi:[1,0]
    v_pk_mul_f32 v[44:45], v[44:45], v[54:55] op_sel_hi:[1,0]
    v_pk_mul_f32 v[46:47], v[46:47], v[54:55] op_sel_hi:[1,0]
    v_mfma_f32_16x16x32_bf16 v[128:131], v[224:227], v[64:67], 0
    s_add_u32 m0, s8, 16640
    ds_read_b64_tr_b16 v[240:241], v206 offset:20736
    v_cvt_pk_bf16_f32 v76, v40, v41
    v_cvt_pk_bf16_f32 v77, v42, v43
    v_mfma_f32_16x16x32_bf16 v[136:139], v[224:227], v[68:71], 0
    s_add_u32 s18, s18, 32768
    ds_read_b64_tr_b16 v[242:243], v206 offset:22784
    v_cvt_pk_bf16_f32 v78, v44, v45
    v_cvt_pk_bf16_f32 v79, v46, v47
    v_mfma_f32_16x16x32_bf16 v[144:147], v[224:227], v[72:75], 0
    ds_read_b64_tr_b16 v[244:245], v207 offset:20736
    ds_write_b128 v212, v[76:79] offset:40960
    v_mfma_f32_16x16x32_bf16 v[152:155], v[224:227], v[76:79], 0
    buffer_load_dwordx4 v204, s[64:67], s18 offen offset:0 lds
    v_accvgpr_read_b32 v32, a32
    v_accvgpr_read_b32 v33, a33
    v_accvgpr_read_b32 v34, a34
    v_accvgpr_read_b32 v35, a35
    v_accvgpr_read_b32 v36, a36
    v_accvgpr_read_b32 v37, a37
    v_accvgpr_read_b32 v38, a38
    v_accvgpr_read_b32 v39, a39
    v_pk_mul_f32 v[32:33], v[32:33], v[48:49] op_sel_hi:[1,0]
    v_pk_mul_f32 v[34:35], v[34:35], v[48:49] op_sel_hi:[1,0]
    v_pk_mul_f32 v[36:37], v[36:37], v[48:49] op_sel_hi:[1,0]
    v_pk_mul_f32 v[38:39], v[38:39], v[48:49] op_sel_hi:[1,0]
    v_mfma_f32_16x16x32_bf16 v[132:135], v[228:231], v[64:67], 0
    ds_read_b64_tr_b16 v[246:247], v207 offset:22784
    v_cvt_pk_bf16_f32 v80, v32, v33
    v_mfma_f32_16x16x32_bf16 v[140:143], v[228:231], v[68:71], 0
    ds_read_b64_tr_b16 v[248:249], v206 offset:20992
    v_cvt_pk_bf16_f32 v81, v34, v35
    v_mfma_f32_16x16x32_bf16 v[148:151], v[228:231], v[72:75], 0
    ds_read_b64_tr_b16 v[250:251], v206 offset:23040
    v_cvt_pk_bf16_f32 v82, v36, v37
    v_cvt_pk_bf16_f32 v83, v38, v39
    v_mfma_f32_16x16x32_bf16 v[156:159], v[228:231], v[76:79], 0
    buffer_load_dwordx4 v205, s[64:67], s18 offen offset:1024 lds
    ds_write_b128 v211, v[80:83] offset:64
    v_accvgpr_read_b32 v40, a40
    v_accvgpr_read_b32 v41, a41
    v_accvgpr_read_b32 v42, a42
    v_accvgpr_read_b32 v43, a43
    v_accvgpr_read_b32 v44, a44
    v_accvgpr_read_b32 v45, a45
    v_accvgpr_read_b32 v46, a46
    v_accvgpr_read_b32 v47, a47
    v_pk_mul_f32 v[40:41], v[40:41], v[50:51] op_sel_hi:[1,0]
    v_pk_mul_f32 v[42:43], v[42:43], v[50:51] op_sel_hi:[1,0]
    v_pk_mul_f32 v[44:45], v[44:45], v[50:51] op_sel_hi:[1,0]
    v_pk_mul_f32 v[46:47], v[46:47], v[50:51] op_sel_hi:[1,0]
    v_mfma_f32_16x16x32_bf16 v[160:163], v[232:235], v[64:67], 0
    ds_read_b64_tr_b16 v[252:253], v207 offset:20992
    v_cvt_pk_bf16_f32 v84, v40, v41
    v_mfma_f32_16x16x32_bf16 v[168:171], v[232:235], v[68:71], 0
    ds_read_b64_tr_b16 v[254:255], v207 offset:23040
    v_cvt_pk_bf16_f32 v85, v42, v43
    v_mfma_f32_16x16x32_bf16 v[176:179], v[232:235], v[72:75], 0
    v_cvt_pk_bf16_f32 v86, v44, v45
    v_cvt_pk_bf16_f32 v87, v46, v47
    v_mfma_f32_16x16x32_bf16 v[184:187], v[232:235], v[76:79], 0
    buffer_load_dwordx4 v208, s[64:67], s18 offen offset:2048 lds
    ds_write_b128 v211, v[84:87] offset:41024
    v_accvgpr_read_b32 v32, a48
    v_accvgpr_read_b32 v33, a49
    v_accvgpr_read_b32 v34, a50
    v_accvgpr_read_b32 v35, a51
    v_accvgpr_read_b32 v36, a52
    v_accvgpr_read_b32 v37, a53
    v_accvgpr_read_b32 v38, a54
    v_accvgpr_read_b32 v39, a55
    v_pk_mul_f32 v[32:33], v[32:33], v[52:53] op_sel_hi:[1,0]
    v_pk_mul_f32 v[34:35], v[34:35], v[52:53] op_sel_hi:[1,0]
    v_pk_mul_f32 v[36:37], v[36:37], v[52:53] op_sel_hi:[1,0]
    v_pk_mul_f32 v[38:39], v[38:39], v[52:53] op_sel_hi:[1,0]
    v_mfma_f32_16x16x32_bf16 v[164:167], v[236:239], v[64:67], 0
    v_cvt_pk_bf16_f32 v88, v32, v33
    v_cvt_pk_bf16_f32 v89, v34, v35
    v_mfma_f32_16x16x32_bf16 v[172:175], v[236:239], v[68:71], 0
    v_cvt_pk_bf16_f32 v90, v36, v37
    v_cvt_pk_bf16_f32 v91, v38, v39
    v_mfma_f32_16x16x32_bf16 v[180:183], v[236:239], v[72:75], 0
    buffer_load_dwordx4 v209, s[64:67], s18 offen offset:3072 lds
    ds_write_b128 v212, v[88:91] offset:64
    v_mfma_f32_16x16x32_bf16 v[188:191], v[236:239], v[76:79], 0
    s_waitcnt vmcnt(12) lgkmcnt(2)
    v_accvgpr_read_b32 v40, a56
    v_accvgpr_read_b32 v41, a57
    v_accvgpr_read_b32 v42, a58
    v_accvgpr_read_b32 v43, a59
    v_accvgpr_read_b32 v44, a60
    v_accvgpr_read_b32 v45, a61
    v_accvgpr_read_b32 v46, a62
    v_accvgpr_read_b32 v47, a63
    v_pk_mul_f32 v[40:41], v[40:41], v[54:55] op_sel_hi:[1,0]
    v_pk_mul_f32 v[42:43], v[42:43], v[54:55] op_sel_hi:[1,0]
    v_pk_mul_f32 v[44:45], v[44:45], v[54:55] op_sel_hi:[1,0]
    v_pk_mul_f32 v[46:47], v[46:47], v[54:55] op_sel_hi:[1,0]
    v_mfma_f32_16x16x32_bf16 v[128:131], v[240:243], v[80:83], v[128:131]
    s_add_u32 m0, s8, 20736
    ds_read_b64_tr_b16 v[224:225], v206 offset:24832
    v_cvt_pk_bf16_f32 v92, v40, v41
    v_cvt_pk_bf16_f32 v93, v42, v43
    v_mfma_f32_16x16x32_bf16 v[136:139], v[240:243], v[84:87], v[136:139]
    s_add_u32 s18, s18, 32768
    ds_read_b64_tr_b16 v[226:227], v206 offset:26880
    v_cvt_pk_bf16_f32 v94, v44, v45
    v_cvt_pk_bf16_f32 v95, v46, v47
    v_mfma_f32_16x16x32_bf16 v[144:147], v[240:243], v[88:91], v[144:147]
    ds_read_b64_tr_b16 v[228:229], v207 offset:24832
    ds_write_b128 v212, v[92:95] offset:41024
    v_mfma_f32_16x16x32_bf16 v[152:155], v[240:243], v[92:95], v[152:155]
    buffer_load_dwordx4 v204, s[64:67], s18 offen offset:0 lds
    v_accvgpr_read_b32 v32, a64
    v_accvgpr_read_b32 v33, a65
    v_accvgpr_read_b32 v34, a66
    v_accvgpr_read_b32 v35, a67
    v_accvgpr_read_b32 v36, a68
    v_accvgpr_read_b32 v37, a69
    v_accvgpr_read_b32 v38, a70
    v_accvgpr_read_b32 v39, a71
    v_pk_mul_f32 v[32:33], v[32:33], v[48:49] op_sel_hi:[1,0]
    v_pk_mul_f32 v[34:35], v[34:35], v[48:49] op_sel_hi:[1,0]
    v_pk_mul_f32 v[36:37], v[36:37], v[48:49] op_sel_hi:[1,0]
    v_pk_mul_f32 v[38:39], v[38:39], v[48:49] op_sel_hi:[1,0]
    v_mfma_f32_16x16x32_bf16 v[132:135], v[244:247], v[80:83], v[132:135]
    ds_read_b64_tr_b16 v[230:231], v207 offset:26880
    v_cvt_pk_bf16_f32 v96, v32, v33
    v_mfma_f32_16x16x32_bf16 v[140:143], v[244:247], v[84:87], v[140:143]
    ds_read_b64_tr_b16 v[232:233], v206 offset:25088
    v_cvt_pk_bf16_f32 v97, v34, v35
    v_mfma_f32_16x16x32_bf16 v[148:151], v[244:247], v[88:91], v[148:151]
    ds_read_b64_tr_b16 v[234:235], v206 offset:27136
    v_cvt_pk_bf16_f32 v98, v36, v37
    v_cvt_pk_bf16_f32 v99, v38, v39
    v_mfma_f32_16x16x32_bf16 v[156:159], v[244:247], v[92:95], v[156:159]
    buffer_load_dwordx4 v205, s[64:67], s18 offen offset:1024 lds
    ds_write_b128 v211, v[96:99] offset:128
    v_accvgpr_read_b32 v40, a72
    v_accvgpr_read_b32 v41, a73
    v_accvgpr_read_b32 v42, a74
    v_accvgpr_read_b32 v43, a75
    v_accvgpr_read_b32 v44, a76
    v_accvgpr_read_b32 v45, a77
    v_accvgpr_read_b32 v46, a78
    v_accvgpr_read_b32 v47, a79
    v_pk_mul_f32 v[40:41], v[40:41], v[50:51] op_sel_hi:[1,0]
    v_pk_mul_f32 v[42:43], v[42:43], v[50:51] op_sel_hi:[1,0]
    v_pk_mul_f32 v[44:45], v[44:45], v[50:51] op_sel_hi:[1,0]
    v_pk_mul_f32 v[46:47], v[46:47], v[50:51] op_sel_hi:[1,0]
    v_mfma_f32_16x16x32_bf16 v[160:163], v[248:251], v[80:83], v[160:163]
    ds_read_b64_tr_b16 v[236:237], v207 offset:25088
    v_cvt_pk_bf16_f32 v100, v40, v41
    v_mfma_f32_16x16x32_bf16 v[168:171], v[248:251], v[84:87], v[168:171]
    ds_read_b64_tr_b16 v[238:239], v207 offset:27136
    v_cvt_pk_bf16_f32 v101, v42, v43
    v_mfma_f32_16x16x32_bf16 v[176:179], v[248:251], v[88:91], v[176:179]
    v_cvt_pk_bf16_f32 v102, v44, v45
    v_cvt_pk_bf16_f32 v103, v46, v47
    v_mfma_f32_16x16x32_bf16 v[184:187], v[248:251], v[92:95], v[184:187]
    buffer_load_dwordx4 v208, s[64:67], s18 offen offset:2048 lds
    ds_write_b128 v211, v[100:103] offset:41088
    v_accvgpr_read_b32 v32, a80
    v_accvgpr_read_b32 v33, a81
    v_accvgpr_read_b32 v34, a82
    v_accvgpr_read_b32 v35, a83
    v_accvgpr_read_b32 v36, a84
    v_accvgpr_read_b32 v37, a85
    v_accvgpr_read_b32 v38, a86
    v_accvgpr_read_b32 v39, a87
    v_pk_mul_f32 v[32:33], v[32:33], v[52:53] op_sel_hi:[1,0]
    v_pk_mul_f32 v[34:35], v[34:35], v[52:53] op_sel_hi:[1,0]
    v_pk_mul_f32 v[36:37], v[36:37], v[52:53] op_sel_hi:[1,0]
    v_pk_mul_f32 v[38:39], v[38:39], v[52:53] op_sel_hi:[1,0]
    v_mfma_f32_16x16x32_bf16 v[164:167], v[252:255], v[80:83], v[164:167]
    v_cvt_pk_bf16_f32 v104, v32, v33
    v_cvt_pk_bf16_f32 v105, v34, v35
    v_mfma_f32_16x16x32_bf16 v[172:175], v[252:255], v[84:87], v[172:175]
    v_cvt_pk_bf16_f32 v106, v36, v37
    v_cvt_pk_bf16_f32 v107, v38, v39
    v_mfma_f32_16x16x32_bf16 v[180:183], v[252:255], v[88:91], v[180:183]
    buffer_load_dwordx4 v209, s[64:67], s18 offen offset:3072 lds
    ds_write_b128 v212, v[104:107] offset:128
    v_mfma_f32_16x16x32_bf16 v[188:191], v[252:255], v[92:95], v[188:191]
    s_waitcnt vmcnt(12) lgkmcnt(2)
    v_accvgpr_read_b32 v40, a88
    v_accvgpr_read_b32 v41, a89
    v_accvgpr_read_b32 v42, a90
    v_accvgpr_read_b32 v43, a91
    v_accvgpr_read_b32 v44, a92
    v_accvgpr_read_b32 v45, a93
    v_accvgpr_read_b32 v46, a94
    v_accvgpr_read_b32 v47, a95
    v_pk_mul_f32 v[40:41], v[40:41], v[54:55] op_sel_hi:[1,0]
    v_pk_mul_f32 v[42:43], v[42:43], v[54:55] op_sel_hi:[1,0]
    v_pk_mul_f32 v[44:45], v[44:45], v[54:55] op_sel_hi:[1,0]
    v_pk_mul_f32 v[46:47], v[46:47], v[54:55] op_sel_hi:[1,0]
    v_mfma_f32_16x16x32_bf16 v[128:131], v[224:227], v[96:99], v[128:131]
    s_add_u32 m0, s8, 24832
    ds_read_b64_tr_b16 v[240:241], v206 offset:28928
    v_cvt_pk_bf16_f32 v108, v40, v41
    v_cvt_pk_bf16_f32 v109, v42, v43
    v_mfma_f32_16x16x32_bf16 v[136:139], v[224:227], v[100:103], v[136:139]
    s_add_u32 s18, s18, 32768
    ds_read_b64_tr_b16 v[242:243], v206 offset:30976
    v_cvt_pk_bf16_f32 v110, v44, v45
    v_cvt_pk_bf16_f32 v111, v46, v47
    v_mfma_f32_16x16x32_bf16 v[144:147], v[224:227], v[104:107], v[144:147]
    ds_read_b64_tr_b16 v[244:245], v207 offset:28928
    ds_write_b128 v212, v[108:111] offset:41088
    v_mfma_f32_16x16x32_bf16 v[152:155], v[224:227], v[108:111], v[152:155]
    buffer_load_dwordx4 v204, s[64:67], s18 offen offset:0 lds
    v_accvgpr_read_b32 v32, a96
    v_accvgpr_read_b32 v33, a97
    v_accvgpr_read_b32 v34, a98
    v_accvgpr_read_b32 v35, a99
    v_accvgpr_read_b32 v36, a100
    v_accvgpr_read_b32 v37, a101
    v_accvgpr_read_b32 v38, a102
    v_accvgpr_read_b32 v39, a103
    v_pk_mul_f32 v[32:33], v[32:33], v[48:49] op_sel_hi:[1,0]
    v_pk_mul_f32 v[34:35], v[34:35], v[48:49] op_sel_hi:[1,0]
    v_pk_mul_f32 v[36:37], v[36:37], v[48:49] op_sel_hi:[1,0]
    v_pk_mul_f32 v[38:39], v[38:39], v[48:49] op_sel_hi:[1,0]
    v_mfma_f32_16x16x32_bf16 v[132:135], v[228:231], v[96:99], v[132:135]
    ds_read_b64_tr_b16 v[246:247], v207 offset:30976
    v_cvt_pk_bf16_f32 v112, v32, v33
    v_mfma_f32_16x16x32_bf16 v[140:143], v[228:231], v[100:103], v[140:143]
    ds_read_b64_tr_b16 v[248:249], v206 offset:29184
    v_cvt_pk_bf16_f32 v113, v34, v35
    v_mfma_f32_16x16x32_bf16 v[148:151], v[228:231], v[104:107], v[148:151]
    ds_read_b64_tr_b16 v[250:251], v206 offset:31232
    v_cvt_pk_bf16_f32 v114, v36, v37
    v_cvt_pk_bf16_f32 v115, v38, v39
    v_mfma_f32_16x16x32_bf16 v[156:159], v[228:231], v[108:111], v[156:159]
    buffer_load_dwordx4 v205, s[64:67], s18 offen offset:1024 lds
    ds_write_b128 v211, v[112:115] offset:192
    v_accvgpr_read_b32 v40, a104
    v_accvgpr_read_b32 v41, a105
    v_accvgpr_read_b32 v42, a106
    v_accvgpr_read_b32 v43, a107
    v_accvgpr_read_b32 v44, a108
    v_accvgpr_read_b32 v45, a109
    v_accvgpr_read_b32 v46, a110
    v_accvgpr_read_b32 v47, a111
    v_pk_mul_f32 v[40:41], v[40:41], v[50:51] op_sel_hi:[1,0]
    v_pk_mul_f32 v[42:43], v[42:43], v[50:51] op_sel_hi:[1,0]
    v_pk_mul_f32 v[44:45], v[44:45], v[50:51] op_sel_hi:[1,0]
    v_pk_mul_f32 v[46:47], v[46:47], v[50:51] op_sel_hi:[1,0]
    v_mfma_f32_16x16x32_bf16 v[160:163], v[232:235], v[96:99], v[160:163]
    ds_read_b64_tr_b16 v[252:253], v207 offset:29184
    v_cvt_pk_bf16_f32 v116, v40, v41
    v_mfma_f32_16x16x32_bf16 v[168:171], v[232:235], v[100:103], v[168:171]
    ds_read_b64_tr_b16 v[254:255], v207 offset:31232
    v_cvt_pk_bf16_f32 v117, v42, v43
    v_mfma_f32_16x16x32_bf16 v[176:179], v[232:235], v[104:107], v[176:179]
    v_cvt_pk_bf16_f32 v118, v44, v45
    v_cvt_pk_bf16_f32 v119, v46, v47
    v_mfma_f32_16x16x32_bf16 v[184:187], v[232:235], v[108:111], v[184:187]
    buffer_load_dwordx4 v208, s[64:67], s18 offen offset:2048 lds
    ds_write_b128 v211, v[116:119] offset:41152
    v_accvgpr_read_b32 v32, a112
    v_accvgpr_read_b32 v33, a113
    v_accvgpr_read_b32 v34, a114
    v_accvgpr_read_b32 v35, a115
    v_accvgpr_read_b32 v36, a116
    v_accvgpr_read_b32 v37, a117
    v_accvgpr_read_b32 v38, a118
    v_accvgpr_read_b32 v39, a119
    v_pk_mul_f32 v[32:33], v[32:33], v[52:53] op_sel_hi:[1,0]
    v_pk_mul_f32 v[34:35], v[34:35], v[52:53] op_sel_hi:[1,0]
    v_pk_mul_f32 v[36:37], v[36:37], v[52:53] op_sel_hi:[1,0]
    v_pk_mul_f32 v[38:39], v[38:39], v[52:53] op_sel_hi:[1,0]
    v_mfma_f32_16x16x32_bf16 v[164:167], v[236:239], v[96:99], v[164:167]
    v_cvt_pk_bf16_f32 v120, v32, v33
    v_cvt_pk_bf16_f32 v121, v34, v35
    v_mfma_f32_16x16x32_bf16 v[172:175], v[236:239], v[100:103], v[172:175]
    v_cvt_pk_bf16_f32 v122, v36, v37
    v_cvt_pk_bf16_f32 v123, v38, v39
    v_mfma_f32_16x16x32_bf16 v[180:183], v[236:239], v[104:107], v[180:183]
    buffer_load_dwordx4 v209, s[64:67], s18 offen offset:3072 lds
    ds_write_b128 v212, v[120:123] offset:192
    v_mfma_f32_16x16x32_bf16 v[188:191], v[236:239], v[108:111], v[188:191]
    s_waitcnt vmcnt(12) lgkmcnt(2)
    v_accvgpr_read_b32 v40, a120
    v_accvgpr_read_b32 v41, a121
    v_accvgpr_read_b32 v42, a122
    v_accvgpr_read_b32 v43, a123
    v_accvgpr_read_b32 v44, a124
    v_accvgpr_read_b32 v45, a125
    v_accvgpr_read_b32 v46, a126
    v_accvgpr_read_b32 v47, a127
    v_pk_mul_f32 v[40:41], v[40:41], v[54:55] op_sel_hi:[1,0]
    v_pk_mul_f32 v[42:43], v[42:43], v[54:55] op_sel_hi:[1,0]
    v_pk_mul_f32 v[44:45], v[44:45], v[54:55] op_sel_hi:[1,0]
    v_pk_mul_f32 v[46:47], v[46:47], v[54:55] op_sel_hi:[1,0]
    v_mfma_f32_16x16x32_bf16 v[128:131], v[240:243], v[112:115], v[128:131]
    s_add_u32 m0, s8, 28928
    ds_read_b64_tr_b16 v[224:225], v206 offset:33024
    v_cvt_pk_bf16_f32 v124, v40, v41
    v_cvt_pk_bf16_f32 v125, v42, v43
    v_mfma_f32_16x16x32_bf16 v[136:139], v[240:243], v[116:119], v[136:139]
    s_add_u32 s18, s18, 32768
    ds_read_b64_tr_b16 v[226:227], v206 offset:35072
    v_cvt_pk_bf16_f32 v126, v44, v45
    v_cvt_pk_bf16_f32 v127, v46, v47
    v_mfma_f32_16x16x32_bf16 v[144:147], v[240:243], v[120:123], v[144:147]
    s_and_b32 s18, s18, 0x7ffff
    ds_read_b64_tr_b16 v[228:229], v207 offset:33024
    ds_write_b128 v212, v[124:127] offset:41152
    v_mfma_f32_16x16x32_bf16 v[152:155], v[240:243], v[124:127], v[152:155]
    buffer_load_dwordx4 v204, s[64:67], s18 offen offset:0 lds
    v_mfma_f32_16x16x32_bf16 v[132:135], v[244:247], v[112:115], v[132:135]
    ds_read_b64_tr_b16 v[230:231], v207 offset:35072
    s_waitcnt lgkmcnt(1)
    s_barrier
    v_mfma_f32_16x16x32_bf16 v[140:143], v[244:247], v[116:119], v[140:143]
    ds_read_b128 a[64:67], v200 offset:0
    ds_read_b128 a[68:71], v200 offset:40960
    v_mfma_f32_16x16x32_bf16 v[148:151], v[244:247], v[120:123], v[148:151]
    ds_read_b128 a[72:75], v201 offset:0
    ds_read_b128 a[76:79], v201 offset:40960
    v_mfma_f32_16x16x32_bf16 v[156:159], v[244:247], v[124:127], v[156:159]
    buffer_load_dwordx4 v205, s[64:67], s18 offen offset:1024 lds
    v_mfma_f32_16x16x32_bf16 v[160:163], v[248:251], v[112:115], v[160:163]
    ds_read_b64_tr_b16 v[232:233], v206 offset:33280
    v_mfma_f32_16x16x32_bf16 v[168:171], v[248:251], v[116:119], v[168:171]
    ds_read_b64_tr_b16 v[234:235], v206 offset:35328
    v_mfma_f32_16x16x32_bf16 v[176:179], v[248:251], v[120:123], v[176:179]
    ds_read_b64_tr_b16 v[236:237], v207 offset:33280
    ds_read_b64_tr_b16 v[238:239], v207 offset:35328
    v_mfma_f32_16x16x32_bf16 v[184:187], v[248:251], v[124:127], v[184:187]
    buffer_load_dwordx4 v208, s[64:67], s18 offen offset:2048 lds
    v_mfma_f32_16x16x32_bf16 v[164:167], v[252:255], v[112:115], v[164:167]
    ds_read_b128 a[80:83], v200 offset:64
    v_mfma_f32_16x16x32_bf16 v[172:175], v[252:255], v[116:119], v[172:175]
    ds_read_b128 a[84:87], v200 offset:41024
    v_mfma_f32_16x16x32_bf16 v[180:183], v[252:255], v[120:123], v[180:183]
    buffer_load_dwordx4 v209, s[64:67], s18 offen offset:3072 lds
    v_mfma_f32_16x16x32_bf16 v[188:191], v[252:255], v[124:127], v[188:191]
    s_waitcnt vmcnt(12) lgkmcnt(2)
    ds_read_b128 a[88:91], v201 offset:64
    ds_read_b128 a[92:95], v201 offset:41024
    v_mfma_f32_16x16x32_bf16 v[128:131], v[224:227], a[64:67], v[128:131]
    s_add_u32 m0, s8, 33024
    ds_read_b64_tr_b16 v[240:241], v206 offset:16640
    v_mfma_f32_16x16x32_bf16 v[136:139], v[224:227], a[68:71], v[136:139]
    s_add_u32 s18, s18, 32768
    ds_read_b64_tr_b16 v[242:243], v206 offset:18688
    v_mfma_f32_16x16x32_bf16 v[144:147], v[224:227], a[72:75], v[144:147]
    ds_read_b64_tr_b16 v[244:245], v207 offset:16640
    v_mfma_f32_16x16x32_bf16 v[152:155], v[224:227], a[76:79], v[152:155]
    buffer_load_dwordx4 v204, s[64:67], s18 offen offset:0 lds
    v_mfma_f32_16x16x32_bf16 v[132:135], v[228:231], a[64:67], v[132:135]
    ds_read_b64_tr_b16 v[246:247], v207 offset:18688
    v_mfma_f32_16x16x32_bf16 v[140:143], v[228:231], a[68:71], v[140:143]
    ds_read_b64_tr_b16 v[248:249], v206 offset:16896
    v_mfma_f32_16x16x32_bf16 v[148:151], v[228:231], a[72:75], v[148:151]
    ds_read_b64_tr_b16 v[250:251], v206 offset:18944
    v_mfma_f32_16x16x32_bf16 v[156:159], v[228:231], a[76:79], v[156:159]
    buffer_load_dwordx4 v205, s[64:67], s18 offen offset:1024 lds
    v_mfma_f32_16x16x32_bf16 v[160:163], v[232:235], a[64:67], v[160:163]
    ds_read_b64_tr_b16 v[252:253], v207 offset:16896
    v_mfma_f32_16x16x32_bf16 v[168:171], v[232:235], a[68:71], v[168:171]
    ds_read_b64_tr_b16 v[254:255], v207 offset:18944
    v_mfma_f32_16x16x32_bf16 v[176:179], v[232:235], a[72:75], v[176:179]
    ds_read_b128 a[96:99], v200 offset:128
    v_mfma_f32_16x16x32_bf16 v[184:187], v[232:235], a[76:79], v[184:187]
    buffer_load_dwordx4 v208, s[64:67], s18 offen offset:2048 lds
    v_mfma_f32_16x16x32_bf16 v[164:167], v[236:239], a[64:67], v[164:167]
    ds_read_b128 a[100:103], v200 offset:41088
    v_mfma_f32_16x16x32_bf16 v[172:175], v[236:239], a[68:71], v[172:175]
    ds_read_b128 a[104:107], v201 offset:128
    v_mfma_f32_16x16x32_bf16 v[180:183], v[236:239], a[72:75], v[180:183]
    buffer_load_dwordx4 v209, s[64:67], s18 offen offset:3072 lds
    v_mfma_f32_16x16x32_bf16 v[188:191], v[236:239], a[76:79], v[188:191]
    s_waitcnt vmcnt(12) lgkmcnt(3)
    ds_read_b128 a[108:111], v201 offset:41088
    v_mfma_f32_16x16x32_bf16 v[128:131], v[240:243], a[80:83], v[128:131]
    s_add_u32 m0, s8, 16640
    ds_read_b64_tr_b16 v[224:225], v206 offset:20736
    v_mfma_f32_16x16x32_bf16 v[136:139], v[240:243], a[84:87], v[136:139]
    s_add_u32 s18, s18, 32768
    ds_read_b64_tr_b16 v[226:227], v206 offset:22784
    v_mfma_f32_16x16x32_bf16 v[144:147], v[240:243], a[88:91], v[144:147]
    s_lshl_b32 s94, s4, 3
    ds_read_b64_tr_b16 v[228:229], v207 offset:20736
    v_mfma_f32_16x16x32_bf16 v[152:155], v[240:243], a[92:95], v[152:155]
    buffer_load_dwordx4 v204, s[64:67], s18 offen offset:0 lds
    v_mfma_f32_16x16x32_bf16 v[132:135], v[244:247], a[80:83], v[132:135]
    s_add_u32 s94, s94, s5
    ds_read_b64_tr_b16 v[230:231], v207 offset:22784
    v_mfma_f32_16x16x32_bf16 v[140:143], v[244:247], a[84:87], v[140:143]
    s_lshl_b32 s15, s94, 16
    ds_read_b64_tr_b16 v[232:233], v206 offset:20992
    v_mfma_f32_16x16x32_bf16 v[148:151], v[244:247], a[88:91], v[148:151]
    s_lshl_b32 s94, s94, 7
    ds_read_b64_tr_b16 v[234:235], v206 offset:23040
    v_mfma_f32_16x16x32_bf16 v[156:159], v[244:247], a[92:95], v[156:159]
    buffer_load_dwordx4 v205, s[64:67], s18 offen offset:1024 lds
    v_mfma_f32_16x16x32_bf16 v[160:163], v[248:251], a[80:83], v[160:163]
    s_add_u32 s94, s94, 0x1800000
    ds_read_b64_tr_b16 v[236:237], v207 offset:20992
    v_mfma_f32_16x16x32_bf16 v[168:171], v[248:251], a[84:87], v[168:171]
    s_lshl_b32 s9, s3, 11
    ds_read_b64_tr_b16 v[238:239], v207 offset:23040
    v_mfma_f32_16x16x32_bf16 v[176:179], v[248:251], a[88:91], v[176:179]
    s_add_u32 s15, s15, s9
    ds_read_b128 a[112:115], v200 offset:192
    v_mfma_f32_16x16x32_bf16 v[184:187], v[248:251], a[92:95], v[184:187]
    buffer_load_dwordx4 v208, s[64:67], s18 offen offset:2048 lds
    v_mfma_f32_16x16x32_bf16 v[164:167], v[252:255], a[80:83], v[164:167]
    s_add_u32 s15, s15, 0x800000
    ds_read_b128 a[116:119], v200 offset:41152
    v_mfma_f32_16x16x32_bf16 v[172:175], v[252:255], a[84:87], v[172:175]
    s_mov_b32 s12, 0xbfb8aa3b
    ds_read_b128 a[120:123], v201 offset:192
    v_mfma_f32_16x16x32_bf16 v[180:183], v[252:255], a[88:91], v[180:183]
    buffer_load_dwordx4 v209, s[64:67], s18 offen offset:3072 lds
    v_mfma_f32_16x16x32_bf16 v[188:191], v[252:255], a[92:95], v[188:191]
    s_waitcnt vmcnt(12) lgkmcnt(3)
    ds_read_b128 a[124:127], v201 offset:41152
    v_mfma_f32_16x16x32_bf16 v[128:131], v[224:227], a[96:99], v[128:131]
    s_add_u32 m0, s8, 20736
    ds_read_b64_tr_b16 v[240:241], v206 offset:24832
    v_mfma_f32_16x16x32_bf16 v[136:139], v[224:227], a[100:103], v[136:139]
    s_add_u32 s18, s18, 32768
    ds_read_b64_tr_b16 v[242:243], v206 offset:26880
    v_mfma_f32_16x16x32_bf16 v[144:147], v[224:227], a[104:107], v[144:147]
    s_lshl_b32 s9, s4, 3
    ds_read_b64_tr_b16 v[244:245], v207 offset:24832
    v_mfma_f32_16x16x32_bf16 v[152:155], v[224:227], a[108:111], v[152:155]
    buffer_load_dwordx4 v204, s[64:67], s18 offen offset:0 lds
    v_mfma_f32_16x16x32_bf16 v[132:135], v[228:231], a[96:99], v[132:135]
    s_add_u32 s28, s28, 256
    ds_read_b64_tr_b16 v[246:247], v207 offset:26880
    v_mfma_f32_16x16x32_bf16 v[140:143], v[228:231], a[100:103], v[140:143]
    s_and_b32 s28, s28, 0x3ff
    ds_read_b64_tr_b16 v[248:249], v206 offset:25088
    v_add_u32 v200, s28, v194
    v_mfma_f32_16x16x32_bf16 v[148:151], v[228:231], a[104:107], v[148:151]
    s_add_u32 s9, s9, s6
    ds_read_b64_tr_b16 v[250:251], v206 offset:27136
    v_add_u32 v201, s28, v195
    v_mfma_f32_16x16x32_bf16 v[156:159], v[228:231], a[108:111], v[156:159]
    buffer_load_dwordx4 v205, s[64:67], s18 offen offset:1024 lds
    v_mfma_f32_16x16x32_bf16 v[160:163], v[232:235], a[96:99], v[160:163]
    s_lshl_b32 s13, s3, 1
    ds_read_b64_tr_b16 v[252:253], v207 offset:25088
    v_mfma_f32_16x16x32_bf16 v[168:171], v[232:235], a[100:103], v[168:171]
    s_add_u32 s13, s13, 1
    ds_read_b64_tr_b16 v[254:255], v207 offset:27136
    v_mfma_f32_16x16x32_bf16 v[176:179], v[232:235], a[104:107], v[176:179]
    s_lshl_b32 s10, s9, 3
    ds_read_b128 a[128:131], v200 offset:0
    v_mfma_f32_16x16x32_bf16 v[184:187], v[232:235], a[108:111], v[184:187]
    buffer_load_dwordx4 v208, s[64:67], s18 offen offset:2048 lds
    v_mfma_f32_16x16x32_bf16 v[164:167], v[236:239], a[96:99], v[164:167]
    s_add_u32 s10, s10, s13
    ds_read_b128 a[132:135], v200 offset:40960
    v_mfma_f32_16x16x32_bf16 v[172:175], v[236:239], a[100:103], v[172:175]
    s_lshl_b32 s10, s10, 13
    ds_read_b128 a[136:139], v201 offset:0
    v_mfma_f32_16x16x32_bf16 v[180:183], v[236:239], a[104:107], v[180:183]
    buffer_load_dwordx4 v209, s[64:67], s18 offen offset:3072 lds
    v_mfma_f32_16x16x32_bf16 v[188:191], v[236:239], a[108:111], v[188:191]
    s_waitcnt vmcnt(12) lgkmcnt(3)
    ds_read_b128 a[140:143], v201 offset:40960
    v_mfma_f32_16x16x32_bf16 v[128:131], v[240:243], a[112:115], v[128:131]
    s_add_u32 m0, s8, 24832
    ds_read_b64_tr_b16 v[224:225], v206 offset:28928
    v_mfma_f32_16x16x32_bf16 v[136:139], v[240:243], a[116:119], v[136:139]
    s_add_u32 s18, s18, 32768
    ds_read_b64_tr_b16 v[226:227], v206 offset:30976
    v_mfma_f32_16x16x32_bf16 v[144:147], v[240:243], a[120:123], v[144:147]
    s_and_b32 s18, s18, 0x7ffff
    ds_read_b64_tr_b16 v[228:229], v207 offset:28928
    v_mfma_f32_16x16x32_bf16 v[152:155], v[240:243], a[124:127], v[152:155]
    buffer_load_dwordx4 v204, s[64:67], s18 offen offset:0 lds
    v_mfma_f32_16x16x32_bf16 v[132:135], v[244:247], a[112:115], v[132:135]
    s_add_u32 s20, s10, 0x800000
    ds_read_b64_tr_b16 v[230:231], v207 offset:30976
    v_mfma_f32_16x16x32_bf16 v[140:143], v[244:247], a[116:119], v[140:143]
    s_add_u32 s30, s20, 4096
    ds_read_b64_tr_b16 v[232:233], v206 offset:29184
    v_mfma_f32_16x16x32_bf16 v[148:151], v[244:247], a[120:123], v[148:151]
    s_lshl_b32 s11, s9, 4
    ds_read_b64_tr_b16 v[234:235], v206 offset:31232
    v_mfma_f32_16x16x32_bf16 v[156:159], v[244:247], a[124:127], v[156:159]
    buffer_load_dwordx4 v205, s[64:67], s18 offen offset:1024 lds
    v_mfma_f32_16x16x32_bf16 v[160:163], v[248:251], a[112:115], v[160:163]
    s_add_u32 s11, s11, s13
    ds_read_b64_tr_b16 v[236:237], v207 offset:29184
    v_mfma_f32_16x16x32_bf16 v[168:171], v[248:251], a[116:119], v[168:171]
    s_lshl_b32 s11, s11, 3
    ds_read_b64_tr_b16 v[238:239], v207 offset:31232
    v_mfma_f32_16x16x32_bf16 v[176:179], v[248:251], a[120:123], v[176:179]
    s_add_u32 s11, s11, 0x1800000
    ds_read_b128 a[144:147], v200 offset:64
    v_mfma_f32_16x16x32_bf16 v[184:187], v[248:251], a[124:127], v[184:187]
    buffer_load_dwordx4 v208, s[64:67], s18 offen offset:2048 lds
    v_mfma_f32_16x16x32_bf16 v[164:167], v[252:255], a[112:115], v[164:167]
    s_xor_b32 s13, s11, 0x88
    ds_read_b128 a[148:151], v200 offset:41024
    v_mfma_f32_16x16x32_bf16 v[172:175], v[252:255], a[116:119], v[172:175]
    s_mov_b32 s7, 0
    ds_read_b128 a[152:155], v201 offset:64
    v_mfma_f32_16x16x32_bf16 v[180:183], v[252:255], a[120:123], v[180:183]
    buffer_load_dwordx4 v209, s[64:67], s18 offen offset:3072 lds
    v_mfma_f32_16x16x32_bf16 v[188:191], v[252:255], a[124:127], v[188:191]
    s_waitcnt vmcnt(12) lgkmcnt(3)
    ds_read_b128 a[156:159], v201 offset:41024
    v_mfma_f32_16x16x32_bf16 v[128:131], v[224:227], a[128:131], v[128:131]
    s_add_u32 m0, s8, 28928
    ds_read_b64_tr_b16 v[240:241], v206 offset:33024
    v_mfma_f32_16x16x32_bf16 v[136:139], v[224:227], a[132:135], v[136:139]
    s_add_u32 s18, s18, 32768
    ds_read_b64_tr_b16 v[242:243], v206 offset:35072
    v_mfma_f32_16x16x32_bf16 v[144:147], v[224:227], a[136:139], v[144:147]
    s_mov_b32 s22, 0
    ds_read_b64_tr_b16 v[244:245], v207 offset:33024
    v_mfma_f32_16x16x32_bf16 v[152:155], v[224:227], a[140:143], v[152:155]
    buffer_load_dwordx4 v204, s[64:67], s18 offen offset:0 lds
    v_mfma_f32_16x16x32_bf16 v[132:135], v[228:231], a[128:131], v[132:135]
    s_lshl_b32 s9, s3, 11
    ds_read_b64_tr_b16 v[246:247], v207 offset:35072
    v_add_u32 v221, s9, v192
    v_mfma_f32_16x16x32_bf16 v[140:143], v[228:231], a[132:135], v[140:143]
    s_lshl_b32 s10, s3, 12
    ds_read_b64_tr_b16 v[248:249], v206 offset:33280
    v_mfma_f32_16x16x32_bf16 v[148:151], v[228:231], a[136:139], v[148:151]
    s_add_u32 s10, s10, 24832
    ds_read_b64_tr_b16 v[250:251], v206 offset:35328
    v_mfma_f32_16x16x32_bf16 v[156:159], v[228:231], a[140:143], v[156:159]
    buffer_load_dwordx4 v205, s[64:67], s18 offen offset:1024 lds
    v_mfma_f32_16x16x32_bf16 v[160:163], v[232:235], a[128:131], v[160:163]
    s_cmp_eq_u32 s3, 3
    s_cselect_b32 s10, 16640, s10
    ds_read_b64_tr_b16 v[252:253], v207 offset:33280
    v_mfma_f32_16x16x32_bf16 v[168:171], v[232:235], a[132:135], v[168:171]
    ds_read_b64_tr_b16 v[254:255], v207 offset:35328
    v_add_u32 v219, s10, v192
    v_mfma_f32_16x16x32_bf16 v[176:179], v[232:235], a[136:139], v[176:179]
    ds_read_b128 a[160:163], v200 offset:128
    v_add_u32 v220, 81920, v219
    v_mfma_f32_16x16x32_bf16 v[184:187], v[232:235], a[140:143], v[184:187]
    buffer_load_dwordx4 v208, s[64:67], s18 offen offset:2048 lds
    v_mfma_f32_16x16x32_bf16 v[164:167], v[236:239], a[128:131], v[164:167]
    s_mov_b32 s21, 1
    ds_read_b128 a[164:167], v200 offset:41088
    v_mfma_f32_16x16x32_bf16 v[172:175], v[236:239], a[132:135], v[172:175]
    ds_read_b128 a[168:171], v201 offset:128
    v_mfma_f32_16x16x32_bf16 v[180:183], v[236:239], a[136:139], v[180:183]
    buffer_load_dwordx4 v209, s[64:67], s18 offen offset:3072 lds
    v_mfma_f32_16x16x32_bf16 v[188:191], v[236:239], a[140:143], v[188:191]
    s_waitcnt vmcnt(12) lgkmcnt(3)
    ds_read_b128 a[172:175], v201 offset:41088
    v_mfma_f32_16x16x32_bf16 v[128:131], v[240:243], a[144:147], v[128:131]
    s_add_u32 m0, s8, 33024
    ds_read_b64_tr_b16 v[224:225], v206 offset:16640
    v_mfma_f32_16x16x32_bf16 v[136:139], v[240:243], a[148:151], v[136:139]
    s_add_u32 s18, s18, 32768
    ds_read_b64_tr_b16 v[226:227], v206 offset:18688
    v_mfma_f32_16x16x32_bf16 v[144:147], v[240:243], a[152:155], v[144:147]
    ds_read_b64_tr_b16 v[228:229], v207 offset:16640
    v_mfma_f32_16x16x32_bf16 v[152:155], v[240:243], a[156:159], v[152:155]
    buffer_load_dwordx4 v204, s[64:67], s18 offen offset:0 lds
    v_mfma_f32_16x16x32_bf16 v[132:135], v[244:247], a[144:147], v[132:135]
    ds_read_b64_tr_b16 v[230:231], v207 offset:18688
    v_mfma_f32_16x16x32_bf16 v[140:143], v[244:247], a[148:151], v[140:143]
    ds_read_b64_tr_b16 v[232:233], v206 offset:16896
    v_mfma_f32_16x16x32_bf16 v[148:151], v[244:247], a[152:155], v[148:151]
    ds_read_b64_tr_b16 v[234:235], v206 offset:18944
    v_mfma_f32_16x16x32_bf16 v[156:159], v[244:247], a[156:159], v[156:159]
    buffer_load_dwordx4 v205, s[64:67], s18 offen offset:1024 lds
    v_mfma_f32_16x16x32_bf16 v[160:163], v[248:251], a[144:147], v[160:163]
    ds_read_b64_tr_b16 v[236:237], v207 offset:16896
    v_mfma_f32_16x16x32_bf16 v[168:171], v[248:251], a[148:151], v[168:171]
    ds_read_b64_tr_b16 v[238:239], v207 offset:18944
    v_mfma_f32_16x16x32_bf16 v[176:179], v[248:251], a[152:155], v[176:179]
    ds_read_b128 a[176:179], v200 offset:192
    v_mfma_f32_16x16x32_bf16 v[184:187], v[248:251], a[156:159], v[184:187]
    buffer_load_dwordx4 v208, s[64:67], s18 offen offset:2048 lds
    v_mfma_f32_16x16x32_bf16 v[164:167], v[252:255], a[144:147], v[164:167]
    ds_read_b128 a[180:183], v200 offset:41152
    v_mfma_f32_16x16x32_bf16 v[172:175], v[252:255], a[148:151], v[172:175]
    ds_read_b128 a[184:187], v201 offset:192
    v_mfma_f32_16x16x32_bf16 v[180:183], v[252:255], a[152:155], v[180:183]
    buffer_load_dwordx4 v209, s[64:67], s18 offen offset:3072 lds
    v_mfma_f32_16x16x32_bf16 v[188:191], v[252:255], a[156:159], v[188:191]
    s_waitcnt vmcnt(12) lgkmcnt(3)
    ds_read_b128 a[188:191], v201 offset:41152
    v_mfma_f32_16x16x32_bf16 v[128:131], v[224:227], a[160:163], v[128:131]
    s_add_u32 m0, s8, 16640
    ds_read_b64_tr_b16 v[240:241], v206 offset:20736
    v_mfma_f32_16x16x32_bf16 v[136:139], v[224:227], a[164:167], v[136:139]
    s_add_u32 s18, s18, 32768
    ds_read_b64_tr_b16 v[242:243], v206 offset:22784
    v_mfma_f32_16x16x32_bf16 v[144:147], v[224:227], a[168:171], v[144:147]
    ds_read_b64_tr_b16 v[244:245], v207 offset:20736
    v_mfma_f32_16x16x32_bf16 v[152:155], v[224:227], a[172:175], v[152:155]
    buffer_load_dwordx4 v204, s[64:67], s18 offen offset:0 lds
    v_mfma_f32_16x16x32_bf16 v[132:135], v[228:231], a[160:163], v[132:135]
    s_add_u32 s28, s28, 256
    ds_read_b64_tr_b16 v[246:247], v207 offset:22784
    v_mfma_f32_16x16x32_bf16 v[140:143], v[228:231], a[164:167], v[140:143]
    s_and_b32 s28, s28, 0x3ff
    ds_read_b64_tr_b16 v[248:249], v206 offset:20992
    v_add_u32 v200, s28, v194
    v_mfma_f32_16x16x32_bf16 v[148:151], v[228:231], a[168:171], v[148:151]
    ds_read_b64_tr_b16 v[250:251], v206 offset:23040
    v_add_u32 v201, s28, v195
    v_mfma_f32_16x16x32_bf16 v[156:159], v[228:231], a[172:175], v[156:159]
    buffer_load_dwordx4 v205, s[64:67], s18 offen offset:1024 lds
    v_mfma_f32_16x16x32_bf16 v[160:163], v[232:235], a[160:163], v[160:163]
    ds_read_b64_tr_b16 v[252:253], v207 offset:20992
    v_mfma_f32_16x16x32_bf16 v[168:171], v[232:235], a[164:167], v[168:171]
    ds_read_b64_tr_b16 v[254:255], v207 offset:23040
    v_mfma_f32_16x16x32_bf16 v[176:179], v[232:235], a[168:171], v[176:179]
    ds_read_b128 v[0:3], v200 offset:0
    v_mfma_f32_16x16x32_bf16 v[184:187], v[232:235], a[172:175], v[184:187]
    buffer_load_dwordx4 v208, s[64:67], s18 offen offset:2048 lds
    v_mfma_f32_16x16x32_bf16 v[164:167], v[236:239], a[160:163], v[164:167]
    ds_read_b128 v[4:7], v200 offset:40960
    v_mfma_f32_16x16x32_bf16 v[172:175], v[236:239], a[164:167], v[172:175]
    ds_read_b128 v[8:11], v201 offset:0
    v_mfma_f32_16x16x32_bf16 v[180:183], v[236:239], a[168:171], v[180:183]
    buffer_load_dwordx4 v209, s[64:67], s18 offen offset:3072 lds
    v_mfma_f32_16x16x32_bf16 v[188:191], v[236:239], a[172:175], v[188:191]
    s_waitcnt vmcnt(12) lgkmcnt(3)
    ds_read_b128 v[12:15], v201 offset:40960
    v_mfma_f32_16x16x32_bf16 v[128:131], v[240:243], a[176:179], v[128:131]
    s_add_u32 m0, s8, 20736
    ds_read_b64_tr_b16 v[224:225], v206 offset:24832
    v_mfma_f32_16x16x32_bf16 v[136:139], v[240:243], a[180:183], v[136:139]
    s_add_u32 s18, s18, 32768
    ds_read_b64_tr_b16 v[226:227], v206 offset:26880
    v_mfma_f32_16x16x32_bf16 v[144:147], v[240:243], a[184:187], v[144:147]
    s_xor_b32 s18, s18, 128
    s_and_b32 s18, s18, 0x7ffff
    ds_read_b64_tr_b16 v[228:229], v207 offset:24832
    v_mfma_f32_16x16x32_bf16 v[152:155], v[240:243], a[188:191], v[152:155]
    buffer_load_dwordx4 v204, s[64:67], s18 offen offset:0 lds
    v_mfma_f32_16x16x32_bf16 v[132:135], v[244:247], a[176:179], v[132:135]
    ds_read_b64_tr_b16 v[230:231], v207 offset:26880
    v_mfma_f32_16x16x32_bf16 v[140:143], v[244:247], a[180:183], v[140:143]
    ds_read_b64_tr_b16 v[232:233], v206 offset:25088
    v_mfma_f32_16x16x32_bf16 v[148:151], v[244:247], a[184:187], v[148:151]
    ds_read_b64_tr_b16 v[234:235], v206 offset:27136
    v_mfma_f32_16x16x32_bf16 v[156:159], v[244:247], a[188:191], v[156:159]
    buffer_load_dwordx4 v205, s[64:67], s18 offen offset:1024 lds
    v_mfma_f32_16x16x32_bf16 v[160:163], v[248:251], a[176:179], v[160:163]
    ds_read_b64_tr_b16 v[236:237], v207 offset:25088
    v_mfma_f32_16x16x32_bf16 v[168:171], v[248:251], a[180:183], v[168:171]
    ds_read_b64_tr_b16 v[238:239], v207 offset:27136
    v_mfma_f32_16x16x32_bf16 v[176:179], v[248:251], a[184:187], v[176:179]
    ds_read_b128 v[16:19], v200 offset:64
    v_mfma_f32_16x16x32_bf16 v[184:187], v[248:251], a[188:191], v[184:187]
    buffer_load_dwordx4 v208, s[64:67], s18 offen offset:2048 lds
    v_mfma_f32_16x16x32_bf16 v[164:167], v[252:255], a[176:179], v[164:167]
    ds_read_b128 v[20:23], v200 offset:41024
    v_mfma_f32_16x16x32_bf16 v[172:175], v[252:255], a[180:183], v[172:175]
    ds_read_b128 v[24:27], v201 offset:64
    v_mfma_f32_16x16x32_bf16 v[180:183], v[252:255], a[184:187], v[180:183]
    buffer_load_dwordx4 v209, s[64:67], s18 offen offset:3072 lds
    v_mfma_f32_16x16x32_bf16 v[188:191], v[252:255], a[188:191], v[188:191]
    s_waitcnt vmcnt(12) lgkmcnt(3)
    ds_read_b128 v[28:31], v201 offset:41024
    v_mfma_f32_16x16x32_bf16 v[128:131], v[224:227], v[0:3], v[128:131]
    s_add_u32 m0, s8, 24832
    ds_read_b64_tr_b16 v[240:241], v206 offset:28928
    v_bfe_u32 v197, v192, 8, 1
    v_mfma_f32_16x16x32_bf16 v[136:139], v[224:227], v[4:7], v[136:139]
    s_add_u32 s18, s18, 32768
    ds_read_b64_tr_b16 v[242:243], v206 offset:30976
    v_lshrrev_b32 v196, 9, v192
    v_mfma_f32_16x16x32_bf16 v[144:147], v[224:227], v[8:11], v[144:147]
    ds_read_b64_tr_b16 v[244:245], v207 offset:28928
    v_lshl_add_u32 v197, v197, 1, v196
    v_mfma_f32_16x16x32_bf16 v[152:155], v[224:227], v[12:15], v[152:155]
    buffer_load_dwordx4 v204, s[64:67], s18 offen offset:0 lds
    v_mfma_f32_16x16x32_bf16 v[132:135], v[228:231], v[0:3], v[132:135]
    ds_read_b64_tr_b16 v[246:247], v207 offset:30976
    v_lshlrev_b32 v197, 4, v197
    v_mfma_f32_16x16x32_bf16 v[140:143], v[228:231], v[4:7], v[140:143]
    ds_read_b64_tr_b16 v[248:249], v206 offset:29184
    v_and_b32 v196, 0xf0, v192
    v_mfma_f32_16x16x32_bf16 v[148:151], v[228:231], v[8:11], v[148:151]
    ds_read_b64_tr_b16 v[250:251], v206 offset:31232
    v_lshl_add_u32 v196, v196, 6, v197
    v_mfma_f32_16x16x32_bf16 v[156:159], v[228:231], v[12:15], v[156:159]
    buffer_load_dwordx4 v205, s[64:67], s18 offen offset:1024 lds
    v_mfma_f32_16x16x32_bf16 v[160:163], v[232:235], v[0:3], v[160:163]
    ds_read_b64_tr_b16 v[252:253], v207 offset:29184
    v_mov_b32 v198, 0x3f80
    v_mfma_f32_16x16x32_bf16 v[168:171], v[232:235], v[4:7], v[168:171]
    ds_read_b64_tr_b16 v[254:255], v207 offset:31232
    v_mov_b32 v199, 0x3f800000
    v_mfma_f32_16x16x32_bf16 v[176:179], v[232:235], v[8:11], v[176:179]
    ds_read_b128 v[32:35], v200 offset:128
    v_mov_b32 v210, 0
    v_mfma_f32_16x16x32_bf16 v[184:187], v[232:235], v[12:15], v[184:187]
    buffer_load_dwordx4 v208, s[64:67], s18 offen offset:2048 lds
    v_mfma_f32_16x16x32_bf16 v[164:167], v[236:239], v[0:3], v[164:167]
    ds_read_b128 v[36:39], v200 offset:41088
    v_add_u32 v218, s8, v192
    v_mfma_f32_16x16x32_bf16 v[172:175], v[236:239], v[4:7], v[172:175]
    ds_read_b128 v[40:43], v201 offset:128
    v_and_b32 v213, 0x70, v192
    v_mfma_f32_16x16x32_bf16 v[180:183], v[236:239], v[8:11], v[180:183]
    buffer_load_dwordx4 v209, s[64:67], s18 offen offset:3072 lds
    v_mfma_f32_16x16x32_bf16 v[188:191], v[236:239], v[12:15], v[188:191]
    s_waitcnt vmcnt(12) lgkmcnt(3)
    ds_read_b128 v[44:47], v201 offset:41088
    v_lshrrev_b32 v213, 1, v213
    v_mfma_f32_16x16x32_bf16 v[128:131], v[240:243], v[16:19], v[128:131]
    s_add_u32 m0, s8, 28928
    ds_read_b64_tr_b16 v[224:225], v206 offset:33024
    v_mfma_f32_16x16x32_bf16 v[136:139], v[240:243], v[20:23], v[136:139]
    s_add_u32 s18, s18, 32768
    ds_read_b64_tr_b16 v[226:227], v206 offset:35072
    v_mfma_f32_16x16x32_bf16 v[144:147], v[240:243], v[24:27], v[144:147]
    ds_read_b64_tr_b16 v[228:229], v207 offset:33024
    v_mfma_f32_16x16x32_bf16 v[152:155], v[240:243], v[28:31], v[152:155]
    buffer_load_dwordx4 v204, s[64:67], s18 offen offset:0 lds
    v_mfma_f32_16x16x32_bf16 v[132:135], v[244:247], v[16:19], v[132:135]
    ds_read_b64_tr_b16 v[230:231], v207 offset:35072
    v_mfma_f32_16x16x32_bf16 v[140:143], v[244:247], v[20:23], v[140:143]
    ds_read_b64_tr_b16 v[232:233], v206 offset:33280
    v_mfma_f32_16x16x32_bf16 v[148:151], v[244:247], v[24:27], v[148:151]
    ds_read_b64_tr_b16 v[234:235], v206 offset:35328
    v_mfma_f32_16x16x32_bf16 v[156:159], v[244:247], v[28:31], v[156:159]
    buffer_load_dwordx4 v205, s[64:67], s18 offen offset:1024 lds
    v_mfma_f32_16x16x32_bf16 v[160:163], v[248:251], v[16:19], v[160:163]
    ds_read_b64_tr_b16 v[236:237], v207 offset:33280
    v_mfma_f32_16x16x32_bf16 v[168:171], v[248:251], v[20:23], v[168:171]
    ds_read_b64_tr_b16 v[238:239], v207 offset:35328
    v_mfma_f32_16x16x32_bf16 v[176:179], v[248:251], v[24:27], v[176:179]
    ds_read_b128 v[48:51], v200 offset:192
    v_mfma_f32_16x16x32_bf16 v[184:187], v[248:251], v[28:31], v[184:187]
    buffer_load_dwordx4 v208, s[64:67], s18 offen offset:2048 lds
    v_mfma_f32_16x16x32_bf16 v[164:167], v[252:255], v[16:19], v[164:167]
    ds_read_b128 v[52:55], v200 offset:41152
    v_mfma_f32_16x16x32_bf16 v[172:175], v[252:255], v[20:23], v[172:175]
    ds_read_b128 v[56:59], v201 offset:192
    v_mfma_f32_16x16x32_bf16 v[180:183], v[252:255], v[24:27], v[180:183]
    buffer_load_dwordx4 v209, s[64:67], s18 offen offset:3072 lds
    v_mfma_f32_16x16x32_bf16 v[188:191], v[252:255], v[28:31], v[188:191]
    s_waitcnt vmcnt(12) lgkmcnt(3)
    ds_read_b128 v[60:63], v201 offset:41152
    v_mfma_f32_16x16x32_bf16 v[128:131], v[224:227], v[32:35], v[128:131]
    s_add_u32 m0, s8, 33024
    ds_read_b64_tr_b16 v[240:241], v206 offset:16640
    v_mfma_f32_16x16x32_bf16 v[136:139], v[224:227], v[36:39], v[136:139]
    s_add_u32 s18, s18, 32768
    ds_read_b64_tr_b16 v[242:243], v206 offset:18688
    v_mfma_f32_16x16x32_bf16 v[144:147], v[224:227], v[40:43], v[144:147]
    ds_read_b64_tr_b16 v[244:245], v207 offset:16640
    v_mfma_f32_16x16x32_bf16 v[152:155], v[224:227], v[44:47], v[152:155]
    buffer_load_dwordx4 v204, s[64:67], s18 offen offset:0 lds
    v_mfma_f32_16x16x32_bf16 v[132:135], v[228:231], v[32:35], v[132:135]
    s_add_u32 s28, s28, 256
    ds_read_b64_tr_b16 v[246:247], v207 offset:18688
    v_mfma_f32_16x16x32_bf16 v[140:143], v[228:231], v[36:39], v[140:143]
    s_and_b32 s28, s28, 0x3ff
    ds_read_b64_tr_b16 v[248:249], v206 offset:16896
    v_add_u32 v200, s28, v194
    v_mfma_f32_16x16x32_bf16 v[148:151], v[228:231], v[40:43], v[148:151]
    ds_read_b64_tr_b16 v[250:251], v206 offset:18944
    v_add_u32 v201, s28, v195
    v_mfma_f32_16x16x32_bf16 v[156:159], v[228:231], v[44:47], v[156:159]
    buffer_load_dwordx4 v205, s[64:67], s18 offen offset:1024 lds
    v_mfma_f32_16x16x32_bf16 v[160:163], v[232:235], v[32:35], v[160:163]
    ds_read_b64_tr_b16 v[252:253], v207 offset:16896
    v_mfma_f32_16x16x32_bf16 v[168:171], v[232:235], v[36:39], v[168:171]
    ds_read_b64_tr_b16 v[254:255], v207 offset:18944
    v_mfma_f32_16x16x32_bf16 v[176:179], v[232:235], v[40:43], v[176:179]
    ds_read_b128 a[0:3], v200 offset:0
    v_mfma_f32_16x16x32_bf16 v[184:187], v[232:235], v[44:47], v[184:187]
    buffer_load_dwordx4 v208, s[64:67], s18 offen offset:2048 lds
    v_mfma_f32_16x16x32_bf16 v[164:167], v[236:239], v[32:35], v[164:167]
    ds_read_b128 a[4:7], v200 offset:40960
    v_mfma_f32_16x16x32_bf16 v[172:175], v[236:239], v[36:39], v[172:175]
    ds_read_b128 a[8:11], v201 offset:0
    v_mfma_f32_16x16x32_bf16 v[180:183], v[236:239], v[40:43], v[180:183]
    buffer_load_dwordx4 v209, s[64:67], s18 offen offset:3072 lds
    v_mfma_f32_16x16x32_bf16 v[188:191], v[236:239], v[44:47], v[188:191]
    s_waitcnt vmcnt(12) lgkmcnt(3)
    ds_read_b128 a[12:15], v201 offset:40960
    v_mfma_f32_16x16x32_bf16 v[128:131], v[240:243], v[48:51], v[128:131]
    s_add_u32 m0, s8, 16640
    ds_read_b64_tr_b16 v[224:225], v206 offset:20736
    v_mfma_f32_16x16x32_bf16 v[136:139], v[240:243], v[52:55], v[136:139]
    s_add_u32 s18, s18, 32768
    ds_read_b64_tr_b16 v[226:227], v206 offset:22784
    v_mfma_f32_16x16x32_bf16 v[144:147], v[240:243], v[56:59], v[144:147]
    s_and_b32 s18, s18, 0x7ffff
    ds_read_b64_tr_b16 v[228:229], v207 offset:20736
    v_mfma_f32_16x16x32_bf16 v[152:155], v[240:243], v[60:63], v[152:155]
    buffer_load_dwordx4 v204, s[64:67], s18 offen offset:0 lds
    v_mfma_f32_16x16x32_bf16 v[132:135], v[244:247], v[48:51], v[132:135]
    ds_read_b64_tr_b16 v[230:231], v207 offset:22784
    v_mfma_f32_16x16x32_bf16 v[140:143], v[244:247], v[52:55], v[140:143]
    ds_read_b64_tr_b16 v[232:233], v206 offset:20992
    v_mfma_f32_16x16x32_bf16 v[148:151], v[244:247], v[56:59], v[148:151]
    ds_read_b64_tr_b16 v[234:235], v206 offset:23040
    v_mfma_f32_16x16x32_bf16 v[156:159], v[244:247], v[60:63], v[156:159]
    buffer_load_dwordx4 v205, s[64:67], s18 offen offset:1024 lds
    v_mfma_f32_16x16x32_bf16 v[160:163], v[248:251], v[48:51], v[160:163]
    ds_read_b64_tr_b16 v[236:237], v207 offset:20992
    v_mfma_f32_16x16x32_bf16 v[168:171], v[248:251], v[52:55], v[168:171]
    ds_read_b64_tr_b16 v[238:239], v207 offset:23040
    v_mfma_f32_16x16x32_bf16 v[176:179], v[248:251], v[56:59], v[176:179]
    ds_read_b128 a[16:19], v200 offset:64
    v_mfma_f32_16x16x32_bf16 v[184:187], v[248:251], v[60:63], v[184:187]
    buffer_load_dwordx4 v208, s[64:67], s18 offen offset:2048 lds
    v_mfma_f32_16x16x32_bf16 v[164:167], v[252:255], v[48:51], v[164:167]
    ds_read_b128 a[20:23], v200 offset:41024
    v_mfma_f32_16x16x32_bf16 v[172:175], v[252:255], v[52:55], v[172:175]
    ds_read_b128 a[24:27], v201 offset:64
    v_mfma_f32_16x16x32_bf16 v[180:183], v[252:255], v[56:59], v[180:183]
    buffer_load_dwordx4 v209, s[64:67], s18 offen offset:3072 lds
    v_mfma_f32_16x16x32_bf16 v[188:191], v[252:255], v[60:63], v[188:191]
    s_waitcnt vmcnt(12) lgkmcnt(3)
    ds_read_b128 a[28:31], v201 offset:41024
    v_mfma_f32_16x16x32_bf16 v[64:67], v[224:227], a[0:3], 0
    s_add_u32 m0, s8, 20736
    ds_read_b64_tr_b16 v[240:241], v206 offset:24832
    v_mfma_f32_16x16x32_bf16 v[72:75], v[224:227], a[4:7], 0
    s_add_u32 s18, s18, 32768
    ds_read_b64_tr_b16 v[242:243], v206 offset:26880
    v_mfma_f32_16x16x32_bf16 v[80:83], v[224:227], a[8:11], 0
    ds_read_b64_tr_b16 v[244:245], v207 offset:24832
    v_mfma_f32_16x16x32_bf16 v[88:91], v[224:227], a[12:15], 0
    buffer_load_dwordx4 v204, s[64:67], s18 offen offset:0 lds
    v_mfma_f32_16x16x32_bf16 v[68:71], v[228:231], a[0:3], 0
    ds_read_b64_tr_b16 v[246:247], v207 offset:26880
    v_mfma_f32_16x16x32_bf16 v[76:79], v[228:231], a[4:7], 0
    ds_read_b64_tr_b16 v[248:249], v206 offset:25088
    v_mfma_f32_16x16x32_bf16 v[84:87], v[228:231], a[8:11], 0
    ds_read_b64_tr_b16 v[250:251], v206 offset:27136
    v_mfma_f32_16x16x32_bf16 v[92:95], v[228:231], a[12:15], 0
    buffer_load_dwordx4 v205, s[64:67], s18 offen offset:1024 lds
    v_mfma_f32_16x16x32_bf16 v[96:99], v[232:235], a[0:3], 0
    ds_read_b64_tr_b16 v[252:253], v207 offset:25088
    v_cvt_pk_bf16_f32 v128, v128, v129
    v_mfma_f32_16x16x32_bf16 v[104:107], v[232:235], a[4:7], 0
    ds_read_b64_tr_b16 v[254:255], v207 offset:27136
    v_cvt_pk_bf16_f32 v129, v130, v131
    v_mfma_f32_16x16x32_bf16 v[112:115], v[232:235], a[8:11], 0
    ds_read_b128 a[32:35], v200 offset:128
    v_cvt_pk_bf16_f32 v130, v132, v133
    v_mfma_f32_16x16x32_bf16 v[120:123], v[232:235], a[12:15], 0
    buffer_load_dwordx4 v208, s[64:67], s18 offen offset:2048 lds
    v_mfma_f32_16x16x32_bf16 v[100:103], v[236:239], a[0:3], 0
    ds_read_b128 a[36:39], v200 offset:41088
    v_cvt_pk_bf16_f32 v131, v134, v135
    v_mfma_f32_16x16x32_bf16 v[108:111], v[236:239], a[4:7], 0
    ds_read_b128 a[40:43], v201 offset:128
    v_cvt_pk_bf16_f32 v136, v136, v137
    v_mfma_f32_16x16x32_bf16 v[116:119], v[236:239], a[8:11], 0
    buffer_load_dwordx4 v209, s[64:67], s18 offen offset:3072 lds
    v_mfma_f32_16x16x32_bf16 v[124:127], v[236:239], a[12:15], 0
    s_waitcnt vmcnt(12) lgkmcnt(3)
    ds_read_b128 a[44:47], v201 offset:41088
    v_cvt_pk_bf16_f32 v137, v138, v139
    v_mfma_f32_16x16x32_bf16 v[64:67], v[240:243], a[16:19], v[64:67]
    s_add_u32 m0, s8, 24832
    ds_read_b64_tr_b16 v[224:225], v206 offset:28928
    v_cvt_pk_bf16_f32 v138, v140, v141
    v_mfma_f32_16x16x32_bf16 v[72:75], v[240:243], a[20:23], v[72:75]
    s_add_u32 s18, s18, 32768
    ds_read_b64_tr_b16 v[226:227], v206 offset:30976
    v_cvt_pk_bf16_f32 v139, v142, v143
    v_mfma_f32_16x16x32_bf16 v[80:83], v[240:243], a[24:27], v[80:83]
    ds_read_b64_tr_b16 v[228:229], v207 offset:28928
    v_cvt_pk_bf16_f32 v144, v144, v145
    v_mfma_f32_16x16x32_bf16 v[88:91], v[240:243], a[28:31], v[88:91]
    buffer_load_dwordx4 v204, s[64:67], s18 offen offset:0 lds
    v_mfma_f32_16x16x32_bf16 v[68:71], v[244:247], a[16:19], v[68:71]
    ds_read_b64_tr_b16 v[230:231], v207 offset:30976
    v_cvt_pk_bf16_f32 v145, v146, v147
    v_mfma_f32_16x16x32_bf16 v[76:79], v[244:247], a[20:23], v[76:79]
    ds_read_b64_tr_b16 v[232:233], v206 offset:29184
    v_cvt_pk_bf16_f32 v146, v148, v149
    v_mfma_f32_16x16x32_bf16 v[84:87], v[244:247], a[24:27], v[84:87]
    ds_read_b64_tr_b16 v[234:235], v206 offset:31232
    v_cvt_pk_bf16_f32 v147, v150, v151
    v_mfma_f32_16x16x32_bf16 v[92:95], v[244:247], a[28:31], v[92:95]
    buffer_load_dwordx4 v205, s[64:67], s18 offen offset:1024 lds
    v_mfma_f32_16x16x32_bf16 v[96:99], v[248:251], a[16:19], v[96:99]
    ds_read_b64_tr_b16 v[236:237], v207 offset:29184
    v_cvt_pk_bf16_f32 v152, v152, v153
    v_mfma_f32_16x16x32_bf16 v[104:107], v[248:251], a[20:23], v[104:107]
    ds_read_b64_tr_b16 v[238:239], v207 offset:31232
    v_cvt_pk_bf16_f32 v153, v154, v155
    v_mfma_f32_16x16x32_bf16 v[112:115], v[248:251], a[24:27], v[112:115]
    ds_read_b128 a[48:51], v200 offset:192
    v_cvt_pk_bf16_f32 v154, v156, v157
    v_mfma_f32_16x16x32_bf16 v[120:123], v[248:251], a[28:31], v[120:123]
    buffer_load_dwordx4 v208, s[64:67], s18 offen offset:2048 lds
    v_mfma_f32_16x16x32_bf16 v[100:103], v[252:255], a[16:19], v[100:103]
    ds_read_b128 a[52:55], v200 offset:41152
    v_cvt_pk_bf16_f32 v155, v158, v159
    v_mfma_f32_16x16x32_bf16 v[108:111], v[252:255], a[20:23], v[108:111]
    ds_read_b128 a[56:59], v201 offset:192
    v_cvt_pk_bf16_f32 v160, v160, v161
    v_mfma_f32_16x16x32_bf16 v[116:119], v[252:255], a[24:27], v[116:119]
    buffer_load_dwordx4 v209, s[64:67], s18 offen offset:3072 lds
    v_mfma_f32_16x16x32_bf16 v[124:127], v[252:255], a[28:31], v[124:127]
    s_waitcnt vmcnt(12) lgkmcnt(3)
    ds_read_b128 a[60:63], v201 offset:41152
    v_cvt_pk_bf16_f32 v161, v162, v163
    v_mfma_f32_16x16x32_bf16 v[64:67], v[224:227], a[32:35], v[64:67]
    s_add_u32 m0, s8, 28928
    ds_read_b64_tr_b16 v[240:241], v206 offset:33024
    v_cvt_pk_bf16_f32 v162, v164, v165
    v_mfma_f32_16x16x32_bf16 v[72:75], v[224:227], a[36:39], v[72:75]
    s_add_u32 s18, s18, 32768
    ds_read_b64_tr_b16 v[242:243], v206 offset:35072
    v_cvt_pk_bf16_f32 v163, v166, v167
    v_mfma_f32_16x16x32_bf16 v[80:83], v[224:227], a[40:43], v[80:83]
    ds_read_b64_tr_b16 v[244:245], v207 offset:33024
    v_cvt_pk_bf16_f32 v168, v168, v169
    v_mfma_f32_16x16x32_bf16 v[88:91], v[224:227], a[44:47], v[88:91]
    buffer_load_dwordx4 v204, s[64:67], s18 offen offset:0 lds
    v_mfma_f32_16x16x32_bf16 v[68:71], v[228:231], a[32:35], v[68:71]
    ds_read_b64_tr_b16 v[246:247], v207 offset:35072
    v_cvt_pk_bf16_f32 v169, v170, v171
    v_mfma_f32_16x16x32_bf16 v[76:79], v[228:231], a[36:39], v[76:79]
    ds_read_b64_tr_b16 v[248:249], v206 offset:33280
    v_cvt_pk_bf16_f32 v170, v172, v173
    v_mfma_f32_16x16x32_bf16 v[84:87], v[228:231], a[40:43], v[84:87]
    ds_read_b64_tr_b16 v[250:251], v206 offset:35328
    v_cvt_pk_bf16_f32 v171, v174, v175
    v_mfma_f32_16x16x32_bf16 v[92:95], v[228:231], a[44:47], v[92:95]
    buffer_load_dwordx4 v205, s[64:67], s18 offen offset:1024 lds
    v_mfma_f32_16x16x32_bf16 v[96:99], v[232:235], a[32:35], v[96:99]
    ds_read_b64_tr_b16 v[252:253], v207 offset:33280
    v_cvt_pk_bf16_f32 v176, v176, v177
    v_mfma_f32_16x16x32_bf16 v[104:107], v[232:235], a[36:39], v[104:107]
    ds_read_b64_tr_b16 v[254:255], v207 offset:35328
    v_cvt_pk_bf16_f32 v177, v178, v179
    v_mfma_f32_16x16x32_bf16 v[112:115], v[232:235], a[40:43], v[112:115]
    v_cvt_pk_bf16_f32 v178, v180, v181
    v_cvt_pk_bf16_f32 v179, v182, v183
    v_mfma_f32_16x16x32_bf16 v[120:123], v[232:235], a[44:47], v[120:123]
    buffer_load_dwordx4 v208, s[64:67], s18 offen offset:2048 lds
    v_mfma_f32_16x16x32_bf16 v[100:103], v[236:239], a[32:35], v[100:103]
    v_cvt_pk_bf16_f32 v184, v184, v185
    v_cvt_pk_bf16_f32 v185, v186, v187
    v_mfma_f32_16x16x32_bf16 v[108:111], v[236:239], a[36:39], v[108:111]
    v_cvt_pk_bf16_f32 v186, v188, v189
    v_cvt_pk_bf16_f32 v187, v190, v191
    v_mfma_f32_16x16x32_bf16 v[116:119], v[236:239], a[40:43], v[116:119]
    buffer_load_dwordx4 v209, s[64:67], s18 offen offset:3072 lds
    v_mfma_f32_16x16x32_bf16 v[124:127], v[236:239], a[44:47], v[124:127]
    s_waitcnt vmcnt(12) lgkmcnt(0)
    v_mfma_f32_16x16x32_bf16 v[64:67], v[240:243], a[48:51], v[64:67]
    s_add_u32 m0, s8, 33024
    ds_read_b64_tr_b16 v[224:225], v206 offset:16640
    v_mfma_f32_16x16x32_bf16 v[72:75], v[240:243], a[52:55], v[72:75]
    s_add_u32 s18, s18, 32768
    ds_read_b64_tr_b16 v[226:227], v206 offset:18688
    v_mfma_f32_16x16x32_bf16 v[80:83], v[240:243], a[56:59], v[80:83]
    s_and_b32 s18, s18, 0x7ffff
    ds_read_b64_tr_b16 v[228:229], v207 offset:16640
    v_mfma_f32_16x16x32_bf16 v[88:91], v[240:243], a[60:63], v[88:91]
    buffer_load_dwordx4 v204, s[64:67], s18 offen offset:0 lds
    v_mfma_f32_16x16x32_bf16 v[68:71], v[244:247], a[48:51], v[68:71]
    ds_read_b64_tr_b16 v[230:231], v207 offset:18688
    v_mfma_f32_16x16x32_bf16 v[76:79], v[244:247], a[52:55], v[76:79]
    ds_read_b64_tr_b16 v[232:233], v206 offset:16896
    v_mfma_f32_16x16x32_bf16 v[84:87], v[244:247], a[56:59], v[84:87]
    ds_read_b64_tr_b16 v[234:235], v206 offset:18944
    v_mfma_f32_16x16x32_bf16 v[92:95], v[244:247], a[60:63], v[92:95]
    buffer_load_dwordx4 v205, s[64:67], s18 offen offset:1024 lds
    v_mfma_f32_16x16x32_bf16 v[96:99], v[248:251], a[48:51], v[96:99]
    ds_read_b64_tr_b16 v[236:237], v207 offset:16896
    v_mfma_f32_16x16x32_bf16 v[104:107], v[248:251], a[52:55], v[104:107]
    ds_read_b64_tr_b16 v[238:239], v207 offset:18944
    v_mfma_f32_16x16x32_bf16 v[112:115], v[248:251], a[56:59], v[112:115]
    v_mfma_f32_16x16x32_bf16 v[120:123], v[248:251], a[60:63], v[120:123]
    buffer_load_dwordx4 v208, s[64:67], s18 offen offset:2048 lds
    v_mfma_f32_16x16x32_bf16 v[100:103], v[252:255], a[48:51], v[100:103]
    v_mfma_f32_16x16x32_bf16 v[108:111], v[252:255], a[52:55], v[108:111]
    v_mfma_f32_16x16x32_bf16 v[116:119], v[252:255], a[56:59], v[116:119]
    buffer_load_dwordx4 v209, s[64:67], s18 offen offset:3072 lds
    v_mfma_f32_16x16x32_bf16 v[124:127], v[252:255], a[60:63], v[124:127]
    s_waitcnt vmcnt(12) lgkmcnt(0)
    v_mfma_f32_16x16x32_bf16 v[64:67], v[224:227], a[64:67], v[64:67]
    s_add_u32 m0, s8, 16640
    ds_read_b64_tr_b16 v[240:241], v206 offset:20736
    v_mfma_f32_16x16x32_bf16 v[72:75], v[224:227], a[68:71], v[72:75]
    s_add_u32 s18, s18, 32768
    ds_read_b64_tr_b16 v[242:243], v206 offset:22784
    v_mfma_f32_16x16x32_bf16 v[80:83], v[224:227], a[72:75], v[80:83]
    ds_read_b64_tr_b16 v[244:245], v207 offset:20736
    v_mfma_f32_16x16x32_bf16 v[88:91], v[224:227], a[76:79], v[88:91]
    buffer_load_dwordx4 v204, s[64:67], s18 offen offset:0 lds
    v_mfma_f32_16x16x32_bf16 v[68:71], v[228:231], a[64:67], v[68:71]
    ds_read_b64_tr_b16 v[246:247], v207 offset:22784
    v_mfma_f32_16x16x32_bf16 v[76:79], v[228:231], a[68:71], v[76:79]
    ds_read_b64_tr_b16 v[248:249], v206 offset:20992
    v_mfma_f32_16x16x32_bf16 v[84:87], v[228:231], a[72:75], v[84:87]
    ds_read_b64_tr_b16 v[250:251], v206 offset:23040
    v_mfma_f32_16x16x32_bf16 v[92:95], v[228:231], a[76:79], v[92:95]
    buffer_load_dwordx4 v205, s[64:67], s18 offen offset:1024 lds
    v_mfma_f32_16x16x32_bf16 v[96:99], v[232:235], a[64:67], v[96:99]
    ds_read_b64_tr_b16 v[252:253], v207 offset:20992
    v_mfma_f32_16x16x32_bf16 v[104:107], v[232:235], a[68:71], v[104:107]
    ds_read_b64_tr_b16 v[254:255], v207 offset:23040
    v_mfma_f32_16x16x32_bf16 v[112:115], v[232:235], a[72:75], v[112:115]
    v_mfma_f32_16x16x32_bf16 v[120:123], v[232:235], a[76:79], v[120:123]
    buffer_load_dwordx4 v208, s[64:67], s18 offen offset:2048 lds
    v_mfma_f32_16x16x32_bf16 v[100:103], v[236:239], a[64:67], v[100:103]
    s_barrier
    v_mfma_f32_16x16x32_bf16 v[108:111], v[236:239], a[68:71], v[108:111]
    v_mfma_f32_16x16x32_bf16 v[116:119], v[236:239], a[72:75], v[116:119]
    buffer_load_dwordx4 v209, s[64:67], s18 offen offset:3072 lds
    v_mfma_f32_16x16x32_bf16 v[124:127], v[236:239], a[76:79], v[124:127]
    s_waitcnt vmcnt(12) lgkmcnt(0)
    v_mfma_f32_16x16x32_bf16 v[64:67], v[240:243], a[80:83], v[64:67]
    s_add_u32 m0, s8, 20736
    ds_read_b64_tr_b16 v[224:225], v206 offset:24832
    v_mfma_f32_16x16x32_bf16 v[72:75], v[240:243], a[84:87], v[72:75]
    s_add_u32 s18, s18, 32768
    ds_read_b64_tr_b16 v[226:227], v206 offset:26880
    v_mfma_f32_16x16x32_bf16 v[80:83], v[240:243], a[88:91], v[80:83]
    ds_read_b64_tr_b16 v[228:229], v207 offset:24832
    v_mfma_f32_16x16x32_bf16 v[88:91], v[240:243], a[92:95], v[88:91]
    buffer_load_dwordx4 v204, s[64:67], s18 offen offset:0 lds
    v_mfma_f32_16x16x32_bf16 v[68:71], v[244:247], a[80:83], v[68:71]
    ds_read_b64_tr_b16 v[230:231], v207 offset:26880
    v_mfma_f32_16x16x32_bf16 v[76:79], v[244:247], a[84:87], v[76:79]
    ds_read_b64_tr_b16 v[232:233], v206 offset:25088
    v_mfma_f32_16x16x32_bf16 v[84:87], v[244:247], a[88:91], v[84:87]
    ds_read_b64_tr_b16 v[234:235], v206 offset:27136
    v_mfma_f32_16x16x32_bf16 v[92:95], v[244:247], a[92:95], v[92:95]
    buffer_load_dwordx4 v205, s[64:67], s18 offen offset:1024 lds
    v_mfma_f32_16x16x32_bf16 v[96:99], v[248:251], a[80:83], v[96:99]
    ds_read_b64_tr_b16 v[236:237], v207 offset:25088
    v_mfma_f32_16x16x32_bf16 v[104:107], v[248:251], a[84:87], v[104:107]
    ds_read_b64_tr_b16 v[238:239], v207 offset:27136
    v_mfma_f32_16x16x32_bf16 v[112:115], v[248:251], a[88:91], v[112:115]
    v_mfma_f32_16x16x32_bf16 v[120:123], v[248:251], a[92:95], v[120:123]
    buffer_load_dwordx4 v208, s[64:67], s18 offen offset:2048 lds
    v_mfma_f32_16x16x32_bf16 v[100:103], v[252:255], a[80:83], v[100:103]
    v_mfma_f32_16x16x32_bf16 v[108:111], v[252:255], a[84:87], v[108:111]
    v_mfma_f32_16x16x32_bf16 v[116:119], v[252:255], a[88:91], v[116:119]
    buffer_load_dwordx4 v209, s[64:67], s18 offen offset:3072 lds
    v_mfma_f32_16x16x32_bf16 v[124:127], v[252:255], a[92:95], v[124:127]
    s_waitcnt vmcnt(12) lgkmcnt(0)
    v_mfma_f32_16x16x32_bf16 v[64:67], v[224:227], a[96:99], v[64:67]
    s_add_u32 m0, s8, 24832
    ds_read_b64_tr_b16 v[240:241], v206 offset:28928
    v_mfma_f32_16x16x32_bf16 v[72:75], v[224:227], a[100:103], v[72:75]
    s_add_u32 s18, s18, 32768
    ds_read_b64_tr_b16 v[242:243], v206 offset:30976
    v_mfma_f32_16x16x32_bf16 v[80:83], v[224:227], a[104:107], v[80:83]
    ds_read_b64_tr_b16 v[244:245], v207 offset:28928
    v_mfma_f32_16x16x32_bf16 v[88:91], v[224:227], a[108:111], v[88:91]
    buffer_load_dwordx4 v204, s[64:67], s18 offen offset:0 lds
    v_mfma_f32_16x16x32_bf16 v[68:71], v[228:231], a[96:99], v[68:71]
    ds_read_b64_tr_b16 v[246:247], v207 offset:30976
    v_mfma_f32_16x16x32_bf16 v[76:79], v[228:231], a[100:103], v[76:79]
    ds_read_b64_tr_b16 v[248:249], v206 offset:29184
    v_mfma_f32_16x16x32_bf16 v[84:87], v[228:231], a[104:107], v[84:87]
    ds_read_b64_tr_b16 v[250:251], v206 offset:31232
    v_mfma_f32_16x16x32_bf16 v[92:95], v[228:231], a[108:111], v[92:95]
    buffer_load_dwordx4 v205, s[64:67], s18 offen offset:1024 lds
    v_mfma_f32_16x16x32_bf16 v[96:99], v[232:235], a[96:99], v[96:99]
    ds_read_b64_tr_b16 v[252:253], v207 offset:29184
    v_mfma_f32_16x16x32_bf16 v[104:107], v[232:235], a[100:103], v[104:107]
    ds_read_b64_tr_b16 v[254:255], v207 offset:31232
    v_mfma_f32_16x16x32_bf16 v[112:115], v[232:235], a[104:107], v[112:115]
    v_mfma_f32_16x16x32_bf16 v[120:123], v[232:235], a[108:111], v[120:123]
    buffer_load_dwordx4 v208, s[64:67], s18 offen offset:2048 lds
    v_mfma_f32_16x16x32_bf16 v[100:103], v[236:239], a[96:99], v[100:103]
    v_mfma_f32_16x16x32_bf16 v[108:111], v[236:239], a[100:103], v[108:111]
    v_mfma_f32_16x16x32_bf16 v[116:119], v[236:239], a[104:107], v[116:119]
    buffer_load_dwordx4 v209, s[64:67], s18 offen offset:3072 lds
    v_mfma_f32_16x16x32_bf16 v[124:127], v[236:239], a[108:111], v[124:127]
    s_waitcnt vmcnt(12) lgkmcnt(0)
    v_mfma_f32_16x16x32_bf16 v[64:67], v[240:243], a[112:115], v[64:67]
    s_add_u32 m0, s8, 28928
    ds_read_b64_tr_b16 v[224:225], v206 offset:33024
    v_mfma_f32_16x16x32_bf16 v[72:75], v[240:243], a[116:119], v[72:75]
    s_add_u32 s18, s18, 32768
    ds_read_b64_tr_b16 v[226:227], v206 offset:35072
    v_mfma_f32_16x16x32_bf16 v[80:83], v[240:243], a[120:123], v[80:83]
    s_and_b32 s18, s18, 0x7ffff
    ds_read_b64_tr_b16 v[228:229], v207 offset:33024
    v_mfma_f32_16x16x32_bf16 v[88:91], v[240:243], a[124:127], v[88:91]
    buffer_load_dwordx4 v204, s[64:67], s18 offen offset:0 lds
    v_mfma_f32_16x16x32_bf16 v[68:71], v[244:247], a[112:115], v[68:71]
    ds_read_b64_tr_b16 v[230:231], v207 offset:35072
    v_mfma_f32_16x16x32_bf16 v[76:79], v[244:247], a[116:119], v[76:79]
    ds_read_b64_tr_b16 v[232:233], v206 offset:33280
    v_mfma_f32_16x16x32_bf16 v[84:87], v[244:247], a[120:123], v[84:87]
    ds_read_b64_tr_b16 v[234:235], v206 offset:35328
    v_mfma_f32_16x16x32_bf16 v[92:95], v[244:247], a[124:127], v[92:95]
    buffer_load_dwordx4 v205, s[64:67], s18 offen offset:1024 lds
    v_mfma_f32_16x16x32_bf16 v[96:99], v[248:251], a[112:115], v[96:99]
    ds_read_b64_tr_b16 v[236:237], v207 offset:33280
    v_mfma_f32_16x16x32_bf16 v[104:107], v[248:251], a[116:119], v[104:107]
    ds_read_b64_tr_b16 v[238:239], v207 offset:35328
    v_mfma_f32_16x16x32_bf16 v[112:115], v[248:251], a[120:123], v[112:115]
    v_mfma_f32_16x16x32_bf16 v[120:123], v[248:251], a[124:127], v[120:123]
    buffer_load_dwordx4 v208, s[64:67], s18 offen offset:2048 lds
    v_mfma_f32_16x16x32_bf16 v[100:103], v[252:255], a[112:115], v[100:103]
    v_mfma_f32_16x16x32_bf16 v[108:111], v[252:255], a[116:119], v[108:111]
    v_mfma_f32_16x16x32_bf16 v[116:119], v[252:255], a[120:123], v[116:119]
    buffer_load_dwordx4 v209, s[64:67], s18 offen offset:3072 lds
    v_mfma_f32_16x16x32_bf16 v[124:127], v[252:255], a[124:127], v[124:127]
    s_waitcnt vmcnt(12) lgkmcnt(0)
    v_mfma_f32_16x16x32_bf16 v[64:67], v[224:227], a[128:131], v[64:67]
    s_add_u32 m0, s8, 33024
    ds_read_b64_tr_b16 v[240:241], v206 offset:16640
    v_mfma_f32_16x16x32_bf16 v[72:75], v[224:227], a[132:135], v[72:75]
    s_add_u32 s18, s18, 32768
    ds_read_b64_tr_b16 v[242:243], v206 offset:18688
    v_mfma_f32_16x16x32_bf16 v[80:83], v[224:227], a[136:139], v[80:83]
    ds_read_b64_tr_b16 v[244:245], v207 offset:16640
    v_mfma_f32_16x16x32_bf16 v[88:91], v[224:227], a[140:143], v[88:91]
    buffer_load_dwordx4 v204, s[64:67], s18 offen offset:0 lds
    v_mfma_f32_16x16x32_bf16 v[68:71], v[228:231], a[128:131], v[68:71]
    ds_read_b64_tr_b16 v[246:247], v207 offset:18688
    v_mfma_f32_16x16x32_bf16 v[76:79], v[228:231], a[132:135], v[76:79]
    ds_read_b64_tr_b16 v[248:249], v206 offset:16896
    v_mfma_f32_16x16x32_bf16 v[84:87], v[228:231], a[136:139], v[84:87]
    ds_read_b64_tr_b16 v[250:251], v206 offset:18944
    v_mfma_f32_16x16x32_bf16 v[92:95], v[228:231], a[140:143], v[92:95]
    buffer_load_dwordx4 v205, s[64:67], s18 offen offset:1024 lds
    v_mfma_f32_16x16x32_bf16 v[96:99], v[232:235], a[128:131], v[96:99]
    ds_read_b64_tr_b16 v[252:253], v207 offset:16896
    v_mfma_f32_16x16x32_bf16 v[104:107], v[232:235], a[132:135], v[104:107]
    ds_read_b64_tr_b16 v[254:255], v207 offset:18944
    v_mfma_f32_16x16x32_bf16 v[112:115], v[232:235], a[136:139], v[112:115]
    v_mfma_f32_16x16x32_bf16 v[120:123], v[232:235], a[140:143], v[120:123]
    buffer_load_dwordx4 v208, s[64:67], s18 offen offset:2048 lds
    v_mfma_f32_16x16x32_bf16 v[100:103], v[236:239], a[128:131], v[100:103]
    v_mfma_f32_16x16x32_bf16 v[108:111], v[236:239], a[132:135], v[108:111]
    v_mfma_f32_16x16x32_bf16 v[116:119], v[236:239], a[136:139], v[116:119]
    buffer_load_dwordx4 v209, s[64:67], s18 offen offset:3072 lds
    v_mfma_f32_16x16x32_bf16 v[124:127], v[236:239], a[140:143], v[124:127]
    s_waitcnt vmcnt(12) lgkmcnt(0)
    v_mfma_f32_16x16x32_bf16 v[64:67], v[240:243], a[144:147], v[64:67]
    s_add_u32 m0, s8, 16640
    ds_read_b64_tr_b16 v[224:225], v206 offset:20736
    v_mfma_f32_16x16x32_bf16 v[72:75], v[240:243], a[148:151], v[72:75]
    s_add_u32 s18, s18, 32768
    ds_read_b64_tr_b16 v[226:227], v206 offset:22784
    v_mfma_f32_16x16x32_bf16 v[80:83], v[240:243], a[152:155], v[80:83]
    ds_read_b64_tr_b16 v[228:229], v207 offset:20736
    v_mfma_f32_16x16x32_bf16 v[88:91], v[240:243], a[156:159], v[88:91]
    buffer_load_dwordx4 v204, s[64:67], s18 offen offset:0 lds
    v_mfma_f32_16x16x32_bf16 v[68:71], v[244:247], a[144:147], v[68:71]
    ds_read_b64_tr_b16 v[230:231], v207 offset:22784
    v_mfma_f32_16x16x32_bf16 v[76:79], v[244:247], a[148:151], v[76:79]
    ds_read_b64_tr_b16 v[232:233], v206 offset:20992
    v_mfma_f32_16x16x32_bf16 v[84:87], v[244:247], a[152:155], v[84:87]
    ds_read_b64_tr_b16 v[234:235], v206 offset:23040
    v_mfma_f32_16x16x32_bf16 v[92:95], v[244:247], a[156:159], v[92:95]
    buffer_load_dwordx4 v205, s[64:67], s18 offen offset:1024 lds
    v_mfma_f32_16x16x32_bf16 v[96:99], v[248:251], a[144:147], v[96:99]
    ds_read_b64_tr_b16 v[236:237], v207 offset:20992
    v_mfma_f32_16x16x32_bf16 v[104:107], v[248:251], a[148:151], v[104:107]
    ds_read_b64_tr_b16 v[238:239], v207 offset:23040
    v_mfma_f32_16x16x32_bf16 v[112:115], v[248:251], a[152:155], v[112:115]
    v_mfma_f32_16x16x32_bf16 v[120:123], v[248:251], a[156:159], v[120:123]
    buffer_load_dwordx4 v208, s[64:67], s18 offen offset:2048 lds
    v_mfma_f32_16x16x32_bf16 v[100:103], v[252:255], a[144:147], v[100:103]
    v_mfma_f32_16x16x32_bf16 v[108:111], v[252:255], a[148:151], v[108:111]
    v_mfma_f32_16x16x32_bf16 v[116:119], v[252:255], a[152:155], v[116:119]
    buffer_load_dwordx4 v209, s[64:67], s18 offen offset:3072 lds
    v_mfma_f32_16x16x32_bf16 v[124:127], v[252:255], a[156:159], v[124:127]
    s_waitcnt vmcnt(12) lgkmcnt(0)
    v_mfma_f32_16x16x32_bf16 v[64:67], v[224:227], a[160:163], v[64:67]
    s_add_u32 m0, s8, 20736
    ds_read_b64_tr_b16 v[240:241], v206 offset:24832
    v_mfma_f32_16x16x32_bf16 v[72:75], v[224:227], a[164:167], v[72:75]
    s_add_u32 s18, s18, 32768
    ds_read_b64_tr_b16 v[242:243], v206 offset:26880
    v_mfma_f32_16x16x32_bf16 v[80:83], v[224:227], a[168:171], v[80:83]
    ds_read_b64_tr_b16 v[244:245], v207 offset:24832
    v_mfma_f32_16x16x32_bf16 v[88:91], v[224:227], a[172:175], v[88:91]
    buffer_load_dwordx4 v204, s[64:67], s18 offen offset:0 lds
    v_mfma_f32_16x16x32_bf16 v[68:71], v[228:231], a[160:163], v[68:71]
    ds_read_b64_tr_b16 v[246:247], v207 offset:26880
    v_mfma_f32_16x16x32_bf16 v[76:79], v[228:231], a[164:167], v[76:79]
    ds_read_b64_tr_b16 v[248:249], v206 offset:25088
    v_mfma_f32_16x16x32_bf16 v[84:87], v[228:231], a[168:171], v[84:87]
    ds_read_b64_tr_b16 v[250:251], v206 offset:27136
    v_mfma_f32_16x16x32_bf16 v[92:95], v[228:231], a[172:175], v[92:95]
    buffer_load_dwordx4 v205, s[64:67], s18 offen offset:1024 lds
    v_mfma_f32_16x16x32_bf16 v[96:99], v[232:235], a[160:163], v[96:99]
    ds_read_b64_tr_b16 v[252:253], v207 offset:25088
    v_mfma_f32_16x16x32_bf16 v[104:107], v[232:235], a[164:167], v[104:107]
    ds_read_b64_tr_b16 v[254:255], v207 offset:27136
    v_mfma_f32_16x16x32_bf16 v[112:115], v[232:235], a[168:171], v[112:115]
    v_mfma_f32_16x16x32_bf16 v[120:123], v[232:235], a[172:175], v[120:123]
    buffer_load_dwordx4 v208, s[64:67], s18 offen offset:2048 lds
    v_mfma_f32_16x16x32_bf16 v[100:103], v[236:239], a[160:163], v[100:103]
    v_mfma_f32_16x16x32_bf16 v[108:111], v[236:239], a[164:167], v[108:111]
    v_mfma_f32_16x16x32_bf16 v[116:119], v[236:239], a[168:171], v[116:119]
    buffer_load_dwordx4 v209, s[64:67], s18 offen offset:3072 lds
    v_mfma_f32_16x16x32_bf16 v[124:127], v[236:239], a[172:175], v[124:127]
    s_waitcnt vmcnt(12) lgkmcnt(0)
    v_mfma_f32_16x16x32_bf16 v[64:67], v[240:243], a[176:179], v[64:67]
    ds_read_b64_tr_b16 v[224:225], v206 offset:28928
    buffer_store_dwordx4 v[128:131], v192, s[72:75], s20 offen offset:0 sc1
    v_mfma_f32_16x16x32_bf16 v[72:75], v[240:243], a[180:183], v[72:75]
    ds_read_b64_tr_b16 v[226:227], v206 offset:30976
    v_mfma_f32_16x16x32_bf16 v[80:83], v[240:243], a[184:187], v[80:83]
    ds_read_b64_tr_b16 v[228:229], v207 offset:28928
    v_mfma_f32_16x16x32_bf16 v[88:91], v[240:243], a[188:191], v[88:91]
    ds_read_b64_tr_b16 v[230:231], v207 offset:30976
    v_mfma_f32_16x16x32_bf16 v[68:71], v[244:247], a[176:179], v[68:71]
    ds_read_b64_tr_b16 v[232:233], v206 offset:29184
    v_mfma_f32_16x16x32_bf16 v[76:79], v[244:247], a[180:183], v[76:79]
    ds_read_b64_tr_b16 v[234:235], v206 offset:31232
    v_mfma_f32_16x16x32_bf16 v[84:87], v[244:247], a[184:187], v[84:87]
    ds_read_b64_tr_b16 v[236:237], v207 offset:29184
    v_mfma_f32_16x16x32_bf16 v[92:95], v[244:247], a[188:191], v[92:95]
    ds_read_b64_tr_b16 v[238:239], v207 offset:31232
    v_mfma_f32_16x16x32_bf16 v[96:99], v[248:251], a[176:179], v[96:99]
    buffer_store_dwordx4 v[136:139], v192, s[72:75], s20 offen offset:2048 sc1
    v_mfma_f32_16x16x32_bf16 v[104:107], v[248:251], a[180:183], v[104:107]
    v_mfma_f32_16x16x32_bf16 v[112:115], v[248:251], a[184:187], v[112:115]
    v_mfma_f32_16x16x32_bf16 v[120:123], v[248:251], a[188:191], v[120:123]
    v_mfma_f32_16x16x32_bf16 v[100:103], v[252:255], a[176:179], v[100:103]
    v_mfma_f32_16x16x32_bf16 v[108:111], v[252:255], a[180:183], v[108:111]
    v_mfma_f32_16x16x32_bf16 v[116:119], v[252:255], a[184:187], v[116:119]
    v_mfma_f32_16x16x32_bf16 v[124:127], v[252:255], a[188:191], v[124:127]
    s_waitcnt vmcnt(10) lgkmcnt(0)
    v_mfma_f32_16x16x32_bf16 v[64:67], v[224:227], v[0:3], v[64:67]
    ds_read_b64_tr_b16 v[240:241], v206 offset:33024
    buffer_store_dwordx4 v[144:147], v192, s[72:75], s30 offen offset:0 sc1
    v_mfma_f32_16x16x32_bf16 v[72:75], v[224:227], v[4:7], v[72:75]
    ds_read_b64_tr_b16 v[242:243], v206 offset:35072
    v_mfma_f32_16x16x32_bf16 v[80:83], v[224:227], v[8:11], v[80:83]
    ds_read_b64_tr_b16 v[244:245], v207 offset:33024
    v_mfma_f32_16x16x32_bf16 v[88:91], v[224:227], v[12:15], v[88:91]
    ds_read_b64_tr_b16 v[246:247], v207 offset:35072
    v_mfma_f32_16x16x32_bf16 v[68:71], v[228:231], v[0:3], v[68:71]
    ds_read_b64_tr_b16 v[248:249], v206 offset:33280
    v_mfma_f32_16x16x32_bf16 v[76:79], v[228:231], v[4:7], v[76:79]
    ds_read_b64_tr_b16 v[250:251], v206 offset:35328
    v_mfma_f32_16x16x32_bf16 v[84:87], v[228:231], v[8:11], v[84:87]
    ds_read_b64_tr_b16 v[252:253], v207 offset:33280
    v_mfma_f32_16x16x32_bf16 v[92:95], v[228:231], v[12:15], v[92:95]
    ds_read_b64_tr_b16 v[254:255], v207 offset:35328
    v_mfma_f32_16x16x32_bf16 v[96:99], v[232:235], v[0:3], v[96:99]
    buffer_store_dwordx4 v[152:155], v192, s[72:75], s30 offen offset:2048 sc1
    v_mfma_f32_16x16x32_bf16 v[104:107], v[232:235], v[4:7], v[104:107]
    v_mfma_f32_16x16x32_bf16 v[112:115], v[232:235], v[8:11], v[112:115]
    v_mfma_f32_16x16x32_bf16 v[120:123], v[232:235], v[12:15], v[120:123]
    v_mfma_f32_16x16x32_bf16 v[100:103], v[236:239], v[0:3], v[100:103]
    v_mfma_f32_16x16x32_bf16 v[108:111], v[236:239], v[4:7], v[108:111]
    v_mfma_f32_16x16x32_bf16 v[116:119], v[236:239], v[8:11], v[116:119]
    v_mfma_f32_16x16x32_bf16 v[124:127], v[236:239], v[12:15], v[124:127]
    s_waitcnt vmcnt(8) lgkmcnt(0)
    v_mfma_f32_16x16x32_bf16 v[64:67], v[240:243], v[16:19], v[64:67]
    ds_read_b64_tr_b16 v[224:225], v206 offset:16640
    buffer_store_dwordx4 v[160:163], v192, s[72:75], s20 offen offset:1024 sc1
    v_mfma_f32_16x16x32_bf16 v[72:75], v[240:243], v[20:23], v[72:75]
    ds_read_b64_tr_b16 v[226:227], v206 offset:18688
    v_mfma_f32_16x16x32_bf16 v[80:83], v[240:243], v[24:27], v[80:83]
    ds_read_b64_tr_b16 v[228:229], v207 offset:16640
    v_mfma_f32_16x16x32_bf16 v[88:91], v[240:243], v[28:31], v[88:91]
    ds_read_b64_tr_b16 v[230:231], v207 offset:18688
    v_mfma_f32_16x16x32_bf16 v[68:71], v[244:247], v[16:19], v[68:71]
    ds_read_b64_tr_b16 v[232:233], v206 offset:16896
    v_mfma_f32_16x16x32_bf16 v[76:79], v[244:247], v[20:23], v[76:79]
    ds_read_b64_tr_b16 v[234:235], v206 offset:18944
    v_mfma_f32_16x16x32_bf16 v[84:87], v[244:247], v[24:27], v[84:87]
    ds_read_b64_tr_b16 v[236:237], v207 offset:16896
    v_mfma_f32_16x16x32_bf16 v[92:95], v[244:247], v[28:31], v[92:95]
    ds_read_b64_tr_b16 v[238:239], v207 offset:18944
    v_mfma_f32_16x16x32_bf16 v[96:99], v[248:251], v[16:19], v[96:99]
    buffer_store_dwordx4 v[168:171], v192, s[72:75], s20 offen offset:3072 sc1
    v_mfma_f32_16x16x32_bf16 v[104:107], v[248:251], v[20:23], v[104:107]
    v_mfma_f32_16x16x32_bf16 v[112:115], v[248:251], v[24:27], v[112:115]
    v_mfma_f32_16x16x32_bf16 v[120:123], v[248:251], v[28:31], v[120:123]
    v_mfma_f32_16x16x32_bf16 v[100:103], v[252:255], v[16:19], v[100:103]
    v_mfma_f32_16x16x32_bf16 v[108:111], v[252:255], v[20:23], v[108:111]
    v_mfma_f32_16x16x32_bf16 v[116:119], v[252:255], v[24:27], v[116:119]
    v_mfma_f32_16x16x32_bf16 v[124:127], v[252:255], v[28:31], v[124:127]
    s_waitcnt vmcnt(6) lgkmcnt(0)
    v_mfma_f32_16x16x32_bf16 v[64:67], v[224:227], v[32:35], v[64:67]
    ds_read_b64_tr_b16 v[240:241], v206 offset:20736
    buffer_store_dwordx4 v[176:179], v192, s[72:75], s30 offen offset:1024 sc1
    v_mfma_f32_16x16x32_bf16 v[72:75], v[224:227], v[36:39], v[72:75]
    ds_read_b64_tr_b16 v[242:243], v206 offset:22784
    v_mfma_f32_16x16x32_bf16 v[80:83], v[224:227], v[40:43], v[80:83]
    ds_read_b64_tr_b16 v[244:245], v207 offset:20736
    v_mfma_f32_16x16x32_bf16 v[88:91], v[224:227], v[44:47], v[88:91]
    ds_read_b64_tr_b16 v[246:247], v207 offset:22784
    v_mfma_f32_16x16x32_bf16 v[68:71], v[228:231], v[32:35], v[68:71]
    ds_read_b64_tr_b16 v[248:249], v206 offset:20992
    v_mfma_f32_16x16x32_bf16 v[76:79], v[228:231], v[36:39], v[76:79]
    ds_read_b64_tr_b16 v[250:251], v206 offset:23040
    v_mfma_f32_16x16x32_bf16 v[84:87], v[228:231], v[40:43], v[84:87]
    ds_read_b64_tr_b16 v[252:253], v207 offset:20992
    v_mfma_f32_16x16x32_bf16 v[92:95], v[228:231], v[44:47], v[92:95]
    ds_read_b64_tr_b16 v[254:255], v207 offset:23040
    v_mfma_f32_16x16x32_bf16 v[96:99], v[232:235], v[32:35], v[96:99]
    buffer_store_dwordx4 v[184:187], v192, s[72:75], s30 offen offset:3072 sc1
    v_mfma_f32_16x16x32_bf16 v[104:107], v[232:235], v[36:39], v[104:107]
    v_mfma_f32_16x16x32_bf16 v[112:115], v[232:235], v[40:43], v[112:115]
    v_mfma_f32_16x16x32_bf16 v[120:123], v[232:235], v[44:47], v[120:123]
    v_mfma_f32_16x16x32_bf16 v[100:103], v[236:239], v[32:35], v[100:103]
    v_mfma_f32_16x16x32_bf16 v[108:111], v[236:239], v[36:39], v[108:111]
    v_mfma_f32_16x16x32_bf16 v[116:119], v[236:239], v[40:43], v[116:119]
    v_mfma_f32_16x16x32_bf16 v[124:127], v[236:239], v[44:47], v[124:127]
    s_waitcnt lgkmcnt(0)
    v_mfma_f32_16x16x32_bf16 v[64:67], v[240:243], v[48:51], v[64:67]
    s_xor_b32 s20, s20, 0x12000
    v_mfma_f32_16x16x32_bf16 v[72:75], v[240:243], v[52:55], v[72:75]
    s_xor_b32 s30, s30, 0x12000
    v_mfma_f32_16x16x32_bf16 v[80:83], v[240:243], v[56:59], v[80:83]
    v_mfma_f32_16x16x32_bf16 v[88:91], v[240:243], v[60:63], v[88:91]
    v_mfma_f32_16x16x32_bf16 v[68:71], v[244:247], v[48:51], v[68:71]
    v_mfma_f32_16x16x32_bf16 v[76:79], v[244:247], v[52:55], v[76:79]
    v_mfma_f32_16x16x32_bf16 v[84:87], v[244:247], v[56:59], v[84:87]
    v_mfma_f32_16x16x32_bf16 v[92:95], v[244:247], v[60:63], v[92:95]
    v_mfma_f32_16x16x32_bf16 v[96:99], v[248:251], v[48:51], v[96:99]
    v_mfma_f32_16x16x32_bf16 v[104:107], v[248:251], v[52:55], v[104:107]
    v_mfma_f32_16x16x32_bf16 v[112:115], v[248:251], v[56:59], v[112:115]
    v_mfma_f32_16x16x32_bf16 v[120:123], v[248:251], v[60:63], v[120:123]
    v_mfma_f32_16x16x32_bf16 v[100:103], v[252:255], v[48:51], v[100:103]
    v_mfma_f32_16x16x32_bf16 v[108:111], v[252:255], v[52:55], v[108:111]
    v_mfma_f32_16x16x32_bf16 v[116:119], v[252:255], v[56:59], v[116:119]
    v_mfma_f32_16x16x32_bf16 v[124:127], v[252:255], v[60:63], v[124:127]
    s_cmp_eq_u32 s3, 0
    s_cbranch_scc1 L_own
    v_cvt_pk_bf16_f32 v64, v64, v65
    v_cvt_pk_bf16_f32 v65, v66, v67
    v_cvt_pk_bf16_f32 v66, v68, v69
    v_cvt_pk_bf16_f32 v67, v70, v71
    buffer_store_dwordx4 v[64:67], v192, s[72:75], s20 offen offset:0 sc1
    v_cvt_pk_bf16_f32 v72, v72, v73
    v_cvt_pk_bf16_f32 v73, v74, v75
    v_cvt_pk_bf16_f32 v74, v76, v77
    v_cvt_pk_bf16_f32 v75, v78, v79
    buffer_store_dwordx4 v[72:75], v192, s[72:75], s20 offen offset:2048 sc1
    v_cvt_pk_bf16_f32 v80, v80, v81
    v_cvt_pk_bf16_f32 v81, v82, v83
    v_cvt_pk_bf16_f32 v82, v84, v85
    v_cvt_pk_bf16_f32 v83, v86, v87
    buffer_store_dwordx4 v[80:83], v192, s[72:75], s30 offen offset:0 sc1
    v_cvt_pk_bf16_f32 v88, v88, v89
    v_cvt_pk_bf16_f32 v89, v90, v91
    v_cvt_pk_bf16_f32 v90, v92, v93
    v_cvt_pk_bf16_f32 v91, v94, v95
    buffer_store_dwordx4 v[88:91], v192, s[72:75], s30 offen offset:2048 sc1
    v_cvt_pk_bf16_f32 v96, v96, v97
    v_cvt_pk_bf16_f32 v97, v98, v99
    v_cvt_pk_bf16_f32 v98, v100, v101
    v_cvt_pk_bf16_f32 v99, v102, v103
    buffer_store_dwordx4 v[96:99], v192, s[72:75], s20 offen offset:1024 sc1
    v_cvt_pk_bf16_f32 v104, v104, v105
    v_cvt_pk_bf16_f32 v105, v106, v107
    v_cvt_pk_bf16_f32 v106, v108, v109
    v_cvt_pk_bf16_f32 v107, v110, v111
    buffer_store_dwordx4 v[104:107], v192, s[72:75], s20 offen offset:3072 sc1
    v_cvt_pk_bf16_f32 v112, v112, v113
    v_cvt_pk_bf16_f32 v113, v114, v115
    v_cvt_pk_bf16_f32 v114, v116, v117
    v_cvt_pk_bf16_f32 v115, v118, v119
    buffer_store_dwordx4 v[112:115], v192, s[72:75], s30 offen offset:1024 sc1
    v_cvt_pk_bf16_f32 v120, v120, v121
    v_cvt_pk_bf16_f32 v121, v122, v123
    v_cvt_pk_bf16_f32 v122, v124, v125
    v_cvt_pk_bf16_f32 v123, v126, v127
    buffer_store_dwordx4 v[120:123], v192, s[72:75], s30 offen offset:3072 sc1
L_ownback:
    ds_write_b128 v218, a[192:195] offset:24832
    ds_write_b128 v218, a[196:199] offset:25856
    ds_write_b128 v218, a[200:203] offset:26880
    ds_write_b128 v218, a[204:207] offset:27904
    ds_write_b128 v218, a[208:211] offset:28928
    ds_write_b128 v218, a[212:215] offset:29952
    ds_write_b128 v218, a[216:219] offset:30976
    ds_write_b128 v218, a[220:223] offset:32000
    ds_write_b128 v218, a[224:227] offset:33024
    ds_write_b128 v218, a[228:231] offset:34048
    ds_write_b128 v218, a[232:235] offset:35072
    ds_write_b128 v218, a[236:239] offset:36096
    ds_write_b128 v218, a[240:243] offset:16640
    ds_write_b128 v218, a[244:247] offset:17664
    ds_write_b128 v218, a[248:251] offset:18688
    ds_write_b128 v218, a[252:255] offset:19712
    ds_read_b128 v[96:99], v218 offset:37888
    ds_read_b128 v[100:103], v218 offset:38912
    s_waitcnt vmcnt(8)
    s_mov_b64 exec, 1
    buffer_store_dwordx2 v[216:217], v210, s[72:75], s11 offen sc1
    s_mov_b64 exec, -1
    s_waitcnt lgkmcnt(0)
    v_permlane16_swap_b32 v96, v98
    v_permlane16_swap_b32 v97, v99
    v_permlane16_swap_b32 v100, v102
    v_permlane16_swap_b32 v101, v103
    v_lshlrev_b32 v80, 16, v96
    v_and_b32 v81, 0xffff0000, v96
    v_lshlrev_b32 v82, 16, v97
    v_and_b32 v83, 0xffff0000, v97
    v_lshlrev_b32 v84, 16, v98
    v_and_b32 v85, 0xffff0000, v98
    v_lshlrev_b32 v86, 16, v99
    v_and_b32 v87, 0xffff0000, v99
    v_lshlrev_b32 v88, 16, v100
    v_and_b32 v89, 0xffff0000, v100
    v_lshlrev_b32 v90, 16, v101
    v_and_b32 v91, 0xffff0000, v101
    v_lshlrev_b32 v92, 16, v102
    v_and_b32 v93, 0xffff0000, v102
    v_lshlrev_b32 v94, 16, v103
    v_and_b32 v95, 0xffff0000, v103
    s_waitcnt vmcnt(1)
    s_mov_b64 exec, 1
    buffer_store_dwordx2 v[216:217], v210, s[72:75], s13 offen sc1
    s_mov_b64 exec, -1
    buffer_load_dwordx2 v[214:215], v213, s[72:75], s94 offen sc1
    s_waitcnt lgkmcnt(0)
    s_barrier
    ds_read_b128 v[0:3], v219 offset:0
    ds_read_b128 v[4:7], v219 offset:1024
    ds_read_b128 v[8:11], v219 offset:2048
    ds_read_b128 v[12:15], v219 offset:3072
    ds_read_b128 v[16:19], v219 offset:40960
    ds_read_b128 v[20:23], v219 offset:41984
    ds_read_b128 v[24:27], v219 offset:43008
    ds_read_b128 v[28:31], v219 offset:44032
    ds_read_b128 v[32:35], v220 offset:0
    ds_read_b128 v[36:39], v220 offset:1024
    ds_read_b128 v[40:43], v220 offset:2048
    ds_read_b128 v[44:47], v220 offset:3072
    ds_read_b128 v[48:51], v220 offset:40960
    ds_read_b128 v[52:55], v220 offset:41984
    ds_read_b128 v[56:59], v220 offset:43008
    ds_read_b128 v[60:63], v220 offset:44032
    s_waitcnt lgkmcnt(8)
    v_add_f32 v64, v0, v16
    v_add_f32 v65, v1, v17
    v_add_f32 v66, v2, v18
    v_add_f32 v67, v3, v19
    v_add_f32 v68, v4, v20
    v_add_f32 v69, v5, v21
    v_add_f32 v70, v6, v22
    v_add_f32 v71, v7, v23
    v_add_f32 v72, v8, v24
    v_add_f32 v73, v9, v25
    v_add_f32 v74, v10, v26
    v_add_f32 v75, v11, v27
    v_add_f32 v76, v12, v28
    v_add_f32 v77, v13, v29
    v_add_f32 v78, v14, v30
    v_add_f32 v79, v15, v31
    s_waitcnt lgkmcnt(4)
    v_add_f32 v64, v64, v32
    v_add_f32 v65, v65, v33
    v_add_f32 v66, v66, v34
    v_add_f32 v67, v67, v35
    v_add_f32 v68, v68, v36
    v_add_f32 v69, v69, v37
    v_add_f32 v70, v70, v38
    v_add_f32 v71, v71, v39
    v_add_f32 v72, v72, v40
    v_add_f32 v73, v73, v41
    v_add_f32 v74, v74, v42
    v_add_f32 v75, v75, v43
    v_add_f32 v76, v76, v44
    v_add_f32 v77, v77, v45
    v_add_f32 v78, v78, v46
    v_add_f32 v79, v79, v47
    s_waitcnt lgkmcnt(0)
    v_add_f32 v64, v64, v48
    v_add_f32 v65, v65, v49
    v_add_f32 v66, v66, v50
    v_add_f32 v67, v67, v51
    v_add_f32 v68, v68, v52
    v_add_f32 v69, v69, v53
    v_add_f32 v70, v70, v54
    v_add_f32 v71, v71, v55
    v_add_f32 v72, v72, v56
    v_add_f32 v73, v73, v57
    v_add_f32 v74, v74, v58
    v_add_f32 v75, v75, v59
    v_add_f32 v76, v76, v60
    v_add_f32 v77, v77, v61
    v_add_f32 v78, v78, v62
    v_add_f32 v79, v79, v63
    ds_read_b128 v[128:131], v221 offset:0
    ds_read_b128 v[132:135], v221 offset:1024
    s_waitcnt vmcnt(0)
    s_branch L_pchk
L_poll:
    s_sleep 1
    buffer_load_dwordx2 v[214:215], v213, s[72:75], s94 offen sc1
    s_add_u32 s40, s40, 1
    s_cmp_gt_u32 s40, 0x100000
    s_cbranch_scc1 L_pdone
    s_call_b64 s[34:35], L_side
    s_waitcnt vmcnt(0)
    s_mov_b32 s22, s21
L_pchk:
    v_cmp_eq_u64 vcc, v[214:215], v[216:217]
    s_nop 1
    s_andn2_b32 s23, vcc_lo, s21
    s_and_b32 s23, s23, 0xff
    s_cbranch_scc0 L_poll
    s_or_b32 s21, s21, s23
    s_bitcmp1_b32 s23, 1
    s_cbranch_scc0 L_sk1
    s_add_u32 s9, s15, 8192
    buffer_load_dwordx4 v[136:139], v192, s[72:75], s9 offen offset:0 sc1
    buffer_load_dwordx4 v[140:143], v192, s[72:75], s9 offen offset:1024 sc1
L_sk1:
    s_bitcmp1_b32 s23, 3
    s_cbranch_scc0 L_sk3
    s_add_u32 s9, s15, 24576
    buffer_load_dwordx4 v[152:155], v192, s[72:75], s9 offen offset:0 sc1
    buffer_load_dwordx4 v[156:159], v192, s[72:75], s9 offen offset:1024 sc1
L_sk3:
    s_bitcmp1_b32 s23, 5
    s_cbranch_scc0 L_sk5
    s_add_u32 s9, s15, 40960
    buffer_load_dwordx4 v[168:171], v192, s[72:75], s9 offen offset:0 sc1
    buffer_load_dwordx4 v[172:175], v192, s[72:75], s9 offen offset:1024 sc1
L_sk5:
    s_bitcmp1_b32 s23, 7
    s_cbranch_scc0 L_sk7
    s_add_u32 s9, s15, 57344
    buffer_load_dwordx4 v[184:187], v192, s[72:75], s9 offen offset:0 sc1
    buffer_load_dwordx4 v[188:191], v192, s[72:75], s9 offen offset:1024 sc1
L_sk7:
    s_bitcmp1_b32 s23, 2
    s_cbranch_scc0 L_sk2
    s_add_u32 s9, s15, 16384
    buffer_load_dwordx4 v[144:147], v192, s[72:75], s9 offen offset:0 sc1
    buffer_load_dwordx4 v[148:151], v192, s[72:75], s9 offen offset:1024 sc1
L_sk2:
    s_bitcmp1_b32 s23, 4
    s_cbranch_scc0 L_sk4
    s_add_u32 s9, s15, 32768
    buffer_load_dwordx4 v[160:163], v192, s[72:75], s9 offen offset:0 sc1
    buffer_load_dwordx4 v[164:167], v192, s[72:75], s9 offen offset:1024 sc1
L_sk4:
    s_bitcmp1_b32 s23, 6
    s_cbranch_scc0 L_sk6
    s_add_u32 s9, s15, 49152
    buffer_load_dwordx4 v[176:179], v192, s[72:75], s9 offen offset:0 sc1
    buffer_load_dwordx4 v[180:183], v192, s[72:75], s9 offen offset:1024 sc1
L_sk6:
    s_cmp_lg_u32 s21, 0xff
    s_cbranch_scc1 L_poll
L_pdone:
    s_call_b64 s[34:35], L_side
    s_waitcnt vmcnt(0)
    s_mov_b32 s22, 0xff
    s_call_b64 s[34:35], L_side
    v_dot2c_f32_bf16 v16, v144, v198
    v_dot2c_f32_bf16 v17, v144, v199
    v_dot2c_f32_bf16 v18, v145, v198
    v_dot2c_f32_bf16 v19, v145, v199
    v_dot2c_f32_bf16 v20, v146, v198
    v_dot2c_f32_bf16 v21, v146, v199
    v_dot2c_f32_bf16 v22, v147, v198
    v_dot2c_f32_bf16 v23, v147, v199
    v_dot2c_f32_bf16 v24, v148, v198
    v_dot2c_f32_bf16 v25, v148, v199
    v_dot2c_f32_bf16 v26, v149, v198
    v_dot2c_f32_bf16 v27, v149, v199
    v_dot2c_f32_bf16 v28, v150, v198
    v_dot2c_f32_bf16 v29, v150, v199
    v_dot2c_f32_bf16 v30, v151, v198
    v_dot2c_f32_bf16 v31, v151, v199
    v_dot2c_f32_bf16 v16, v160, v198
    v_dot2c_f32_bf16 v17, v160, v199
    v_dot2c_f32_bf16 v18, v161, v198
    v_dot2c_f32_bf16 v19, v161, v199
    v_dot2c_f32_bf16 v20, v162, v198
    v_dot2c_f32_bf16 v21, v162, v199
    v_dot2c_f32_bf16 v22, v163, v198
    v_dot2c_f32_bf16 v23, v163, v199
    v_dot2c_f32_bf16 v24, v164, v198
    v_dot2c_f32_bf16 v25, v164, v199
    v_dot2c_f32_bf16 v26, v165, v198
    v_dot2c_f32_bf16 v27, v165, v199
    v_dot2c_f32_bf16 v28, v166, v198
    v_dot2c_f32_bf16 v29, v166, v199
    v_dot2c_f32_bf16 v30, v167, v198
    v_dot2c_f32_bf16 v31, v167, v199
    v_dot2c_f32_bf16 v16, v176, v198
    v_dot2c_f32_bf16 v17, v176, v199
    v_dot2c_f32_bf16 v18, v177, v198
    v_dot2c_f32_bf16 v19, v177, v199
    v_dot2c_f32_bf16 v20, v178, v198
    v_dot2c_f32_bf16 v21, v178, v199
    v_dot2c_f32_bf16 v22, v179, v198
    v_dot2c_f32_bf16 v23, v179, v199
    v_dot2c_f32_bf16 v24, v180, v198
    v_dot2c_f32_bf16 v25, v180, v199
    v_dot2c_f32_bf16 v26, v181, v198
    v_dot2c_f32_bf16 v27, v181, v199
    v_dot2c_f32_bf16 v28, v182, v198
    v_dot2c_f32_bf16 v29, v182, v199
    v_dot2c_f32_bf16 v30, v183, v198
    v_dot2c_f32_bf16 v31, v183, v199
    s_nop 0
    v_fma_f32 v0, v0, v16, v80
    v_fma_f32 v1, v1, v17, v81
    v_fma_f32 v2, v2, v18, v82
    v_fma_f32 v3, v3, v19, v83
    v_fma_f32 v4, v4, v20, v84
    v_fma_f32 v5, v5, v21, v85
    v_fma_f32 v6, v6, v22, v86
    v_fma_f32 v7, v7, v23, v87
    v_fma_f32 v8, v8, v24, v88
    v_fma_f32 v9, v9, v25, v89
    v_fma_f32 v10, v10, v26, v90
    v_fma_f32 v11, v11, v27, v91
    v_fma_f32 v12, v12, v28, v92
    v_fma_f32 v13, v13, v29, v93
    v_fma_f32 v14, v14, v30, v94
    v_fma_f32 v15, v15, v31, v95
    v_cvt_pk_bf16_f32 v48, v0, v1
    v_cvt_pk_bf16_f32 v49, v2, v3
    v_cvt_pk_bf16_f32 v50, v4, v5
    v_cvt_pk_bf16_f32 v51, v6, v7
    v_cvt_pk_bf16_f32 v52, v8, v9
    v_cvt_pk_bf16_f32 v53, v10, v11
    v_cvt_pk_bf16_f32 v54, v12, v13
    v_cvt_pk_bf16_f32 v55, v14, v15
    v_permlane16_swap_b32 v48, v50
    v_permlane16_swap_b32 v49, v51
    v_permlane16_swap_b32 v52, v54
    v_permlane16_swap_b32 v53, v55
    buffer_store_dwordx4 v[48:51], v196, s[76:79], s31 offen offset:0
    buffer_store_dwordx4 v[52:55], v196, s[76:79], s31 offen offset:64
L_end:
    s_endpgm
L_side:
    s_bitcmp1_b32 s7, 0
    s_cbranch_scc1 L_side1
    v_mul_f32 v0, s12, v64
    v_mul_f32 v1, s12, v65
    v_mul_f32 v2, s12, v66
    v_mul_f32 v3, s12, v67
    v_mul_f32 v4, s12, v68
    v_mul_f32 v5, s12, v69
    v_mul_f32 v6, s12, v70
    v_mul_f32 v7, s12, v71
    v_mul_f32 v8, s12, v72
    v_mul_f32 v9, s12, v73
    v_mul_f32 v10, s12, v74
    v_mul_f32 v11, s12, v75
    v_mul_f32 v12, s12, v76
    v_mul_f32 v13, s12, v77
    v_mul_f32 v14, s12, v78
    v_mul_f32 v15, s12, v79
    v_exp_f32 v0, v0
    v_exp_f32 v1, v1
    v_exp_f32 v2, v2
    v_exp_f32 v3, v3
    v_exp_f32 v4, v4
    v_exp_f32 v5, v5
    v_exp_f32 v6, v6
    v_exp_f32 v7, v7
    v_exp_f32 v8, v8
    v_exp_f32 v9, v9
    v_exp_f32 v10, v10
    v_exp_f32 v11, v11
    v_exp_f32 v12, v12
    v_exp_f32 v13, v13
    v_exp_f32 v14, v14
    v_exp_f32 v15, v15
    v_add_f32 v0, 1.0, v0
    v_add_f32 v1, 1.0, v1
    v_add_f32 v2, 1.0, v2
    v_add_f32 v3, 1.0, v3
    v_add_f32 v4, 1.0, v4
    v_add_f32 v5, 1.0, v5
    v_add_f32 v6, 1.0, v6
    v_add_f32 v7, 1.0, v7
    v_add_f32 v8, 1.0, v8
    v_add_f32 v9, 1.0, v9
    v_add_f32 v10, 1.0, v10
    v_add_f32 v11, 1.0, v11
    v_add_f32 v12, 1.0, v12
    v_add_f32 v13, 1.0, v13
    v_add_f32 v14, 1.0, v14
    v_add_f32 v15, 1.0, v15
    v_rcp_f32 v0, v0
    v_rcp_f32 v1, v1
    v_rcp_f32 v2, v2
    v_rcp_f32 v3, v3
    v_rcp_f32 v4, v4
    v_rcp_f32 v5, v5
    v_rcp_f32 v6, v6
    v_rcp_f32 v7, v7
    v_rcp_f32 v8, v8
    v_rcp_f32 v9, v9
    v_rcp_f32 v10, v10
    v_rcp_f32 v11, v11
    v_rcp_f32 v12, v12
    v_rcp_f32 v13, v13
    v_rcp_f32 v14, v14
    v_rcp_f32 v15, v15
    v_mul_f32 v0, v0, v64
    v_mul_f32 v1, v1, v65
    v_mul_f32 v2, v2, v66
    v_mul_f32 v3, v3, v67
    v_mul_f32 v4, v4, v68
    v_mul_f32 v5, v5, v69
    v_mul_f32 v6, v6, v70
    v_mul_f32 v7, v7, v71
    v_mul_f32 v8, v8, v72
    v_mul_f32 v9, v9, v73
    v_mul_f32 v10, v10, v74
    v_mul_f32 v11, v11, v75
    v_mul_f32 v12, v12, v76
    v_mul_f32 v13, v13, v77
    v_mul_f32 v14, v14, v78
    v_mul_f32 v15, v15, v79
    s_or_b32 s7, s7, 1
L_side1:
    s_and_b32 s9, s22, 0xaa
    s_and_b32 s10, s7, 2
    s_lshl_b32 s10, s10, 8
    s_or_b32 s9, s9, s10
    s_cmp_lg_u32 s9, 0xaa
    s_cbranch_scc1 L_side2
    s_waitcnt lgkmcnt(0)
    v_lshlrev_b32 v16, 16, v128
    v_and_b32 v17, 0xffff0000, v128
    v_lshlrev_b32 v18, 16, v129
    v_and_b32 v19, 0xffff0000, v129
    v_lshlrev_b32 v20, 16, v130
    v_and_b32 v21, 0xffff0000, v130
    v_lshlrev_b32 v22, 16, v131
    v_and_b32 v23, 0xffff0000, v131
    v_lshlrev_b32 v24, 16, v132
    v_and_b32 v25, 0xffff0000, v132
    v_lshlrev_b32 v26, 16, v133
    v_and_b32 v27, 0xffff0000, v133
    v_lshlrev_b32 v28, 16, v134
    v_and_b32 v29, 0xffff0000, v134
    v_lshlrev_b32 v30, 16, v135
    v_and_b32 v31, 0xffff0000, v135
    v_dot2c_f32_bf16 v16, v136, v198
    v_dot2c_f32_bf16 v17, v136, v199
    v_dot2c_f32_bf16 v18, v137, v198
    v_dot2c_f32_bf16 v19, v137, v199
    v_dot2c_f32_bf16 v20, v138, v198
    v_dot2c_f32_bf16 v21, v138, v199
    v_dot2c_f32_bf16 v22, v139, v198
    v_dot2c_f32_bf16 v23, v139, v199
    v_dot2c_f32_bf16 v24, v140, v198
    v_dot2c_f32_bf16 v25, v140, v199
    v_dot2c_f32_bf16 v26, v141, v198
    v_dot2c_f32_bf16 v27, v141, v199
    v_dot2c_f32_bf16 v28, v142, v198
    v_dot2c_f32_bf16 v29, v142, v199
    v_dot2c_f32_bf16 v30, v143, v198
    v_dot2c_f32_bf16 v31, v143, v199
    v_dot2c_f32_bf16 v16, v152, v198
    v_dot2c_f32_bf16 v17, v152, v199
    v_dot2c_f32_bf16 v18, v153, v198
    v_dot2c_f32_bf16 v19, v153, v199
    v_dot2c_f32_bf16 v20, v154, v198
    v_dot2c_f32_bf16 v21, v154, v199
    v_dot2c_f32_bf16 v22, v155, v198
    v_dot2c_f32_bf16 v23, v155, v199
    v_dot2c_f32_bf16 v24, v156, v198
    v_dot2c_f32_bf16 v25, v156, v199
    v_dot2c_f32_bf16 v26, v157, v198
    v_dot2c_f32_bf16 v27, v157, v199
    v_dot2c_f32_bf16 v28, v158, v198
    v_dot2c_f32_bf16 v29, v158, v199
    v_dot2c_f32_bf16 v30, v159, v198
    v_dot2c_f32_bf16 v31, v159, v199
    v_dot2c_f32_bf16 v16, v168, v198
    v_dot2c_f32_bf16 v17, v168, v199
    v_dot2c_f32_bf16 v18, v169, v198
    v_dot2c_f32_bf16 v19, v169, v199
    v_dot2c_f32_bf16 v20, v170, v198
    v_dot2c_f32_bf16 v21, v170, v199
    v_dot2c_f32_bf16 v22, v171, v198
    v_dot2c_f32_bf16 v23, v171, v199
    v_dot2c_f32_bf16 v24, v172, v198
    v_dot2c_f32_bf16 v25, v172, v199
    v_dot2c_f32_bf16 v26, v173, v198
    v_dot2c_f32_bf16 v27, v173, v199
    v_dot2c_f32_bf16 v28, v174, v198
    v_dot2c_f32_bf16 v29, v174, v199
    v_dot2c_f32_bf16 v30, v175, v198
    v_dot2c_f32_bf16 v31, v175, v199
    v_dot2c_f32_bf16 v16, v184, v198
    v_dot2c_f32_bf16 v17, v184, v199
    v_dot2c_f32_bf16 v18, v185, v198
    v_dot2c_f32_bf16 v19, v185, v199
    v_dot2c_f32_bf16 v20, v186, v198
    v_dot2c_f32_bf16 v21, v186, v199
    v_dot2c_f32_bf16 v22, v187, v198
    v_dot2c_f32_bf16 v23, v187, v199
    v_dot2c_f32_bf16 v24, v188, v198
    v_dot2c_f32_bf16 v25, v188, v199
    v_dot2c_f32_bf16 v26, v189, v198
    v_dot2c_f32_bf16 v27, v189, v199
    v_dot2c_f32_bf16 v28, v190, v198
    v_dot2c_f32_bf16 v29, v190, v199
    v_dot2c_f32_bf16 v30, v191, v198
    v_dot2c_f32_bf16 v31, v191, v199
    s_or_b32 s7, s7, 2
L_side2:
    s_setpc_b64 s[34:35]
L_own:
    v_cvt_pk_bf16_f32 v64, v64, v65
    v_cvt_pk_bf16_f32 v65, v66, v67
    v_cvt_pk_bf16_f32 v66, v68, v69
    v_cvt_pk_bf16_f32 v67, v70, v71
    ds_write_b128 v192, v[64:67] offset:0
    v_cvt_pk_bf16_f32 v72, v72, v73
    v_cvt_pk_bf16_f32 v73, v74, v75
    v_cvt_pk_bf16_f32 v74, v76, v77
    v_cvt_pk_bf16_f32 v75, v78, v79
    ds_write_b128 v192, v[72:75] offset:2048
    v_cvt_pk_bf16_f32 v80, v80, v81
    v_cvt_pk_bf16_f32 v81, v82, v83
    v_cvt_pk_bf16_f32 v82, v84, v85
    v_cvt_pk_bf16_f32 v83, v86, v87
    ds_write_b128 v192, v[80:83] offset:4096
    v_cvt_pk_bf16_f32 v88, v88, v89
    v_cvt_pk_bf16_f32 v89, v90, v91
    v_cvt_pk_bf16_f32 v90, v92, v93
    v_cvt_pk_bf16_f32 v91, v94, v95
    ds_write_b128 v192, v[88:91] offset:6144
    v_cvt_pk_bf16_f32 v96, v96, v97
    v_cvt_pk_bf16_f32 v97, v98, v99
    v_cvt_pk_bf16_f32 v98, v100, v101
    v_cvt_pk_bf16_f32 v99, v102, v103
    ds_write_b128 v192, v[96:99] offset:1024
    v_cvt_pk_bf16_f32 v104, v104, v105
    v_cvt_pk_bf16_f32 v105, v106, v107
    v_cvt_pk_bf16_f32 v106, v108, v109
    v_cvt_pk_bf16_f32 v107, v110, v111
    ds_write_b128 v192, v[104:107] offset:3072
    v_cvt_pk_bf16_f32 v112, v112, v113
    v_cvt_pk_bf16_f32 v113, v114, v115
    v_cvt_pk_bf16_f32 v114, v116, v117
    v_cvt_pk_bf16_f32 v115, v118, v119
    ds_write_b128 v192, v[112:115] offset:5120
    v_cvt_pk_bf16_f32 v120, v120, v121
    v_cvt_pk_bf16_f32 v121, v122, v123
    v_cvt_pk_bf16_f32 v122, v124, v125
    v_cvt_pk_bf16_f32 v123, v126, v127
    ds_write_b128 v192, v[120:123] offset:7168
    s_waitcnt vmcnt(0) lgkmcnt(0)
    s_branch L_ownback
L_codeend:
L_mktag:
    s_memrealtime s[36:37]
    s_waitcnt lgkmcnt(0)
    s_or_b32 s9, s36, 1
    v_mov_b32 v120, s9
    v_mov_b32 v121, s37
    v_mov_b32 v122, 0
    global_store_dwordx2 v122, v[120:121], s[38:39] sc1
    s_branch L_notag
L_tagwait:
    s_sleep 1
    global_load_dwordx2 v[216:217], v240, s[38:39] sc1
    s_add_u32 s40, s40, 1
    s_cmp_gt_u32 s40, 0x100000
    s_cbranch_scc1 L_tagok
    s_waitcnt vmcnt(0)
    v_cmp_eq_u32 vcc, 0, v216
    s_cbranch_vccnz L_tagwait
    s_branch L_tagok
L_hwait:
    s_sleep 1
    buffer_load_dwordx2 v[242:243], v241, s[72:75], s94 offen sc1
    s_add_u32 s40, s40, 1
    s_cmp_gt_u32 s40, 0x100000
    s_cbranch_scc1 L_hok
    s_waitcnt vmcnt(0)
    v_cmp_ne_u64 vcc, v[242:243], v[216:217]
    s_cbranch_vccnz L_hwait
    s_branch L_hok
L_rarep00:
    s_call_b64 s[34:35], L_resc1
    s_branch L_backp00
L_rarep01:
    s_call_b64 s[34:35], L_resc0
    s_branch L_backp01
L_rarel0:
    s_call_b64 s[34:35], L_resc1
    s_branch L_backl0
L_rarel1:
    s_call_b64 s[34:35], L_resc0
    s_branch L_backl1
L_raret:
    s_call_b64 s[34:35], L_resc1
    s_branch L_backt
L_resc0:
    s_nop 7
    s_nop 3
    v_max3_f32 v200, v128, v129, v130
    v_max3_f32 v200, v200, v131, v132
    v_max3_f32 v200, v200, v133, v134
    v_max_f32 v200, v200, v135
    v_max3_f32 v201, v136, v137, v138
    v_max3_f32 v201, v201, v139, v140
    v_max3_f32 v201, v201, v141, v142
    v_max_f32 v201, v201, v143
    v_max3_f32 v202, v144, v145, v146
    v_max3_f32 v202, v202, v147, v148
    v_max3_f32 v202, v202, v149, v150
    v_max_f32 v202, v202, v151
    v_max3_f32 v203, v152, v153, v154
    v_max3_f32 v203, v203, v155, v156
    v_max3_f32 v203, v203, v157, v158
    v_max_f32 v203, v203, v159
    v_mov_b32 v226, v200
    v_mov_b32 v227, v201
    v_mov_b32 v228, v202
    v_mov_b32 v229, v203
    v_permlane16_swap_b32 v226, v200
    v_permlane16_swap_b32 v227, v201
    v_permlane16_swap_b32 v228, v202
    v_permlane16_swap_b32 v229, v203
    v_max_f32 v200, v200, v226
    v_max_f32 v201, v201, v227
    v_max_f32 v202, v202, v228
    v_max_f32 v203, v203, v229
    v_mov_b32 v226, v200
    v_mov_b32 v227, v201
    v_mov_b32 v228, v202
    v_mov_b32 v229, v203
    v_permlane32_swap_b32 v226, v200
    v_permlane32_swap_b32 v227, v201
    v_permlane32_swap_b32 v228, v202
    v_permlane32_swap_b32 v229, v203
    v_max_f32 v200, v200, v226
    v_max_f32 v201, v201, v227
    v_max_f32 v202, v202, v228
    v_max_f32 v203, v203, v229
    v_add_f32 v200, 0x41800000, v200
    v_add_f32 v201, 0x41800000, v201
    v_add_f32 v202, 0x41800000, v202
    v_add_f32 v203, 0x41800000, v203
    v_max_f32 v200, 0, v200
    v_max_f32 v201, 0, v201
    v_max_f32 v202, 0, v202
    v_max_f32 v203, 0, v203
    v_ceil_f32 v200, v200
    v_ceil_f32 v201, v201
    v_ceil_f32 v202, v202
    v_ceil_f32 v203, v203
    v_exp_f32 v226, -v200
    v_exp_f32 v227, -v201
    v_exp_f32 v228, -v202
    v_exp_f32 v229, -v203
    v_sub_f32 v128, v128, v200
    v_sub_f32 v64, v64, v200
    v_sub_f32 v129, v129, v200
    v_sub_f32 v65, v65, v200
    v_sub_f32 v130, v130, v200
    v_sub_f32 v66, v66, v200
    v_sub_f32 v131, v131, v200
    v_sub_f32 v67, v67, v200
    v_sub_f32 v132, v132, v200
    v_sub_f32 v68, v68, v200
    v_sub_f32 v133, v133, v200
    v_sub_f32 v69, v69, v200
    v_sub_f32 v134, v134, v200
    v_sub_f32 v70, v70, v200
    v_sub_f32 v135, v135, v200
    v_sub_f32 v71, v71, v200
    v_sub_f32 v160, v160, v200
    v_mul_f32 v184, v184, v226
    v_sub_f32 v161, v161, v200
    v_mul_f32 v185, v185, v226
    v_sub_f32 v162, v162, v200
    v_mul_f32 v186, v186, v226
    v_sub_f32 v163, v163, v200
    v_mul_f32 v187, v187, v226
    v_sub_f32 v136, v136, v201
    v_sub_f32 v72, v72, v201
    v_sub_f32 v137, v137, v201
    v_sub_f32 v73, v73, v201
    v_sub_f32 v138, v138, v201
    v_sub_f32 v74, v74, v201
    v_sub_f32 v139, v139, v201
    v_sub_f32 v75, v75, v201
    v_sub_f32 v140, v140, v201
    v_sub_f32 v76, v76, v201
    v_sub_f32 v141, v141, v201
    v_sub_f32 v77, v77, v201
    v_sub_f32 v142, v142, v201
    v_sub_f32 v78, v78, v201
    v_sub_f32 v143, v143, v201
    v_sub_f32 v79, v79, v201
    v_sub_f32 v164, v164, v201
    v_mul_f32 v188, v188, v227
    v_sub_f32 v165, v165, v201
    v_mul_f32 v189, v189, v227
    v_sub_f32 v166, v166, v201
    v_mul_f32 v190, v190, v227
    v_sub_f32 v167, v167, v201
    v_mul_f32 v191, v191, v227
    v_sub_f32 v144, v144, v202
    v_sub_f32 v80, v80, v202
    v_sub_f32 v145, v145, v202
    v_sub_f32 v81, v81, v202
    v_sub_f32 v146, v146, v202
    v_sub_f32 v82, v82, v202
    v_sub_f32 v147, v147, v202
    v_sub_f32 v83, v83, v202
    v_sub_f32 v148, v148, v202
    v_sub_f32 v84, v84, v202
    v_sub_f32 v149, v149, v202
    v_sub_f32 v85, v85, v202
    v_sub_f32 v150, v150, v202
    v_sub_f32 v86, v86, v202
    v_sub_f32 v151, v151, v202
    v_sub_f32 v87, v87, v202
    v_sub_f32 v168, v168, v202
    v_mul_f32 v196, v196, v228
    v_sub_f32 v169, v169, v202
    v_mul_f32 v197, v197, v228
    v_sub_f32 v170, v170, v202
    v_mul_f32 v198, v198, v228
    v_sub_f32 v171, v171, v202
    v_mul_f32 v199, v199, v228
    v_sub_f32 v152, v152, v203
    v_sub_f32 v88, v88, v203
    v_sub_f32 v153, v153, v203
    v_sub_f32 v89, v89, v203
    v_sub_f32 v154, v154, v203
    v_sub_f32 v90, v90, v203
    v_sub_f32 v155, v155, v203
    v_sub_f32 v91, v91, v203
    v_sub_f32 v156, v156, v203
    v_sub_f32 v92, v92, v203
    v_sub_f32 v157, v157, v203
    v_sub_f32 v93, v93, v203
    v_sub_f32 v158, v158, v203
    v_sub_f32 v94, v94, v203
    v_sub_f32 v159, v159, v203
    v_sub_f32 v95, v95, v203
    v_sub_f32 v172, v172, v203
    v_mul_f32 v218, v218, v229
    v_sub_f32 v173, v173, v203
    v_mul_f32 v219, v219, v229
    v_sub_f32 v174, v174, v203
    v_mul_f32 v220, v220, v229
    v_sub_f32 v175, v175, v203
    v_mul_f32 v221, v221, v229
    v_accvgpr_read_b32 v200, a0
    v_accvgpr_read_b32 v201, a1
    v_accvgpr_read_b32 v202, a2
    v_accvgpr_read_b32 v203, a3
    v_mul_f32 v200, v200, v226
    v_mul_f32 v201, v201, v226
    v_mul_f32 v202, v202, v226
    v_mul_f32 v203, v203, v226
    v_accvgpr_write_b32 a0, v200
    v_accvgpr_write_b32 a1, v201
    v_accvgpr_write_b32 a2, v202
    v_accvgpr_write_b32 a3, v203
    v_accvgpr_read_b32 v200, a8
    v_accvgpr_read_b32 v201, a9
    v_accvgpr_read_b32 v202, a10
    v_accvgpr_read_b32 v203, a11
    v_mul_f32 v200, v200, v227
    v_mul_f32 v201, v201, v227
    v_mul_f32 v202, v202, v227
    v_mul_f32 v203, v203, v227
    v_accvgpr_write_b32 a8, v200
    v_accvgpr_write_b32 a9, v201
    v_accvgpr_write_b32 a10, v202
    v_accvgpr_write_b32 a11, v203
    v_accvgpr_read_b32 v200, a16
    v_accvgpr_read_b32 v201, a17
    v_accvgpr_read_b32 v202, a18
    v_accvgpr_read_b32 v203, a19
    v_mul_f32 v200, v200, v228
    v_mul_f32 v201, v201, v228
    v_mul_f32 v202, v202, v228
    v_mul_f32 v203, v203, v228
    v_accvgpr_write_b32 a16, v200
    v_accvgpr_write_b32 a17, v201
    v_accvgpr_write_b32 a18, v202
    v_accvgpr_write_b32 a19, v203
    v_accvgpr_read_b32 v200, a24
    v_accvgpr_read_b32 v201, a25
    v_accvgpr_read_b32 v202, a26
    v_accvgpr_read_b32 v203, a27
    v_mul_f32 v200, v200, v229
    v_mul_f32 v201, v201, v229
    v_mul_f32 v202, v202, v229
    v_mul_f32 v203, v203, v229
    v_accvgpr_write_b32 a24, v200
    v_accvgpr_write_b32 a25, v201
    v_accvgpr_write_b32 a26, v202
    v_accvgpr_write_b32 a27, v203
    v_accvgpr_read_b32 v200, a4
    v_accvgpr_read_b32 v201, a5
    v_accvgpr_read_b32 v202, a6
    v_accvgpr_read_b32 v203, a7
    v_mul_f32 v200, v200, v226
    v_mul_f32 v201, v201, v226
    v_mul_f32 v202, v202, v226
    v_mul_f32 v203, v203, v226
    v_accvgpr_write_b32 a4, v200
    v_accvgpr_write_b32 a5, v201
    v_accvgpr_write_b32 a6, v202
    v_accvgpr_write_b32 a7, v203
    v_accvgpr_read_b32 v200, a12
    v_accvgpr_read_b32 v201, a13
    v_accvgpr_read_b32 v202, a14
    v_accvgpr_read_b32 v203, a15
    v_mul_f32 v200, v200, v227
    v_mul_f32 v201, v201, v227
    v_mul_f32 v202, v202, v227
    v_mul_f32 v203, v203, v227
    v_accvgpr_write_b32 a12, v200
    v_accvgpr_write_b32 a13, v201
    v_accvgpr_write_b32 a14, v202
    v_accvgpr_write_b32 a15, v203
    v_accvgpr_read_b32 v200, a20
    v_accvgpr_read_b32 v201, a21
    v_accvgpr_read_b32 v202, a22
    v_accvgpr_read_b32 v203, a23
    v_mul_f32 v200, v200, v228
    v_mul_f32 v201, v201, v228
    v_mul_f32 v202, v202, v228
    v_mul_f32 v203, v203, v228
    v_accvgpr_write_b32 a20, v200
    v_accvgpr_write_b32 a21, v201
    v_accvgpr_write_b32 a22, v202
    v_accvgpr_write_b32 a23, v203
    v_accvgpr_read_b32 v200, a28
    v_accvgpr_read_b32 v201, a29
    v_accvgpr_read_b32 v202, a30
    v_accvgpr_read_b32 v203, a31
    v_mul_f32 v200, v200, v229
    v_mul_f32 v201, v201, v229
    v_mul_f32 v202, v202, v229
    v_mul_f32 v203, v203, v229
    v_accvgpr_write_b32 a28, v200
    v_accvgpr_write_b32 a29, v201
    v_accvgpr_write_b32 a30, v202
    v_accvgpr_write_b32 a31, v203
    v_accvgpr_read_b32 v200, a32
    v_accvgpr_read_b32 v201, a33
    v_accvgpr_read_b32 v202, a34
    v_accvgpr_read_b32 v203, a35
    v_mul_f32 v200, v200, v226
    v_mul_f32 v201, v201, v226
    v_mul_f32 v202, v202, v226
    v_mul_f32 v203, v203, v226
    v_accvgpr_write_b32 a32, v200
    v_accvgpr_write_b32 a33, v201
    v_accvgpr_write_b32 a34, v202
    v_accvgpr_write_b32 a35, v203
    v_accvgpr_read_b32 v200, a40
    v_accvgpr_read_b32 v201, a41
    v_accvgpr_read_b32 v202, a42
    v_accvgpr_read_b32 v203, a43
    v_mul_f32 v200, v200, v227
    v_mul_f32 v201, v201, v227
    v_mul_f32 v202, v202, v227
    v_mul_f32 v203, v203, v227
    v_accvgpr_write_b32 a40, v200
    v_accvgpr_write_b32 a41, v201
    v_accvgpr_write_b32 a42, v202
    v_accvgpr_write_b32 a43, v203
    v_accvgpr_read_b32 v200, a48
    v_accvgpr_read_b32 v201, a49
    v_accvgpr_read_b32 v202, a50
    v_accvgpr_read_b32 v203, a51
    v_mul_f32 v200, v200, v228
    v_mul_f32 v201, v201, v228
    v_mul_f32 v202, v202, v228
    v_mul_f32 v203, v203, v228
    v_accvgpr_write_b32 a48, v200
    v_accvgpr_write_b32 a49, v201
    v_accvgpr_write_b32 a50, v202
    v_accvgpr_write_b32 a51, v203
    v_accvgpr_read_b32 v200, a56
    v_accvgpr_read_b32 v201, a57
    v_accvgpr_read_b32 v202, a58
    v_accvgpr_read_b32 v203, a59
    v_mul_f32 v200, v200, v229
    v_mul_f32 v201, v201, v229
    v_mul_f32 v202, v202, v229
    v_mul_f32 v203, v203, v229
    v_accvgpr_write_b32 a56, v200
    v_accvgpr_write_b32 a57, v201
    v_accvgpr_write_b32 a58, v202
    v_accvgpr_write_b32 a59, v203
    v_accvgpr_read_b32 v200, a36
    v_accvgpr_read_b32 v201, a37
    v_accvgpr_read_b32 v202, a38
    v_accvgpr_read_b32 v203, a39
    v_mul_f32 v200, v200, v226
    v_mul_f32 v201, v201, v226
    v_mul_f32 v202, v202, v226
    v_mul_f32 v203, v203, v226
    v_accvgpr_write_b32 a36, v200
    v_accvgpr_write_b32 a37, v201
    v_accvgpr_write_b32 a38, v202
    v_accvgpr_write_b32 a39, v203
    v_accvgpr_read_b32 v200, a44
    v_accvgpr_read_b32 v201, a45
    v_accvgpr_read_b32 v202, a46
    v_accvgpr_read_b32 v203, a47
    v_mul_f32 v200, v200, v227
    v_mul_f32 v201, v201, v227
    v_mul_f32 v202, v202, v227
    v_mul_f32 v203, v203, v227
    v_accvgpr_write_b32 a44, v200
    v_accvgpr_write_b32 a45, v201
    v_accvgpr_write_b32 a46, v202
    v_accvgpr_write_b32 a47, v203
    v_accvgpr_read_b32 v200, a52
    v_accvgpr_read_b32 v201, a53
    v_accvgpr_read_b32 v202, a54
    v_accvgpr_read_b32 v203, a55
    v_mul_f32 v200, v200, v228
    v_mul_f32 v201, v201, v228
    v_mul_f32 v202, v202, v228
    v_mul_f32 v203, v203, v228
    v_accvgpr_write_b32 a52, v200
    v_accvgpr_write_b32 a53, v201
    v_accvgpr_write_b32 a54, v202
    v_accvgpr_write_b32 a55, v203
    v_accvgpr_read_b32 v200, a60
    v_accvgpr_read_b32 v201, a61
    v_accvgpr_read_b32 v202, a62
    v_accvgpr_read_b32 v203, a63
    v_mul_f32 v200, v200, v229
    v_mul_f32 v201, v201, v229
    v_mul_f32 v202, v202, v229
    v_mul_f32 v203, v203, v229
    v_accvgpr_write_b32 a60, v200
    v_accvgpr_write_b32 a61, v201
    v_accvgpr_write_b32 a62, v202
    v_accvgpr_write_b32 a63, v203
    v_accvgpr_read_b32 v200, a64
    v_accvgpr_read_b32 v201, a65
    v_accvgpr_read_b32 v202, a66
    v_accvgpr_read_b32 v203, a67
    v_mul_f32 v200, v200, v226
    v_mul_f32 v201, v201, v226
    v_mul_f32 v202, v202, v226
    v_mul_f32 v203, v203, v226
    v_accvgpr_write_b32 a64, v200
    v_accvgpr_write_b32 a65, v201
    v_accvgpr_write_b32 a66, v202
    v_accvgpr_write_b32 a67, v203
    v_accvgpr_read_b32 v200, a72
    v_accvgpr_read_b32 v201, a73
    v_accvgpr_read_b32 v202, a74
    v_accvgpr_read_b32 v203, a75
    v_mul_f32 v200, v200, v227
    v_mul_f32 v201, v201, v227
    v_mul_f32 v202, v202, v227
    v_mul_f32 v203, v203, v227
    v_accvgpr_write_b32 a72, v200
    v_accvgpr_write_b32 a73, v201
    v_accvgpr_write_b32 a74, v202
    v_accvgpr_write_b32 a75, v203
    v_accvgpr_read_b32 v200, a80
    v_accvgpr_read_b32 v201, a81
    v_accvgpr_read_b32 v202, a82
    v_accvgpr_read_b32 v203, a83
    v_mul_f32 v200, v200, v228
    v_mul_f32 v201, v201, v228
    v_mul_f32 v202, v202, v228
    v_mul_f32 v203, v203, v228
    v_accvgpr_write_b32 a80, v200
    v_accvgpr_write_b32 a81, v201
    v_accvgpr_write_b32 a82, v202
    v_accvgpr_write_b32 a83, v203
    v_accvgpr_read_b32 v200, a88
    v_accvgpr_read_b32 v201, a89
    v_accvgpr_read_b32 v202, a90
    v_accvgpr_read_b32 v203, a91
    v_mul_f32 v200, v200, v229
    v_mul_f32 v201, v201, v229
    v_mul_f32 v202, v202, v229
    v_mul_f32 v203, v203, v229
    v_accvgpr_write_b32 a88, v200
    v_accvgpr_write_b32 a89, v201
    v_accvgpr_write_b32 a90, v202
    v_accvgpr_write_b32 a91, v203
    v_accvgpr_read_b32 v200, a68
    v_accvgpr_read_b32 v201, a69
    v_accvgpr_read_b32 v202, a70
    v_accvgpr_read_b32 v203, a71
    v_mul_f32 v200, v200, v226
    v_mul_f32 v201, v201, v226
    v_mul_f32 v202, v202, v226
    v_mul_f32 v203, v203, v226
    v_accvgpr_write_b32 a68, v200
    v_accvgpr_write_b32 a69, v201
    v_accvgpr_write_b32 a70, v202
    v_accvgpr_write_b32 a71, v203
    v_accvgpr_read_b32 v200, a76
    v_accvgpr_read_b32 v201, a77
    v_accvgpr_read_b32 v202, a78
    v_accvgpr_read_b32 v203, a79
    v_mul_f32 v200, v200, v227
    v_mul_f32 v201, v201, v227
    v_mul_f32 v202, v202, v227
    v_mul_f32 v203, v203, v227
    v_accvgpr_write_b32 a76, v200
    v_accvgpr_write_b32 a77, v201
    v_accvgpr_write_b32 a78, v202
    v_accvgpr_write_b32 a79, v203
    v_accvgpr_read_b32 v200, a84
    v_accvgpr_read_b32 v201, a85
    v_accvgpr_read_b32 v202, a86
    v_accvgpr_read_b32 v203, a87
    v_mul_f32 v200, v200, v228
    v_mul_f32 v201, v201, v228
    v_mul_f32 v202, v202, v228
    v_mul_f32 v203, v203, v228
    v_accvgpr_write_b32 a84, v200
    v_accvgpr_write_b32 a85, v201
    v_accvgpr_write_b32 a86, v202
    v_accvgpr_write_b32 a87, v203
    v_accvgpr_read_b32 v200, a92
    v_accvgpr_read_b32 v201, a93
    v_accvgpr_read_b32 v202, a94
    v_accvgpr_read_b32 v203, a95
    v_mul_f32 v200, v200, v229
    v_mul_f32 v201, v201, v229
    v_mul_f32 v202, v202, v229
    v_mul_f32 v203, v203, v229
    v_accvgpr_write_b32 a92, v200
    v_accvgpr_write_b32 a93, v201
    v_accvgpr_write_b32 a94, v202
    v_accvgpr_write_b32 a95, v203
    v_accvgpr_read_b32 v200, a96
    v_accvgpr_read_b32 v201, a97
    v_accvgpr_read_b32 v202, a98
    v_accvgpr_read_b32 v203, a99
    v_mul_f32 v200, v200, v226
    v_mul_f32 v201, v201, v226
    v_mul_f32 v202, v202, v226
    v_mul_f32 v203, v203, v226
    v_accvgpr_write_b32 a96, v200
    v_accvgpr_write_b32 a97, v201
    v_accvgpr_write_b32 a98, v202
    v_accvgpr_write_b32 a99, v203
    v_accvgpr_read_b32 v200, a104
    v_accvgpr_read_b32 v201, a105
    v_accvgpr_read_b32 v202, a106
    v_accvgpr_read_b32 v203, a107
    v_mul_f32 v200, v200, v227
    v_mul_f32 v201, v201, v227
    v_mul_f32 v202, v202, v227
    v_mul_f32 v203, v203, v227
    v_accvgpr_write_b32 a104, v200
    v_accvgpr_write_b32 a105, v201
    v_accvgpr_write_b32 a106, v202
    v_accvgpr_write_b32 a107, v203
    v_accvgpr_read_b32 v200, a112
    v_accvgpr_read_b32 v201, a113
    v_accvgpr_read_b32 v202, a114
    v_accvgpr_read_b32 v203, a115
    v_mul_f32 v200, v200, v228
    v_mul_f32 v201, v201, v228
    v_mul_f32 v202, v202, v228
    v_mul_f32 v203, v203, v228
    v_accvgpr_write_b32 a112, v200
    v_accvgpr_write_b32 a113, v201
    v_accvgpr_write_b32 a114, v202
    v_accvgpr_write_b32 a115, v203
    v_accvgpr_read_b32 v200, a120
    v_accvgpr_read_b32 v201, a121
    v_accvgpr_read_b32 v202, a122
    v_accvgpr_read_b32 v203, a123
    v_mul_f32 v200, v200, v229
    v_mul_f32 v201, v201, v229
    v_mul_f32 v202, v202, v229
    v_mul_f32 v203, v203, v229
    v_accvgpr_write_b32 a120, v200
    v_accvgpr_write_b32 a121, v201
    v_accvgpr_write_b32 a122, v202
    v_accvgpr_write_b32 a123, v203
    v_accvgpr_read_b32 v200, a100
    v_accvgpr_read_b32 v201, a101
    v_accvgpr_read_b32 v202, a102
    v_accvgpr_read_b32 v203, a103
    v_mul_f32 v200, v200, v226
    v_mul_f32 v201, v201, v226
    v_mul_f32 v202, v202, v226
    v_mul_f32 v203, v203, v226
    v_accvgpr_write_b32 a100, v200
    v_accvgpr_write_b32 a101, v201
    v_accvgpr_write_b32 a102, v202
    v_accvgpr_write_b32 a103, v203
    v_accvgpr_read_b32 v200, a108
    v_accvgpr_read_b32 v201, a109
    v_accvgpr_read_b32 v202, a110
    v_accvgpr_read_b32 v203, a111
    v_mul_f32 v200, v200, v227
    v_mul_f32 v201, v201, v227
    v_mul_f32 v202, v202, v227
    v_mul_f32 v203, v203, v227
    v_accvgpr_write_b32 a108, v200
    v_accvgpr_write_b32 a109, v201
    v_accvgpr_write_b32 a110, v202
    v_accvgpr_write_b32 a111, v203
    v_accvgpr_read_b32 v200, a116
    v_accvgpr_read_b32 v201, a117
    v_accvgpr_read_b32 v202, a118
    v_accvgpr_read_b32 v203, a119
    v_mul_f32 v200, v200, v228
    v_mul_f32 v201, v201, v228
    v_mul_f32 v202, v202, v228
    v_mul_f32 v203, v203, v228
    v_accvgpr_write_b32 a116, v200
    v_accvgpr_write_b32 a117, v201
    v_accvgpr_write_b32 a118, v202
    v_accvgpr_write_b32 a119, v203
    v_accvgpr_read_b32 v200, a124
    v_accvgpr_read_b32 v201, a125
    v_accvgpr_read_b32 v202, a126
    v_accvgpr_read_b32 v203, a127
    v_mul_f32 v200, v200, v229
    v_mul_f32 v201, v201, v229
    v_mul_f32 v202, v202, v229
    v_mul_f32 v203, v203, v229
    v_accvgpr_write_b32 a124, v200
    v_accvgpr_write_b32 a125, v201
    v_accvgpr_write_b32 a126, v202
    v_accvgpr_write_b32 a127, v203
    v_lshlrev_b32 v224, 16, v112
    v_and_b32 v225, 0xffff0000, v112
    v_mul_f32 v224, v224, v226
    v_mul_f32 v225, v225, v226
    v_cvt_pk_bf16_f32 v112, v224, v225
    v_lshlrev_b32 v224, 16, v113
    v_and_b32 v225, 0xffff0000, v113
    v_mul_f32 v224, v224, v226
    v_mul_f32 v225, v225, v226
    v_cvt_pk_bf16_f32 v113, v224, v225
    v_lshlrev_b32 v224, 16, v114
    v_and_b32 v225, 0xffff0000, v114
    v_mul_f32 v224, v224, v226
    v_mul_f32 v225, v225, v226
    v_cvt_pk_bf16_f32 v114, v224, v225
    v_lshlrev_b32 v224, 16, v115
    v_and_b32 v225, 0xffff0000, v115
    v_mul_f32 v224, v224, v226
    v_mul_f32 v225, v225, v226
    v_cvt_pk_bf16_f32 v115, v224, v225
    v_lshlrev_b32 v224, 16, v116
    v_and_b32 v225, 0xffff0000, v116
    v_mul_f32 v224, v224, v227
    v_mul_f32 v225, v225, v227
    v_cvt_pk_bf16_f32 v116, v224, v225
    v_lshlrev_b32 v224, 16, v117
    v_and_b32 v225, 0xffff0000, v117
    v_mul_f32 v224, v224, v227
    v_mul_f32 v225, v225, v227
    v_cvt_pk_bf16_f32 v117, v224, v225
    v_lshlrev_b32 v224, 16, v118
    v_and_b32 v225, 0xffff0000, v118
    v_mul_f32 v224, v224, v227
    v_mul_f32 v225, v225, v227
    v_cvt_pk_bf16_f32 v118, v224, v225
    v_lshlrev_b32 v224, 16, v119
    v_and_b32 v225, 0xffff0000, v119
    v_mul_f32 v224, v224, v227
    v_mul_f32 v225, v225, v227
    v_cvt_pk_bf16_f32 v119, v224, v225
    v_lshlrev_b32 v224, 16, v120
    v_and_b32 v225, 0xffff0000, v120
    v_mul_f32 v224, v224, v228
    v_mul_f32 v225, v225, v228
    v_cvt_pk_bf16_f32 v120, v224, v225
    v_lshlrev_b32 v224, 16, v121
    v_and_b32 v225, 0xffff0000, v121
    v_mul_f32 v224, v224, v228
    v_mul_f32 v225, v225, v228
    v_cvt_pk_bf16_f32 v121, v224, v225
    v_lshlrev_b32 v224, 16, v122
    v_and_b32 v225, 0xffff0000, v122
    v_mul_f32 v224, v224, v228
    v_mul_f32 v225, v225, v228
    v_cvt_pk_bf16_f32 v122, v224, v225
    v_lshlrev_b32 v224, 16, v123
    v_and_b32 v225, 0xffff0000, v123
    v_mul_f32 v224, v224, v228
    v_mul_f32 v225, v225, v228
    v_cvt_pk_bf16_f32 v123, v224, v225
    v_lshlrev_b32 v224, 16, v124
    v_and_b32 v225, 0xffff0000, v124
    v_mul_f32 v224, v224, v229
    v_mul_f32 v225, v225, v229
    v_cvt_pk_bf16_f32 v124, v224, v225
    v_lshlrev_b32 v224, 16, v125
    v_and_b32 v225, 0xffff0000, v125
    v_mul_f32 v224, v224, v229
    v_mul_f32 v225, v225, v229
    v_cvt_pk_bf16_f32 v125, v224, v225
    v_lshlrev_b32 v224, 16, v126
    v_and_b32 v225, 0xffff0000, v126
    v_mul_f32 v224, v224, v229
    v_mul_f32 v225, v225, v229
    v_cvt_pk_bf16_f32 v126, v224, v225
    v_lshlrev_b32 v224, 16, v127
    v_and_b32 v225, 0xffff0000, v127
    v_mul_f32 v224, v224, v229
    v_mul_f32 v225, v225, v229
    v_cvt_pk_bf16_f32 v127, v224, v225
    v_mov_b32 v200, 0x3f803f80
    v_mov_b32 v201, 0x3f803f80
    v_mov_b32 v202, 0x3f803f80
    v_mov_b32 v203, 0x3f803f80
    v_exp_f32 v224, v128
    v_exp_f32 v225, v129
    v_exp_f32 v226, v130
    v_exp_f32 v227, v131
    v_cvt_pk_bf16_f32 v96, v224, v225
    v_exp_f32 v228, v132
    v_exp_f32 v229, v133
    v_cvt_pk_bf16_f32 v97, v226, v227
    v_exp_f32 v224, v134
    v_exp_f32 v225, v135
    v_cvt_pk_bf16_f32 v98, v228, v229
    v_exp_f32 v226, v136
    v_exp_f32 v227, v137
    v_cvt_pk_bf16_f32 v99, v224, v225
    v_exp_f32 v228, v138
    v_exp_f32 v229, v139
    v_cvt_pk_bf16_f32 v100, v226, v227
    v_exp_f32 v224, v140
    v_exp_f32 v225, v141
    v_cvt_pk_bf16_f32 v101, v228, v229
    v_exp_f32 v226, v142
    v_exp_f32 v227, v143
    v_cvt_pk_bf16_f32 v102, v224, v225
    v_exp_f32 v228, v144
    v_exp_f32 v229, v145
    v_cvt_pk_bf16_f32 v103, v226, v227
    v_exp_f32 v224, v146
    v_exp_f32 v225, v147
    v_cvt_pk_bf16_f32 v104, v228, v229
    v_exp_f32 v226, v148
    v_exp_f32 v227, v149
    v_cvt_pk_bf16_f32 v105, v224, v225
    v_exp_f32 v228, v150
    v_exp_f32 v229, v151
    v_cvt_pk_bf16_f32 v106, v226, v227
    v_exp_f32 v224, v152
    v_exp_f32 v225, v153
    v_cvt_pk_bf16_f32 v107, v228, v229
    v_exp_f32 v226, v154
    v_exp_f32 v227, v155
    v_cvt_pk_bf16_f32 v108, v224, v225
    v_exp_f32 v228, v156
    v_exp_f32 v229, v157
    v_cvt_pk_bf16_f32 v109, v226, v227
    v_exp_f32 v224, v158
    v_exp_f32 v225, v159
    v_cvt_pk_bf16_f32 v110, v228, v229
    s_nop 0
    v_cvt_pk_bf16_f32 v111, v224, v225
    s_nop 1
    s_setpc_b64 s[34:35]
L_resc1:
    s_nop 7
    s_nop 3
    v_max3_f32 v200, v64, v65, v66
    v_max3_f32 v200, v200, v67, v68
    v_max3_f32 v200, v200, v69, v70
    v_max_f32 v200, v200, v71
    v_max3_f32 v201, v72, v73, v74
    v_max3_f32 v201, v201, v75, v76
    v_max3_f32 v201, v201, v77, v78
    v_max_f32 v201, v201, v79
    v_max3_f32 v202, v80, v81, v82
    v_max3_f32 v202, v202, v83, v84
    v_max3_f32 v202, v202, v85, v86
    v_max_f32 v202, v202, v87
    v_max3_f32 v203, v88, v89, v90
    v_max3_f32 v203, v203, v91, v92
    v_max3_f32 v203, v203, v93, v94
    v_max_f32 v203, v203, v95
    v_mov_b32 v226, v200
    v_mov_b32 v227, v201
    v_mov_b32 v228, v202
    v_mov_b32 v229, v203
    v_permlane16_swap_b32 v226, v200
    v_permlane16_swap_b32 v227, v201
    v_permlane16_swap_b32 v228, v202
    v_permlane16_swap_b32 v229, v203
    v_max_f32 v200, v200, v226
    v_max_f32 v201, v201, v227
    v_max_f32 v202, v202, v228
    v_max_f32 v203, v203, v229
    v_mov_b32 v226, v200
    v_mov_b32 v227, v201
    v_mov_b32 v228, v202
    v_mov_b32 v229, v203
    v_permlane32_swap_b32 v226, v200
    v_permlane32_swap_b32 v227, v201
    v_permlane32_swap_b32 v228, v202
    v_permlane32_swap_b32 v229, v203
    v_max_f32 v200, v200, v226
    v_max_f32 v201, v201, v227
    v_max_f32 v202, v202, v228
    v_max_f32 v203, v203, v229
    v_add_f32 v200, 0x41800000, v200
    v_add_f32 v201, 0x41800000, v201
    v_add_f32 v202, 0x41800000, v202
    v_add_f32 v203, 0x41800000, v203
    v_max_f32 v200, 0, v200
    v_max_f32 v201, 0, v201
    v_max_f32 v202, 0, v202
    v_max_f32 v203, 0, v203
    v_ceil_f32 v200, v200
    v_ceil_f32 v201, v201
    v_ceil_f32 v202, v202
    v_ceil_f32 v203, v203
    v_exp_f32 v226, -v200
    v_exp_f32 v227, -v201
    v_exp_f32 v228, -v202
    v_exp_f32 v229, -v203
    v_sub_f32 v128, v128, v200
    v_sub_f32 v64, v64, v200
    v_sub_f32 v129, v129, v200
    v_sub_f32 v65, v65, v200
    v_sub_f32 v130, v130, v200
    v_sub_f32 v66, v66, v200
    v_sub_f32 v131, v131, v200
    v_sub_f32 v67, v67, v200
    v_sub_f32 v132, v132, v200
    v_sub_f32 v68, v68, v200
    v_sub_f32 v133, v133, v200
    v_sub_f32 v69, v69, v200
    v_sub_f32 v134, v134, v200
    v_sub_f32 v70, v70, v200
    v_sub_f32 v135, v135, v200
    v_sub_f32 v71, v71, v200
    v_sub_f32 v160, v160, v200
    v_mul_f32 v184, v184, v226
    v_sub_f32 v161, v161, v200
    v_mul_f32 v185, v185, v226
    v_sub_f32 v162, v162, v200
    v_mul_f32 v186, v186, v226
    v_sub_f32 v163, v163, v200
    v_mul_f32 v187, v187, v226
    v_sub_f32 v136, v136, v201
    v_sub_f32 v72, v72, v201
    v_sub_f32 v137, v137, v201
    v_sub_f32 v73, v73, v201
    v_sub_f32 v138, v138, v201
    v_sub_f32 v74, v74, v201
    v_sub_f32 v139, v139, v201
    v_sub_f32 v75, v75, v201
    v_sub_f32 v140, v140, v201
    v_sub_f32 v76, v76, v201
    v_sub_f32 v141, v141, v201
    v_sub_f32 v77, v77, v201
    v_sub_f32 v142, v142, v201
    v_sub_f32 v78, v78, v201
    v_sub_f32 v143, v143, v201
    v_sub_f32 v79, v79, v201
    v_sub_f32 v164, v164, v201
    v_mul_f32 v188, v188, v227
    v_sub_f32 v165, v165, v201
    v_mul_f32 v189, v189, v227
    v_sub_f32 v166, v166, v201
    v_mul_f32 v190, v190, v227
    v_sub_f32 v167, v167, v201
    v_mul_f32 v191, v191, v227
    v_sub_f32 v144, v144, v202
    v_sub_f32 v80, v80, v202
    v_sub_f32 v145, v145, v202
    v_sub_f32 v81, v81, v202
    v_sub_f32 v146, v146, v202
    v_sub_f32 v82, v82, v202
    v_sub_f32 v147, v147, v202
    v_sub_f32 v83, v83, v202
    v_sub_f32 v148, v148, v202
    v_sub_f32 v84, v84, v202
    v_sub_f32 v149, v149, v202
    v_sub_f32 v85, v85, v202
    v_sub_f32 v150, v150, v202
    v_sub_f32 v86, v86, v202
    v_sub_f32 v151, v151, v202
    v_sub_f32 v87, v87, v202
    v_sub_f32 v168, v168, v202
    v_mul_f32 v196, v196, v228
    v_sub_f32 v169, v169, v202
    v_mul_f32 v197, v197, v228
    v_sub_f32 v170, v170, v202
    v_mul_f32 v198, v198, v228
    v_sub_f32 v171, v171, v202
    v_mul_f32 v199, v199, v228
    v_sub_f32 v152, v152, v203
    v_sub_f32 v88, v88, v203
    v_sub_f32 v153, v153, v203
    v_sub_f32 v89, v89, v203
    v_sub_f32 v154, v154, v203
    v_sub_f32 v90, v90, v203
    v_sub_f32 v155, v155, v203
    v_sub_f32 v91, v91, v203
    v_sub_f32 v156, v156, v203
    v_sub_f32 v92, v92, v203
    v_sub_f32 v157, v157, v203
    v_sub_f32 v93, v93, v203
    v_sub_f32 v158, v158, v203
    v_sub_f32 v94, v94, v203
    v_sub_f32 v159, v159, v203
    v_sub_f32 v95, v95, v203
    v_sub_f32 v172, v172, v203
    v_mul_f32 v218, v218, v229
    v_sub_f32 v173, v173, v203
    v_mul_f32 v219, v219, v229
    v_sub_f32 v174, v174, v203
    v_mul_f32 v220, v220, v229
    v_sub_f32 v175, v175, v203
    v_mul_f32 v221, v221, v229
    v_accvgpr_read_b32 v200, a0
    v_accvgpr_read_b32 v201, a1
    v_accvgpr_read_b32 v202, a2
    v_accvgpr_read_b32 v203, a3
    v_mul_f32 v200, v200, v226
    v_mul_f32 v201, v201, v226
    v_mul_f32 v202, v202, v226
    v_mul_f32 v203, v203, v226
    v_accvgpr_write_b32 a0, v200
    v_accvgpr_write_b32 a1, v201
    v_accvgpr_write_b32 a2, v202
    v_accvgpr_write_b32 a3, v203
    v_accvgpr_read_b32 v200, a8
    v_accvgpr_read_b32 v201, a9
    v_accvgpr_read_b32 v202, a10
    v_accvgpr_read_b32 v203, a11
    v_mul_f32 v200, v200, v227
    v_mul_f32 v201, v201, v227
    v_mul_f32 v202, v202, v227
    v_mul_f32 v203, v203, v227
    v_accvgpr_write_b32 a8, v200
    v_accvgpr_write_b32 a9, v201
    v_accvgpr_write_b32 a10, v202
    v_accvgpr_write_b32 a11, v203
    v_accvgpr_read_b32 v200, a16
    v_accvgpr_read_b32 v201, a17
    v_accvgpr_read_b32 v202, a18
    v_accvgpr_read_b32 v203, a19
    v_mul_f32 v200, v200, v228
    v_mul_f32 v201, v201, v228
    v_mul_f32 v202, v202, v228
    v_mul_f32 v203, v203, v228
    v_accvgpr_write_b32 a16, v200
    v_accvgpr_write_b32 a17, v201
    v_accvgpr_write_b32 a18, v202
    v_accvgpr_write_b32 a19, v203
    v_accvgpr_read_b32 v200, a24
    v_accvgpr_read_b32 v201, a25
    v_accvgpr_read_b32 v202, a26
    v_accvgpr_read_b32 v203, a27
    v_mul_f32 v200, v200, v229
    v_mul_f32 v201, v201, v229
    v_mul_f32 v202, v202, v229
    v_mul_f32 v203, v203, v229
    v_accvgpr_write_b32 a24, v200
    v_accvgpr_write_b32 a25, v201
    v_accvgpr_write_b32 a26, v202
    v_accvgpr_write_b32 a27, v203
    v_accvgpr_read_b32 v200, a4
    v_accvgpr_read_b32 v201, a5
    v_accvgpr_read_b32 v202, a6
    v_accvgpr_read_b32 v203, a7
    v_mul_f32 v200, v200, v226
    v_mul_f32 v201, v201, v226
    v_mul_f32 v202, v202, v226
    v_mul_f32 v203, v203, v226
    v_accvgpr_write_b32 a4, v200
    v_accvgpr_write_b32 a5, v201
    v_accvgpr_write_b32 a6, v202
    v_accvgpr_write_b32 a7, v203
    v_accvgpr_read_b32 v200, a12
    v_accvgpr_read_b32 v201, a13
    v_accvgpr_read_b32 v202, a14
    v_accvgpr_read_b32 v203, a15
    v_mul_f32 v200, v200, v227
    v_mul_f32 v201, v201, v227
    v_mul_f32 v202, v202, v227
    v_mul_f32 v203, v203, v227
    v_accvgpr_write_b32 a12, v200
    v_accvgpr_write_b32 a13, v201
    v_accvgpr_write_b32 a14, v202
    v_accvgpr_write_b32 a15, v203
    v_accvgpr_read_b32 v200, a20
    v_accvgpr_read_b32 v201, a21
    v_accvgpr_read_b32 v202, a22
    v_accvgpr_read_b32 v203, a23
    v_mul_f32 v200, v200, v228
    v_mul_f32 v201, v201, v228
    v_mul_f32 v202, v202, v228
    v_mul_f32 v203, v203, v228
    v_accvgpr_write_b32 a20, v200
    v_accvgpr_write_b32 a21, v201
    v_accvgpr_write_b32 a22, v202
    v_accvgpr_write_b32 a23, v203
    v_accvgpr_read_b32 v200, a28
    v_accvgpr_read_b32 v201, a29
    v_accvgpr_read_b32 v202, a30
    v_accvgpr_read_b32 v203, a31
    v_mul_f32 v200, v200, v229
    v_mul_f32 v201, v201, v229
    v_mul_f32 v202, v202, v229
    v_mul_f32 v203, v203, v229
    v_accvgpr_write_b32 a28, v200
    v_accvgpr_write_b32 a29, v201
    v_accvgpr_write_b32 a30, v202
    v_accvgpr_write_b32 a31, v203
    v_accvgpr_read_b32 v200, a32
    v_accvgpr_read_b32 v201, a33
    v_accvgpr_read_b32 v202, a34
    v_accvgpr_read_b32 v203, a35
    v_mul_f32 v200, v200, v226
    v_mul_f32 v201, v201, v226
    v_mul_f32 v202, v202, v226
    v_mul_f32 v203, v203, v226
    v_accvgpr_write_b32 a32, v200
    v_accvgpr_write_b32 a33, v201
    v_accvgpr_write_b32 a34, v202
    v_accvgpr_write_b32 a35, v203
    v_accvgpr_read_b32 v200, a40
    v_accvgpr_read_b32 v201, a41
    v_accvgpr_read_b32 v202, a42
    v_accvgpr_read_b32 v203, a43
    v_mul_f32 v200, v200, v227
    v_mul_f32 v201, v201, v227
    v_mul_f32 v202, v202, v227
    v_mul_f32 v203, v203, v227
    v_accvgpr_write_b32 a40, v200
    v_accvgpr_write_b32 a41, v201
    v_accvgpr_write_b32 a42, v202
    v_accvgpr_write_b32 a43, v203
    v_accvgpr_read_b32 v200, a48
    v_accvgpr_read_b32 v201, a49
    v_accvgpr_read_b32 v202, a50
    v_accvgpr_read_b32 v203, a51
    v_mul_f32 v200, v200, v228
    v_mul_f32 v201, v201, v228
    v_mul_f32 v202, v202, v228
    v_mul_f32 v203, v203, v228
    v_accvgpr_write_b32 a48, v200
    v_accvgpr_write_b32 a49, v201
    v_accvgpr_write_b32 a50, v202
    v_accvgpr_write_b32 a51, v203
    v_accvgpr_read_b32 v200, a56
    v_accvgpr_read_b32 v201, a57
    v_accvgpr_read_b32 v202, a58
    v_accvgpr_read_b32 v203, a59
    v_mul_f32 v200, v200, v229
    v_mul_f32 v201, v201, v229
    v_mul_f32 v202, v202, v229
    v_mul_f32 v203, v203, v229
    v_accvgpr_write_b32 a56, v200
    v_accvgpr_write_b32 a57, v201
    v_accvgpr_write_b32 a58, v202
    v_accvgpr_write_b32 a59, v203
    v_accvgpr_read_b32 v200, a36
    v_accvgpr_read_b32 v201, a37
    v_accvgpr_read_b32 v202, a38
    v_accvgpr_read_b32 v203, a39
    v_mul_f32 v200, v200, v226
    v_mul_f32 v201, v201, v226
    v_mul_f32 v202, v202, v226
    v_mul_f32 v203, v203, v226
    v_accvgpr_write_b32 a36, v200
    v_accvgpr_write_b32 a37, v201
    v_accvgpr_write_b32 a38, v202
    v_accvgpr_write_b32 a39, v203
    v_accvgpr_read_b32 v200, a44
    v_accvgpr_read_b32 v201, a45
    v_accvgpr_read_b32 v202, a46
    v_accvgpr_read_b32 v203, a47
    v_mul_f32 v200, v200, v227
    v_mul_f32 v201, v201, v227
    v_mul_f32 v202, v202, v227
    v_mul_f32 v203, v203, v227
    v_accvgpr_write_b32 a44, v200
    v_accvgpr_write_b32 a45, v201
    v_accvgpr_write_b32 a46, v202
    v_accvgpr_write_b32 a47, v203
    v_accvgpr_read_b32 v200, a52
    v_accvgpr_read_b32 v201, a53
    v_accvgpr_read_b32 v202, a54
    v_accvgpr_read_b32 v203, a55
    v_mul_f32 v200, v200, v228
    v_mul_f32 v201, v201, v228
    v_mul_f32 v202, v202, v228
    v_mul_f32 v203, v203, v228
    v_accvgpr_write_b32 a52, v200
    v_accvgpr_write_b32 a53, v201
    v_accvgpr_write_b32 a54, v202
    v_accvgpr_write_b32 a55, v203
    v_accvgpr_read_b32 v200, a60
    v_accvgpr_read_b32 v201, a61
    v_accvgpr_read_b32 v202, a62
    v_accvgpr_read_b32 v203, a63
    v_mul_f32 v200, v200, v229
    v_mul_f32 v201, v201, v229
    v_mul_f32 v202, v202, v229
    v_mul_f32 v203, v203, v229
    v_accvgpr_write_b32 a60, v200
    v_accvgpr_write_b32 a61, v201
    v_accvgpr_write_b32 a62, v202
    v_accvgpr_write_b32 a63, v203
    v_accvgpr_read_b32 v200, a64
    v_accvgpr_read_b32 v201, a65
    v_accvgpr_read_b32 v202, a66
    v_accvgpr_read_b32 v203, a67
    v_mul_f32 v200, v200, v226
    v_mul_f32 v201, v201, v226
    v_mul_f32 v202, v202, v226
    v_mul_f32 v203, v203, v226
    v_accvgpr_write_b32 a64, v200
    v_accvgpr_write_b32 a65, v201
    v_accvgpr_write_b32 a66, v202
    v_accvgpr_write_b32 a67, v203
    v_accvgpr_read_b32 v200, a72
    v_accvgpr_read_b32 v201, a73
    v_accvgpr_read_b32 v202, a74
    v_accvgpr_read_b32 v203, a75
    v_mul_f32 v200, v200, v227
    v_mul_f32 v201, v201, v227
    v_mul_f32 v202, v202, v227
    v_mul_f32 v203, v203, v227
    v_accvgpr_write_b32 a72, v200
    v_accvgpr_write_b32 a73, v201
    v_accvgpr_write_b32 a74, v202
    v_accvgpr_write_b32 a75, v203
    v_accvgpr_read_b32 v200, a80
    v_accvgpr_read_b32 v201, a81
    v_accvgpr_read_b32 v202, a82
    v_accvgpr_read_b32 v203, a83
    v_mul_f32 v200, v200, v228
    v_mul_f32 v201, v201, v228
    v_mul_f32 v202, v202, v228
    v_mul_f32 v203, v203, v228
    v_accvgpr_write_b32 a80, v200
    v_accvgpr_write_b32 a81, v201
    v_accvgpr_write_b32 a82, v202
    v_accvgpr_write_b32 a83, v203
    v_accvgpr_read_b32 v200, a88
    v_accvgpr_read_b32 v201, a89
    v_accvgpr_read_b32 v202, a90
    v_accvgpr_read_b32 v203, a91
    v_mul_f32 v200, v200, v229
    v_mul_f32 v201, v201, v229
    v_mul_f32 v202, v202, v229
    v_mul_f32 v203, v203, v229
    v_accvgpr_write_b32 a88, v200
    v_accvgpr_write_b32 a89, v201
    v_accvgpr_write_b32 a90, v202
    v_accvgpr_write_b32 a91, v203
    v_accvgpr_read_b32 v200, a68
    v_accvgpr_read_b32 v201, a69
    v_accvgpr_read_b32 v202, a70
    v_accvgpr_read_b32 v203, a71
    v_mul_f32 v200, v200, v226
    v_mul_f32 v201, v201, v226
    v_mul_f32 v202, v202, v226
    v_mul_f32 v203, v203, v226
    v_accvgpr_write_b32 a68, v200
    v_accvgpr_write_b32 a69, v201
    v_accvgpr_write_b32 a70, v202
    v_accvgpr_write_b32 a71, v203
    v_accvgpr_read_b32 v200, a76
    v_accvgpr_read_b32 v201, a77
    v_accvgpr_read_b32 v202, a78
    v_accvgpr_read_b32 v203, a79
    v_mul_f32 v200, v200, v227
    v_mul_f32 v201, v201, v227
    v_mul_f32 v202, v202, v227
    v_mul_f32 v203, v203, v227
    v_accvgpr_write_b32 a76, v200
    v_accvgpr_write_b32 a77, v201
    v_accvgpr_write_b32 a78, v202
    v_accvgpr_write_b32 a79, v203
    v_accvgpr_read_b32 v200, a84
    v_accvgpr_read_b32 v201, a85
    v_accvgpr_read_b32 v202, a86
    v_accvgpr_read_b32 v203, a87
    v_mul_f32 v200, v200, v228
    v_mul_f32 v201, v201, v228
    v_mul_f32 v202, v202, v228
    v_mul_f32 v203, v203, v228
    v_accvgpr_write_b32 a84, v200
    v_accvgpr_write_b32 a85, v201
    v_accvgpr_write_b32 a86, v202
    v_accvgpr_write_b32 a87, v203
    v_accvgpr_read_b32 v200, a92
    v_accvgpr_read_b32 v201, a93
    v_accvgpr_read_b32 v202, a94
    v_accvgpr_read_b32 v203, a95
    v_mul_f32 v200, v200, v229
    v_mul_f32 v201, v201, v229
    v_mul_f32 v202, v202, v229
    v_mul_f32 v203, v203, v229
    v_accvgpr_write_b32 a92, v200
    v_accvgpr_write_b32 a93, v201
    v_accvgpr_write_b32 a94, v202
    v_accvgpr_write_b32 a95, v203
    v_accvgpr_read_b32 v200, a96
    v_accvgpr_read_b32 v201, a97
    v_accvgpr_read_b32 v202, a98
    v_accvgpr_read_b32 v203, a99
    v_mul_f32 v200, v200, v226
    v_mul_f32 v201, v201, v226
    v_mul_f32 v202, v202, v226
    v_mul_f32 v203, v203, v226
    v_accvgpr_write_b32 a96, v200
    v_accvgpr_write_b32 a97, v201
    v_accvgpr_write_b32 a98, v202
    v_accvgpr_write_b32 a99, v203
    v_accvgpr_read_b32 v200, a104
    v_accvgpr_read_b32 v201, a105
    v_accvgpr_read_b32 v202, a106
    v_accvgpr_read_b32 v203, a107
    v_mul_f32 v200, v200, v227
    v_mul_f32 v201, v201, v227
    v_mul_f32 v202, v202, v227
    v_mul_f32 v203, v203, v227
    v_accvgpr_write_b32 a104, v200
    v_accvgpr_write_b32 a105, v201
    v_accvgpr_write_b32 a106, v202
    v_accvgpr_write_b32 a107, v203
    v_accvgpr_read_b32 v200, a112
    v_accvgpr_read_b32 v201, a113
    v_accvgpr_read_b32 v202, a114
    v_accvgpr_read_b32 v203, a115
    v_mul_f32 v200, v200, v228
    v_mul_f32 v201, v201, v228
    v_mul_f32 v202, v202, v228
    v_mul_f32 v203, v203, v228
    v_accvgpr_write_b32 a112, v200
    v_accvgpr_write_b32 a113, v201
    v_accvgpr_write_b32 a114, v202
    v_accvgpr_write_b32 a115, v203
    v_accvgpr_read_b32 v200, a120
    v_accvgpr_read_b32 v201, a121
    v_accvgpr_read_b32 v202, a122
    v_accvgpr_read_b32 v203, a123
    v_mul_f32 v200, v200, v229
    v_mul_f32 v201, v201, v229
    v_mul_f32 v202, v202, v229
    v_mul_f32 v203, v203, v229
    v_accvgpr_write_b32 a120, v200
    v_accvgpr_write_b32 a121, v201
    v_accvgpr_write_b32 a122, v202
    v_accvgpr_write_b32 a123, v203
    v_accvgpr_read_b32 v200, a100
    v_accvgpr_read_b32 v201, a101
    v_accvgpr_read_b32 v202, a102
    v_accvgpr_read_b32 v203, a103
    v_mul_f32 v200, v200, v226
    v_mul_f32 v201, v201, v226
    v_mul_f32 v202, v202, v226
    v_mul_f32 v203, v203, v226
    v_accvgpr_write_b32 a100, v200
    v_accvgpr_write_b32 a101, v201
    v_accvgpr_write_b32 a102, v202
    v_accvgpr_write_b32 a103, v203
    v_accvgpr_read_b32 v200, a108
    v_accvgpr_read_b32 v201, a109
    v_accvgpr_read_b32 v202, a110
    v_accvgpr_read_b32 v203, a111
    v_mul_f32 v200, v200, v227
    v_mul_f32 v201, v201, v227
    v_mul_f32 v202, v202, v227
    v_mul_f32 v203, v203, v227
    v_accvgpr_write_b32 a108, v200
    v_accvgpr_write_b32 a109, v201
    v_accvgpr_write_b32 a110, v202
    v_accvgpr_write_b32 a111, v203
    v_accvgpr_read_b32 v200, a116
    v_accvgpr_read_b32 v201, a117
    v_accvgpr_read_b32 v202, a118
    v_accvgpr_read_b32 v203, a119
    v_mul_f32 v200, v200, v228
    v_mul_f32 v201, v201, v228
    v_mul_f32 v202, v202, v228
    v_mul_f32 v203, v203, v228
    v_accvgpr_write_b32 a116, v200
    v_accvgpr_write_b32 a117, v201
    v_accvgpr_write_b32 a118, v202
    v_accvgpr_write_b32 a119, v203
    v_accvgpr_read_b32 v200, a124
    v_accvgpr_read_b32 v201, a125
    v_accvgpr_read_b32 v202, a126
    v_accvgpr_read_b32 v203, a127
    v_mul_f32 v200, v200, v229
    v_mul_f32 v201, v201, v229
    v_mul_f32 v202, v202, v229
    v_mul_f32 v203, v203, v229
    v_accvgpr_write_b32 a124, v200
    v_accvgpr_write_b32 a125, v201
    v_accvgpr_write_b32 a126, v202
    v_accvgpr_write_b32 a127, v203
    v_lshlrev_b32 v224, 16, v96
    v_and_b32 v225, 0xffff0000, v96
    v_mul_f32 v224, v224, v226
    v_mul_f32 v225, v225, v226
    v_cvt_pk_bf16_f32 v96, v224, v225
    v_lshlrev_b32 v224, 16, v97
    v_and_b32 v225, 0xffff0000, v97
    v_mul_f32 v224, v224, v226
    v_mul_f32 v225, v225, v226
    v_cvt_pk_bf16_f32 v97, v224, v225
    v_lshlrev_b32 v224, 16, v98
    v_and_b32 v225, 0xffff0000, v98
    v_mul_f32 v224, v224, v226
    v_mul_f32 v225, v225, v226
    v_cvt_pk_bf16_f32 v98, v224, v225
    v_lshlrev_b32 v224, 16, v99
    v_and_b32 v225, 0xffff0000, v99
    v_mul_f32 v224, v224, v226
    v_mul_f32 v225, v225, v226
    v_cvt_pk_bf16_f32 v99, v224, v225
    v_lshlrev_b32 v224, 16, v100
    v_and_b32 v225, 0xffff0000, v100
    v_mul_f32 v224, v224, v227
    v_mul_f32 v225, v225, v227
    v_cvt_pk_bf16_f32 v100, v224, v225
    v_lshlrev_b32 v224, 16, v101
    v_and_b32 v225, 0xffff0000, v101
    v_mul_f32 v224, v224, v227
    v_mul_f32 v225, v225, v227
    v_cvt_pk_bf16_f32 v101, v224, v225
    v_lshlrev_b32 v224, 16, v102
    v_and_b32 v225, 0xffff0000, v102
    v_mul_f32 v224, v224, v227
    v_mul_f32 v225, v225, v227
    v_cvt_pk_bf16_f32 v102, v224, v225
    v_lshlrev_b32 v224, 16, v103
    v_and_b32 v225, 0xffff0000, v103
    v_mul_f32 v224, v224, v227
    v_mul_f32 v225, v225, v227
    v_cvt_pk_bf16_f32 v103, v224, v225
    v_lshlrev_b32 v224, 16, v104
    v_and_b32 v225, 0xffff0000, v104
    v_mul_f32 v224, v224, v228
    v_mul_f32 v225, v225, v228
    v_cvt_pk_bf16_f32 v104, v224, v225
    v_lshlrev_b32 v224, 16, v105
    v_and_b32 v225, 0xffff0000, v105
    v_mul_f32 v224, v224, v228
    v_mul_f32 v225, v225, v228
    v_cvt_pk_bf16_f32 v105, v224, v225
    v_lshlrev_b32 v224, 16, v106
    v_and_b32 v225, 0xffff0000, v106
    v_mul_f32 v224, v224, v228
    v_mul_f32 v225, v225, v228
    v_cvt_pk_bf16_f32 v106, v224, v225
    v_lshlrev_b32 v224, 16, v107
    v_and_b32 v225, 0xffff0000, v107
    v_mul_f32 v224, v224, v228
    v_mul_f32 v225, v225, v228
    v_cvt_pk_bf16_f32 v107, v224, v225
    v_lshlrev_b32 v224, 16, v108
    v_and_b32 v225, 0xffff0000, v108
    v_mul_f32 v224, v224, v229
    v_mul_f32 v225, v225, v229
    v_cvt_pk_bf16_f32 v108, v224, v225
    v_lshlrev_b32 v224, 16, v109
    v_and_b32 v225, 0xffff0000, v109
    v_mul_f32 v224, v224, v229
    v_mul_f32 v225, v225, v229
    v_cvt_pk_bf16_f32 v109, v224, v225
    v_lshlrev_b32 v224, 16, v110
    v_and_b32 v225, 0xffff0000, v110
    v_mul_f32 v224, v224, v229
    v_mul_f32 v225, v225, v229
    v_cvt_pk_bf16_f32 v110, v224, v225
    v_lshlrev_b32 v224, 16, v111
    v_and_b32 v225, 0xffff0000, v111
    v_mul_f32 v224, v224, v229
    v_mul_f32 v225, v225, v229
    v_cvt_pk_bf16_f32 v111, v224, v225
    v_mov_b32 v200, 0x3f803f80
    v_mov_b32 v201, 0x3f803f80
    v_mov_b32 v202, 0x3f803f80
    v_mov_b32 v203, 0x3f803f80
    v_exp_f32 v224, v64
    v_exp_f32 v225, v65
    v_exp_f32 v226, v66
    v_exp_f32 v227, v67
    v_cvt_pk_bf16_f32 v112, v224, v225
    v_exp_f32 v228, v68
    v_exp_f32 v229, v69
    v_cvt_pk_bf16_f32 v113, v226, v227
    v_exp_f32 v224, v70
    v_exp_f32 v225, v71
    v_cvt_pk_bf16_f32 v114, v228, v229
    v_exp_f32 v226, v72
    v_exp_f32 v227, v73
    v_cvt_pk_bf16_f32 v115, v224, v225
    v_exp_f32 v228, v74
    v_exp_f32 v229, v75
    v_cvt_pk_bf16_f32 v116, v226, v227
    v_exp_f32 v224, v76
    v_exp_f32 v225, v77
    v_cvt_pk_bf16_f32 v117, v228, v229
    v_exp_f32 v226, v78
    v_exp_f32 v227, v79
    v_cvt_pk_bf16_f32 v118, v224, v225
    v_exp_f32 v228, v80
    v_exp_f32 v229, v81
    v_cvt_pk_bf16_f32 v119, v226, v227
    v_exp_f32 v224, v82
    v_exp_f32 v225, v83
    v_cvt_pk_bf16_f32 v120, v228, v229
    v_exp_f32 v226, v84
    v_exp_f32 v227, v85
    v_cvt_pk_bf16_f32 v121, v224, v225
    v_exp_f32 v228, v86
    v_exp_f32 v229, v87
    v_cvt_pk_bf16_f32 v122, v226, v227
    v_exp_f32 v224, v88
    v_exp_f32 v225, v89
    v_cvt_pk_bf16_f32 v123, v228, v229
    v_exp_f32 v226, v90
    v_exp_f32 v227, v91
    v_cvt_pk_bf16_f32 v124, v224, v225
    v_exp_f32 v228, v92
    v_exp_f32 v229, v93
    v_cvt_pk_bf16_f32 v125, v226, v227
    v_exp_f32 v224, v94
    v_exp_f32 v225, v95
    v_cvt_pk_bf16_f32 v126, v228, v229
    s_nop 0
    v_cvt_pk_bf16_f32 v127, v224, v225
    s_nop 1
    s_setpc_b64 s[34:35]
.section .rodata,"a"
.p2align 6
.amdhsa_kernel recurrent_scan__sliding_block_cached__dense_activation_squared_relu__prompt_kernel
  .amdhsa_next_free_vgpr 512
  .amdhsa_next_free_sgpr 102
  .amdhsa_accum_offset 256
  .amdhsa_group_segment_fixed_size 0
  .amdhsa_kernarg_size 104
  .amdhsa_user_sgpr_count 2
  .amdhsa_user_sgpr_kernarg_segment_ptr 1
  .amdhsa_system_sgpr_workgroup_id_x 1
.end_amdhsa_kernel
```
